```python
import torch

def _softmax(x, axis=-1):
    return torch.softmax(x, dim=axis)
def _gelu(x):
    return torch.nn.functional.gelu(x, approximate="tanh")
def _silu(x):
    return torch.nn.functional.silu(x)
def _sigmoid(x):
    return torch.sigmoid(x)
def _layernorm(x, axis=-1, eps=1e-5):
    m = x.mean(dim=axis, keepdim=True)
    v = x.var(dim=axis, keepdim=True, unbiased=False)
    return (x - m) / torch.sqrt(v + eps)
def _scatter_add(tgt, idx, src, axis=0):
    return tgt.clone().index_add_(axis, idx, src)
def _segment_sum(src, seg, n):
    out = torch.zeros((n,) + src.shape[1:], dtype=src.dtype)
    return out.index_add_(0, seg, src)
def _pad(x, pw):
    flat = tuple(v for pair in reversed(pw) for v in pair)
    return torch.nn.functional.pad(x, flat)

kernel_name = 'parallel_sum__sliding_block__mixer_token_mlp__prompt'

def setup_inputs():

    _w = (lambda a: (lambda t: t.to(torch.bfloat16) if t.is_floating_point() else t)(torch.as_tensor(a)))
    def _A_setup():
        B, S, D = 1, 2048, 576
        return {
            "x": _w((lambda *s: torch.randn(*s, dtype=torch.bfloat16) * 0.05)(B, S, D)),
            "wqkv": _w((lambda *s: torch.randn(*s, dtype=torch.bfloat16) * 0.05)(D, 3 * D)),
            "wo": _w((lambda *s: torch.randn(*s, dtype=torch.bfloat16) * 0.05)(D, D)),
        }
    _A_in = _A_setup()

    def _B_setup():
        B, S, D, F = 1, 2048, 576, 4608
        return {
            "x": _w((lambda *s: torch.randn(*s, dtype=torch.bfloat16) * 0.05)(B, S, D)),
            "w1": _w((lambda *s: torch.randn(*s, dtype=torch.bfloat16) * 1.6)(S, F) * (S ** -0.5)),
            "b1": _w((lambda *s: torch.randn(*s, dtype=torch.bfloat16) * 12.8)(F) * 0.02),
            "w2": _w((lambda *s: torch.randn(*s, dtype=torch.bfloat16) * 0.4)(F, S) * (F ** -0.5)),
            "b2": _w((lambda *s: torch.randn(*s, dtype=torch.bfloat16) * 6.4)(S) * 0.02),
        }
    _B_in = _B_setup()

    return {
        "A_x": _A_in["x"],
        "A_wqkv": _A_in["wqkv"],
        "A_wo": _A_in["wo"],
        "B_x": _B_in["x"],
        "B_w1": _B_in["w1"],
        "B_b1": _B_in["b1"],
        "B_w2": _B_in["w2"],
        "B_b2": _B_in["b2"],
    }

def reference(A_x, A_wqkv, A_wo, B_x, B_w1, B_b1, B_w2, B_b2):
    def _A_ref(x, wqkv, wo):
        B, S, D = x.shape
        H = 32; Dh = D // H; W = 256
        qkv = (lambda x, *d: x.permute(*d))((x @ wqkv).reshape(B, S, 3, H, Dh), 2, 0, 3, 1, 4)
        q, k, v = qkv[0], qkv[1], qkv[2]
        scores = torch.einsum("bhqd,bhkd->bhqk", q, k) * (Dh ** -0.5)
        idx = torch.arange(S)
        mask = (idx[:, None] - idx[None, :] >= 0) & (idx[:, None] - idx[None, :] < W)
        scores = torch.where(mask[None, None], scores, -1e9)
        p = _softmax(scores, axis=-1)
        o = torch.einsum("bhqk,bhkd->bhqd", p, v)
        return (lambda x, *d: x.permute(*d))(o, 0, 2, 1, 3).reshape(B, S, D) @ wo

    def _B_ref(x, w1, b1, w2, b2):
        B, S, D = x.shape
        h = _layernorm(x, axis=-1)
        u = torch.einsum("bsd,sf->bdf", h, w1) + b1
        u = _gelu(u)
        y = torch.einsum("bdf,fs->bds", u, w2) + b2
        return (lambda x, *d: x.permute(*d))(y, 0, 2, 1)

    x = A_x
    xn = _layernorm(x, axis=-1)
    return x + _A_ref(xn, A_wqkv, A_wo) + _B_ref(xn, B_w1, B_b1, B_w2, B_b2)
```

```asm
; @launch kernel=k0_ln_qkv_kernel grid=(256,1,1) block=(512,1,1) lds=122880
; @launch kernel=k1_gemm1_attn_kernel grid=(256,1,1) block=(512,1,1) lds=143616
; @launch kernel=k2_gemm2_kernel grid=(256,1,1) block=(512,1,1) lds=104448
.amdgcn_target "amdgcn-amd-amdhsa--gfx950"
.text
.p2align 8
.globl k0_ln_qkv_kernel
.type k0_ln_qkv_kernel,@function
k0_ln_qkv_kernel:
  s_cmp_ge_u32 s2, 256
  s_cbranch_scc1 k0_exit
  s_load_dwordx4 s[24:27], s[0:1], 0
  s_load_dwordx2 s[28:29], s[0:1], 16
  s_load_dwordx2 s[30:31], s[0:1], 80
  s_load_dwordx2 s[44:45], s[0:1], 32
  v_lshrrev_b32 v1, 6, v0
  v_and_b32 v0, 63, v0
  v_readfirstlane_b32 s3, v1
  s_and_b32 s4, s2, 7
  s_lshr_b32 s5, s2, 3
  s_lshl_b32 s6, s4, 1
  s_and_b32 s7, s5, 1
  s_add_u32 s6, s6, s7
  s_lshr_b32 s7, s5, 1
  s_waitcnt lgkmcnt(0)
  s_mov_b32 s8, s24
  s_and_b32 s9, s25, 0xffff
  s_mov_b32 s10, 2359296
  s_mov_b32 s11, 0x20000
  s_mov_b32 s12, s26
  s_and_b32 s13, s27, 0xffff
  s_mov_b32 s14, 1990656
  s_mov_b32 s15, 0x20000
  s_mov_b32 s20, s28
  s_and_b32 s21, s29, 0xffff
  s_mov_b32 s22, 663552
  s_mov_b32 s23, 0x20000
  s_mov_b32 s16, s30
  s_and_b32 s17, s31, 0xffff
  s_mov_b32 s18, 37355520
  s_mov_b32 s19, 0x20000
  s_mov_b32 s48, s44
  s_and_b32 s49, s45, 0xffff
  s_mov_b32 s50, 15728640
  s_mov_b32 s51, 0x20000
  s_cmp_ge_u32 s5, 26
  s_cbranch_scc1 k0_pf
  s_cmp_ge_u32 s5, 18
  s_cbranch_scc1 k0_ln
  s_cmp_ge_u32 s3, 4
  s_cbranch_scc1 k0_loader
  s_setprio 2
  v_lshrrev_b32 v164, 4, v0
  v_bfe_u32 v165, v0, 2, 2
  v_lshl_add_u32 v166, v164, 3, v165
  v_mul_u32_u24 v166, 384, v166
  v_and_b32 v167, 3, v0
  v_lshl_add_u32 v166, v167, 3, v166
  v_lshrrev_b32 v165, 1, v165
  v_and_b32 v164, 1, v164
  v_lshl_add_u32 v165, v164, 1, v165
  v_xor_b32 v164, 0, v165
  v_lshl_add_u32 v1, v164, 5, v166
  v_xor_b32 v164, 1, v165
  v_lshl_add_u32 v2, v164, 5, v166
  v_xor_b32 v164, 2, v165
  v_lshl_add_u32 v3, v164, 5, v166
  v_xor_b32 v164, 3, v165
  v_lshl_add_u32 v4, v164, 5, v166
  s_lshl_b32 s32, s6, 7
  s_lshl_b32 s33, s3, 5
  s_add_u32 s32, s32, s33
  v_and_b32 v13, 15, v0
  v_lshrrev_b32 v14, 4, v0
  v_add_u32 v15, s32, v13
  v_lshrrev_b32 v16, 1, v13
  v_xor_b32 v16, v16, v14
  v_add_u32 v17, s33, v13
  v_lshlrev_b32 v17, 7, v17
  v_lshl_add_u32 v9, v16, 4, v17
  v_xor_b32 v16, 4, v16
  v_lshl_add_u32 v10, v16, 4, v17
  v_mov_b32 v5, v1
  v_mov_b32 v40, 0x3f803f80
  v_mov_b32 v6, v2
  v_mov_b32 v41, 0x3f803f80
  v_mov_b32 v7, v3
  v_mov_b32 v42, 0x3f803f80
  v_mov_b32 v8, v4
  v_mov_b32 v43, 0x3f803f80
  v_mov_b32 v11, v9
  v_mov_b32 v12, v10
  v_mov_b32 v24, 0
  v_mov_b32 v25, 0
  v_mov_b32 v26, 0
  v_mov_b32 v27, 0
  v_mov_b32 v28, 0
  v_mov_b32 v29, 0
  v_mov_b32 v30, 0
  v_mov_b32 v31, 0
  v_mov_b32 v32, 0
  v_mov_b32 v33, 0
  v_mov_b32 v34, 0
  v_mov_b32 v35, 0
  v_mov_b32 v36, 0
  v_mov_b32 v37, 0
  v_mov_b32 v38, 0
  v_mov_b32 v39, 0
  s_mul_i32 s35, s7, 86
  s_lshr_b32 s35, s35, 8
  s_mul_i32 s34, s35, 3
  s_sub_u32 s35, s7, s34
  s_mov_b32 s44, 0
  s_cmp_ge_u32 s7, 6
  s_cbranch_scc1 k0_cv
  s_mov_b32 s36, 10878976
  s_mov_b32 s37, 13238272
  s_cmp_ge_u32 s7, 3
  s_cselect_b32 s36, s37, s36
  s_mul_i32 s37, s35, 48
  v_lshlrev_b32 v16, 5, v15
  v_lshlrev_b32 v17, 3, v15
  v_add_u32 v18, s37, v14
  v_add_u32 v164, 0, v18
  v_mul_u32_u24 v165, 57, v164
  v_lshrrev_b32 v165, 9, v165
  v_mul_u32_u24 v166, 9, v165
  v_sub_u32 v164, v164, v166
  v_cmp_lt_u32 vcc, 4, v164
  v_lshlrev_b32 v166, 17, v165
  v_lshl_add_u32 v166, v164, 3, v166
  v_add_u32 v166, v166, v16
  v_add_u32 v44, 65496, v166
  v_cndmask_b32 v166, v166, v44, vcc
  v_cmp_eq_u32 vcc, 4, v164
  v_lshlrev_b32 v165, 14, v165
  v_add_u32 v165, 2097152, v165
  v_add_u32 v165, v165, v17
  v_cndmask_b32 v44, v166, v165, vcc
  v_mov_b32 v164, 512
  v_mov_b32 v165, 128
  v_cndmask_b32 v164, v164, v165, vcc
  v_add_u32 v56, v44, v164
  v_add_u32 v164, 4, v18
  v_mul_u32_u24 v165, 57, v164
  v_lshrrev_b32 v165, 9, v165
  v_mul_u32_u24 v166, 9, v165
  v_sub_u32 v164, v164, v166
  v_cmp_lt_u32 vcc, 4, v164
  v_lshlrev_b32 v166, 17, v165
  v_lshl_add_u32 v166, v164, 3, v166
  v_add_u32 v166, v166, v16
  v_add_u32 v45, 65496, v166
  v_cndmask_b32 v166, v166, v45, vcc
  v_cmp_eq_u32 vcc, 4, v164
  v_lshlrev_b32 v165, 14, v165
  v_add_u32 v165, 2097152, v165
  v_add_u32 v165, v165, v17
  v_cndmask_b32 v45, v166, v165, vcc
  v_mov_b32 v164, 512
  v_mov_b32 v165, 128
  v_cndmask_b32 v164, v164, v165, vcc
  v_add_u32 v57, v45, v164
  v_add_u32 v164, 8, v18
  v_mul_u32_u24 v165, 57, v164
  v_lshrrev_b32 v165, 9, v165
  v_mul_u32_u24 v166, 9, v165
  v_sub_u32 v164, v164, v166
  v_cmp_lt_u32 vcc, 4, v164
  v_lshlrev_b32 v166, 17, v165
  v_lshl_add_u32 v166, v164, 3, v166
  v_add_u32 v166, v166, v16
  v_add_u32 v46, 65496, v166
  v_cndmask_b32 v166, v166, v46, vcc
  v_cmp_eq_u32 vcc, 4, v164
  v_lshlrev_b32 v165, 14, v165
  v_add_u32 v165, 2097152, v165
  v_add_u32 v165, v165, v17
  v_cndmask_b32 v46, v166, v165, vcc
  v_mov_b32 v164, 512
  v_mov_b32 v165, 128
  v_cndmask_b32 v164, v164, v165, vcc
  v_add_u32 v58, v46, v164
  v_add_u32 v164, 12, v18
  v_mul_u32_u24 v165, 57, v164
  v_lshrrev_b32 v165, 9, v165
  v_mul_u32_u24 v166, 9, v165
  v_sub_u32 v164, v164, v166
  v_cmp_lt_u32 vcc, 4, v164
  v_lshlrev_b32 v166, 17, v165
  v_lshl_add_u32 v166, v164, 3, v166
  v_add_u32 v166, v166, v16
  v_add_u32 v47, 65496, v166
  v_cndmask_b32 v166, v166, v47, vcc
  v_cmp_eq_u32 vcc, 4, v164
  v_lshlrev_b32 v165, 14, v165
  v_add_u32 v165, 2097152, v165
  v_add_u32 v165, v165, v17
  v_cndmask_b32 v47, v166, v165, vcc
  v_mov_b32 v164, 512
  v_mov_b32 v165, 128
  v_cndmask_b32 v164, v164, v165, vcc
  v_add_u32 v59, v47, v164
  v_add_u32 v164, 16, v18
  v_mul_u32_u24 v165, 57, v164
  v_lshrrev_b32 v165, 9, v165
  v_mul_u32_u24 v166, 9, v165
  v_sub_u32 v164, v164, v166
  v_cmp_lt_u32 vcc, 4, v164
  v_lshlrev_b32 v166, 17, v165
  v_lshl_add_u32 v166, v164, 3, v166
  v_add_u32 v166, v166, v16
  v_add_u32 v48, 65496, v166
  v_cndmask_b32 v166, v166, v48, vcc
  v_cmp_eq_u32 vcc, 4, v164
  v_lshlrev_b32 v165, 14, v165
  v_add_u32 v165, 2097152, v165
  v_add_u32 v165, v165, v17
  v_cndmask_b32 v48, v166, v165, vcc
  v_mov_b32 v164, 512
  v_mov_b32 v165, 128
  v_cndmask_b32 v164, v164, v165, vcc
  v_add_u32 v60, v48, v164
  v_add_u32 v164, 20, v18
  v_mul_u32_u24 v165, 57, v164
  v_lshrrev_b32 v165, 9, v165
  v_mul_u32_u24 v166, 9, v165
  v_sub_u32 v164, v164, v166
  v_cmp_lt_u32 vcc, 4, v164
  v_lshlrev_b32 v166, 17, v165
  v_lshl_add_u32 v166, v164, 3, v166
  v_add_u32 v166, v166, v16
  v_add_u32 v49, 65496, v166
  v_cndmask_b32 v166, v166, v49, vcc
  v_cmp_eq_u32 vcc, 4, v164
  v_lshlrev_b32 v165, 14, v165
  v_add_u32 v165, 2097152, v165
  v_add_u32 v165, v165, v17
  v_cndmask_b32 v49, v166, v165, vcc
  v_mov_b32 v164, 512
  v_mov_b32 v165, 128
  v_cndmask_b32 v164, v164, v165, vcc
  v_add_u32 v61, v49, v164
  v_add_u32 v164, 24, v18
  v_mul_u32_u24 v165, 57, v164
  v_lshrrev_b32 v165, 9, v165
  v_mul_u32_u24 v166, 9, v165
  v_sub_u32 v164, v164, v166
  v_cmp_lt_u32 vcc, 4, v164
  v_lshlrev_b32 v166, 17, v165
  v_lshl_add_u32 v166, v164, 3, v166
  v_add_u32 v166, v166, v16
  v_add_u32 v50, 65496, v166
  v_cndmask_b32 v166, v166, v50, vcc
  v_cmp_eq_u32 vcc, 4, v164
  v_lshlrev_b32 v165, 14, v165
  v_add_u32 v165, 2097152, v165
  v_add_u32 v165, v165, v17
  v_cndmask_b32 v50, v166, v165, vcc
  v_mov_b32 v164, 512
  v_mov_b32 v165, 128
  v_cndmask_b32 v164, v164, v165, vcc
  v_add_u32 v62, v50, v164
  v_add_u32 v164, 28, v18
  v_mul_u32_u24 v165, 57, v164
  v_lshrrev_b32 v165, 9, v165
  v_mul_u32_u24 v166, 9, v165
  v_sub_u32 v164, v164, v166
  v_cmp_lt_u32 vcc, 4, v164
  v_lshlrev_b32 v166, 17, v165
  v_lshl_add_u32 v166, v164, 3, v166
  v_add_u32 v166, v166, v16
  v_add_u32 v51, 65496, v166
  v_cndmask_b32 v166, v166, v51, vcc
  v_cmp_eq_u32 vcc, 4, v164
  v_lshlrev_b32 v165, 14, v165
  v_add_u32 v165, 2097152, v165
  v_add_u32 v165, v165, v17
  v_cndmask_b32 v51, v166, v165, vcc
  v_mov_b32 v164, 512
  v_mov_b32 v165, 128
  v_cndmask_b32 v164, v164, v165, vcc
  v_add_u32 v63, v51, v164
  v_add_u32 v164, 32, v18
  v_mul_u32_u24 v165, 57, v164
  v_lshrrev_b32 v165, 9, v165
  v_mul_u32_u24 v166, 9, v165
  v_sub_u32 v164, v164, v166
  v_cmp_lt_u32 vcc, 4, v164
  v_lshlrev_b32 v166, 17, v165
  v_lshl_add_u32 v166, v164, 3, v166
  v_add_u32 v166, v166, v16
  v_add_u32 v52, 65496, v166
  v_cndmask_b32 v166, v166, v52, vcc
  v_cmp_eq_u32 vcc, 4, v164
  v_lshlrev_b32 v165, 14, v165
  v_add_u32 v165, 2097152, v165
  v_add_u32 v165, v165, v17
  v_cndmask_b32 v52, v166, v165, vcc
  v_mov_b32 v164, 512
  v_mov_b32 v165, 128
  v_cndmask_b32 v164, v164, v165, vcc
  v_add_u32 v64, v52, v164
  v_add_u32 v164, 36, v18
  v_mul_u32_u24 v165, 57, v164
  v_lshrrev_b32 v165, 9, v165
  v_mul_u32_u24 v166, 9, v165
  v_sub_u32 v164, v164, v166
  v_cmp_lt_u32 vcc, 4, v164
  v_lshlrev_b32 v166, 17, v165
  v_lshl_add_u32 v166, v164, 3, v166
  v_add_u32 v166, v166, v16
  v_add_u32 v53, 65496, v166
  v_cndmask_b32 v166, v166, v53, vcc
  v_cmp_eq_u32 vcc, 4, v164
  v_lshlrev_b32 v165, 14, v165
  v_add_u32 v165, 2097152, v165
  v_add_u32 v165, v165, v17
  v_cndmask_b32 v53, v166, v165, vcc
  v_mov_b32 v164, 512
  v_mov_b32 v165, 128
  v_cndmask_b32 v164, v164, v165, vcc
  v_add_u32 v65, v53, v164
  v_add_u32 v164, 40, v18
  v_mul_u32_u24 v165, 57, v164
  v_lshrrev_b32 v165, 9, v165
  v_mul_u32_u24 v166, 9, v165
  v_sub_u32 v164, v164, v166
  v_cmp_lt_u32 vcc, 4, v164
  v_lshlrev_b32 v166, 17, v165
  v_lshl_add_u32 v166, v164, 3, v166
  v_add_u32 v166, v166, v16
  v_add_u32 v54, 65496, v166
  v_cndmask_b32 v166, v166, v54, vcc
  v_cmp_eq_u32 vcc, 4, v164
  v_lshlrev_b32 v165, 14, v165
  v_add_u32 v165, 2097152, v165
  v_add_u32 v165, v165, v17
  v_cndmask_b32 v54, v166, v165, vcc
  v_mov_b32 v164, 512
  v_mov_b32 v165, 128
  v_cndmask_b32 v164, v164, v165, vcc
  v_add_u32 v66, v54, v164
  v_add_u32 v164, 44, v18
  v_mul_u32_u24 v165, 57, v164
  v_lshrrev_b32 v165, 9, v165
  v_mul_u32_u24 v166, 9, v165
  v_sub_u32 v164, v164, v166
  v_cmp_lt_u32 vcc, 4, v164
  v_lshlrev_b32 v166, 17, v165
  v_lshl_add_u32 v166, v164, 3, v166
  v_add_u32 v166, v166, v16
  v_add_u32 v55, 65496, v166
  v_cndmask_b32 v166, v166, v55, vcc
  v_cmp_eq_u32 vcc, 4, v164
  v_lshlrev_b32 v165, 14, v165
  v_add_u32 v165, 2097152, v165
  v_add_u32 v165, v165, v17
  v_cndmask_b32 v55, v166, v165, vcc
  v_mov_b32 v164, 512
  v_mov_b32 v165, 128
  v_cndmask_b32 v164, v164, v165, vcc
  v_add_u32 v67, v55, v164
  v_mov_b32 v68, 0
  v_mov_b32 v69, 0
  v_mov_b32 v70, 0
  v_mov_b32 v71, 0
  v_mov_b32 v72, 0
  v_mov_b32 v73, 0
  v_mov_b32 v74, 0
  v_mov_b32 v75, 0
  v_mov_b32 v76, 0
  v_mov_b32 v77, 0
  v_mov_b32 v78, 0
  v_mov_b32 v79, 0
  v_mov_b32 v80, 0
  v_mov_b32 v81, 0
  v_mov_b32 v82, 0
  v_mov_b32 v83, 0
  v_mov_b32 v84, 0
  v_mov_b32 v85, 0
  v_mov_b32 v86, 0
  v_mov_b32 v87, 0
  v_mov_b32 v88, 0
  v_mov_b32 v89, 0
  v_mov_b32 v90, 0
  v_mov_b32 v91, 0
  v_mov_b32 v92, 0
  v_mov_b32 v93, 0
  v_mov_b32 v94, 0
  v_mov_b32 v95, 0
  v_mov_b32 v96, 0
  v_mov_b32 v97, 0
  v_mov_b32 v98, 0
  v_mov_b32 v99, 0
  v_mov_b32 v100, 0
  v_mov_b32 v101, 0
  v_mov_b32 v102, 0
  v_mov_b32 v103, 0
  v_mov_b32 v104, 0
  v_mov_b32 v105, 0
  v_mov_b32 v106, 0
  v_mov_b32 v107, 0
  v_mov_b32 v108, 0
  v_mov_b32 v109, 0
  v_mov_b32 v110, 0
  v_mov_b32 v111, 0
  v_mov_b32 v112, 0
  v_mov_b32 v113, 0
  v_mov_b32 v114, 0
  v_mov_b32 v115, 0
  v_mov_b32 v116, 0
  v_mov_b32 v117, 0
  v_mov_b32 v118, 0
  v_mov_b32 v119, 0
  v_mov_b32 v120, 0
  v_mov_b32 v121, 0
  v_mov_b32 v122, 0
  v_mov_b32 v123, 0
  v_mov_b32 v124, 0
  v_mov_b32 v125, 0
  v_mov_b32 v126, 0
  v_mov_b32 v127, 0
  v_mov_b32 v128, 0
  v_mov_b32 v129, 0
  v_mov_b32 v130, 0
  v_mov_b32 v131, 0
  v_mov_b32 v132, 0
  v_mov_b32 v133, 0
  v_mov_b32 v134, 0
  v_mov_b32 v135, 0
  v_mov_b32 v136, 0
  v_mov_b32 v137, 0
  v_mov_b32 v138, 0
  v_mov_b32 v139, 0
  v_mov_b32 v140, 0
  v_mov_b32 v141, 0
  v_mov_b32 v142, 0
  v_mov_b32 v143, 0
  v_mov_b32 v144, 0
  v_mov_b32 v145, 0
  v_mov_b32 v146, 0
  v_mov_b32 v147, 0
  v_mov_b32 v148, 0
  v_mov_b32 v149, 0
  v_mov_b32 v150, 0
  v_mov_b32 v151, 0
  v_mov_b32 v152, 0
  v_mov_b32 v153, 0
  v_mov_b32 v154, 0
  v_mov_b32 v155, 0
  v_mov_b32 v156, 0
  v_mov_b32 v157, 0
  v_mov_b32 v158, 0
  v_mov_b32 v159, 0
  v_mov_b32 v160, 0
  v_mov_b32 v161, 0
  v_mov_b32 v162, 0
  v_mov_b32 v163, 0
  s_barrier
  ds_read_b128 v[204:207], v11 offset:24576
  ds_read_b128 v[208:211], v11 offset:26624
  ds_read_b64_tr_b16 v[180:181], v5 offset:0
  ds_read_b64_tr_b16 v[182:183], v5 offset:1536
  ds_read_b64_tr_b16 v[184:185], v6 offset:0
  ds_read_b64_tr_b16 v[186:187], v6 offset:1536
  ds_read_b64_tr_b16 v[188:189], v7 offset:0
  ds_read_b64_tr_b16 v[190:191], v7 offset:1536
  ds_read_b64_tr_b16 v[192:193], v8 offset:0
  ds_read_b64_tr_b16 v[194:195], v8 offset:1536
  s_mov_b32 s45, 8
k0_loop_qk:
  s_waitcnt lgkmcnt(6)
  v_mfma_f32_16x16x32_bf16 v[68:71], v[180:183], v[204:207], v[68:71]
  ds_read_b64_tr_b16 v[196:197], v5 offset:128
  ds_read_b64_tr_b16 v[198:199], v5 offset:1664
  v_mfma_f32_16x16x32_bf16 v[72:75], v[180:183], v[208:211], v[72:75]
  s_waitcnt lgkmcnt(6)
  v_mfma_f32_16x16x32_bf16 v[76:79], v[184:187], v[204:207], v[76:79]
  ds_read_b64_tr_b16 v[200:201], v6 offset:128
  ds_read_b64_tr_b16 v[202:203], v6 offset:1664
  v_mfma_f32_16x16x32_bf16 v[80:83], v[184:187], v[208:211], v[80:83]
  s_waitcnt lgkmcnt(6)
  v_mfma_f32_16x16x32_bf16 v[84:87], v[188:191], v[204:207], v[84:87]
  ds_read_b64_tr_b16 v[180:181], v7 offset:128
  ds_read_b64_tr_b16 v[182:183], v7 offset:1664
  v_mfma_f32_16x16x32_bf16 v[88:91], v[188:191], v[208:211], v[88:91]
  v_mfma_f32_16x16x32_bf16 v[24:27], v[40:43], v[204:207], v[24:27]
  s_waitcnt lgkmcnt(6)
  v_mfma_f32_16x16x32_bf16 v[92:95], v[192:195], v[204:207], v[92:95]
  ds_read_b64_tr_b16 v[184:185], v8 offset:128
  ds_read_b64_tr_b16 v[186:187], v8 offset:1664
  v_mfma_f32_16x16x32_bf16 v[96:99], v[192:195], v[208:211], v[96:99]
  v_mfma_f32_16x16x32_bf16 v[28:31], v[40:43], v[208:211], v[28:31]
  s_waitcnt lgkmcnt(6)
  v_mfma_f32_16x16x32_bf16 v[100:103], v[196:199], v[204:207], v[100:103]
  ds_read_b64_tr_b16 v[188:189], v5 offset:256
  ds_read_b64_tr_b16 v[190:191], v5 offset:1792
  v_mfma_f32_16x16x32_bf16 v[104:107], v[196:199], v[208:211], v[104:107]
  v_mfma_f32_16x16x32_bf16 v[32:35], v[204:207], v[204:207], v[32:35]
  s_waitcnt lgkmcnt(6)
  v_mfma_f32_16x16x32_bf16 v[108:111], v[200:203], v[204:207], v[108:111]
  ds_read_b64_tr_b16 v[192:193], v6 offset:256
  ds_read_b64_tr_b16 v[194:195], v6 offset:1792
  v_mfma_f32_16x16x32_bf16 v[112:115], v[200:203], v[208:211], v[112:115]
  v_mfma_f32_16x16x32_bf16 v[36:39], v[208:211], v[208:211], v[36:39]
  s_waitcnt lgkmcnt(6)
  v_mfma_f32_16x16x32_bf16 v[116:119], v[180:183], v[204:207], v[116:119]
  ds_read_b64_tr_b16 v[196:197], v7 offset:256
  ds_read_b64_tr_b16 v[198:199], v7 offset:1792
  v_mfma_f32_16x16x32_bf16 v[120:123], v[180:183], v[208:211], v[120:123]
  s_waitcnt lgkmcnt(6)
  v_mfma_f32_16x16x32_bf16 v[124:127], v[184:187], v[204:207], v[124:127]
  ds_read_b64_tr_b16 v[200:201], v8 offset:256
  ds_read_b64_tr_b16 v[202:203], v8 offset:1792
  v_mfma_f32_16x16x32_bf16 v[128:131], v[184:187], v[208:211], v[128:131]
  s_waitcnt lgkmcnt(6)
  v_mfma_f32_16x16x32_bf16 v[132:135], v[188:191], v[204:207], v[132:135]
  ds_read_b128 v[212:215], v12 offset:24576
  ds_read_b128 v[216:219], v12 offset:26624
  ds_read_b64_tr_b16 v[180:181], v5 offset:12288
  ds_read_b64_tr_b16 v[182:183], v5 offset:13824
  v_mfma_f32_16x16x32_bf16 v[136:139], v[188:191], v[208:211], v[136:139]
  s_waitcnt lgkmcnt(8)
  v_mfma_f32_16x16x32_bf16 v[140:143], v[192:195], v[204:207], v[140:143]
  ds_read_b64_tr_b16 v[184:185], v6 offset:12288
  ds_read_b64_tr_b16 v[186:187], v6 offset:13824
  v_mfma_f32_16x16x32_bf16 v[144:147], v[192:195], v[208:211], v[144:147]
  s_waitcnt lgkmcnt(8)
  v_mfma_f32_16x16x32_bf16 v[148:151], v[196:199], v[204:207], v[148:151]
  ds_read_b64_tr_b16 v[188:189], v7 offset:12288
  ds_read_b64_tr_b16 v[190:191], v7 offset:13824
  v_mfma_f32_16x16x32_bf16 v[152:155], v[196:199], v[208:211], v[152:155]
  s_waitcnt lgkmcnt(8)
  v_mfma_f32_16x16x32_bf16 v[156:159], v[200:203], v[204:207], v[156:159]
  ds_read_b64_tr_b16 v[192:193], v8 offset:12288
  ds_read_b64_tr_b16 v[194:195], v8 offset:13824
  v_mfma_f32_16x16x32_bf16 v[160:163], v[200:203], v[208:211], v[160:163]
  s_waitcnt lgkmcnt(6)
  v_mfma_f32_16x16x32_bf16 v[68:71], v[180:183], v[212:215], v[68:71]
  ds_read_b64_tr_b16 v[196:197], v5 offset:12416
  ds_read_b64_tr_b16 v[198:199], v5 offset:13952
  v_mfma_f32_16x16x32_bf16 v[72:75], v[180:183], v[216:219], v[72:75]
  s_waitcnt lgkmcnt(6)
  v_mfma_f32_16x16x32_bf16 v[76:79], v[184:187], v[212:215], v[76:79]
  ds_read_b64_tr_b16 v[200:201], v6 offset:12416
  ds_read_b64_tr_b16 v[202:203], v6 offset:13952
  v_mfma_f32_16x16x32_bf16 v[80:83], v[184:187], v[216:219], v[80:83]
  s_waitcnt lgkmcnt(6)
  v_mfma_f32_16x16x32_bf16 v[84:87], v[188:191], v[212:215], v[84:87]
  ds_read_b64_tr_b16 v[180:181], v7 offset:12416
  ds_read_b64_tr_b16 v[182:183], v7 offset:13952
  v_mfma_f32_16x16x32_bf16 v[88:91], v[188:191], v[216:219], v[88:91]
  v_mfma_f32_16x16x32_bf16 v[24:27], v[40:43], v[212:215], v[24:27]
  s_waitcnt lgkmcnt(6)
  v_mfma_f32_16x16x32_bf16 v[92:95], v[192:195], v[212:215], v[92:95]
  ds_read_b64_tr_b16 v[184:185], v8 offset:12416
  ds_read_b64_tr_b16 v[186:187], v8 offset:13952
  v_mfma_f32_16x16x32_bf16 v[96:99], v[192:195], v[216:219], v[96:99]
  v_mfma_f32_16x16x32_bf16 v[28:31], v[40:43], v[216:219], v[28:31]
  s_waitcnt lgkmcnt(6)
  v_mfma_f32_16x16x32_bf16 v[100:103], v[196:199], v[212:215], v[100:103]
  ds_read_b64_tr_b16 v[188:189], v5 offset:12544
  ds_read_b64_tr_b16 v[190:191], v5 offset:14080
  v_mfma_f32_16x16x32_bf16 v[104:107], v[196:199], v[216:219], v[104:107]
  v_mfma_f32_16x16x32_bf16 v[32:35], v[212:215], v[212:215], v[32:35]
  s_waitcnt lgkmcnt(6)
  v_mfma_f32_16x16x32_bf16 v[108:111], v[200:203], v[212:215], v[108:111]
  ds_read_b64_tr_b16 v[192:193], v6 offset:12544
  ds_read_b64_tr_b16 v[194:195], v6 offset:14080
  v_mfma_f32_16x16x32_bf16 v[112:115], v[200:203], v[216:219], v[112:115]
  v_mfma_f32_16x16x32_bf16 v[36:39], v[216:219], v[216:219], v[36:39]
  s_waitcnt lgkmcnt(6)
  v_mfma_f32_16x16x32_bf16 v[116:119], v[180:183], v[212:215], v[116:119]
  ds_read_b64_tr_b16 v[196:197], v7 offset:12544
  ds_read_b64_tr_b16 v[198:199], v7 offset:14080
  v_mfma_f32_16x16x32_bf16 v[120:123], v[180:183], v[216:219], v[120:123]
  ds_read_b64_tr_b16 v[200:201], v8 offset:12544
  ds_read_b64_tr_b16 v[202:203], v8 offset:14080
  s_waitcnt lgkmcnt(8)
  v_mfma_f32_16x16x32_bf16 v[124:127], v[184:187], v[212:215], v[124:127]
  v_mfma_f32_16x16x32_bf16 v[128:131], v[184:187], v[216:219], v[128:131]
  s_waitcnt lgkmcnt(0)
  v_mfma_f32_16x16x32_bf16 v[132:135], v[188:191], v[212:215], v[132:135]
  s_add_u32 s44, s44, 40960
  s_cmp_ge_u32 s44, 122880
  s_cselect_b32 s44, 0, s44
  s_barrier
  v_add_u32 v5, s44, v1
  v_add_u32 v6, s44, v2
  v_add_u32 v7, s44, v3
  v_add_u32 v8, s44, v4
  v_add_u32 v11, s44, v9
  v_add_u32 v12, s44, v10
  ds_read_b128 v[204:207], v11 offset:24576
  ds_read_b128 v[208:211], v11 offset:26624
  ds_read_b64_tr_b16 v[180:181], v5 offset:0
  ds_read_b64_tr_b16 v[182:183], v5 offset:1536
  v_mfma_f32_16x16x32_bf16 v[136:139], v[188:191], v[216:219], v[136:139]
  v_mfma_f32_16x16x32_bf16 v[140:143], v[192:195], v[212:215], v[140:143]
  ds_read_b64_tr_b16 v[184:185], v6 offset:0
  ds_read_b64_tr_b16 v[186:187], v6 offset:1536
  v_mfma_f32_16x16x32_bf16 v[144:147], v[192:195], v[216:219], v[144:147]
  v_mfma_f32_16x16x32_bf16 v[148:151], v[196:199], v[212:215], v[148:151]
  ds_read_b64_tr_b16 v[188:189], v7 offset:0
  ds_read_b64_tr_b16 v[190:191], v7 offset:1536
  v_mfma_f32_16x16x32_bf16 v[152:155], v[196:199], v[216:219], v[152:155]
  v_mfma_f32_16x16x32_bf16 v[156:159], v[200:203], v[212:215], v[156:159]
  ds_read_b64_tr_b16 v[192:193], v8 offset:0
  ds_read_b64_tr_b16 v[194:195], v8 offset:1536
  v_mfma_f32_16x16x32_bf16 v[160:163], v[200:203], v[216:219], v[160:163]
  s_sub_u32 s45, s45, 1
  s_cmp_lg_u32 s45, 0
  s_cbranch_scc1 k0_loop_qk
  s_waitcnt lgkmcnt(6)
  v_mfma_f32_16x16x32_bf16 v[68:71], v[180:183], v[204:207], v[68:71]
  ds_read_b64_tr_b16 v[196:197], v5 offset:128
  ds_read_b64_tr_b16 v[198:199], v5 offset:1664
  v_mfma_f32_16x16x32_bf16 v[72:75], v[180:183], v[208:211], v[72:75]
  s_waitcnt lgkmcnt(6)
  v_mfma_f32_16x16x32_bf16 v[76:79], v[184:187], v[204:207], v[76:79]
  ds_read_b64_tr_b16 v[200:201], v6 offset:128
  ds_read_b64_tr_b16 v[202:203], v6 offset:1664
  v_mfma_f32_16x16x32_bf16 v[80:83], v[184:187], v[208:211], v[80:83]
  s_waitcnt lgkmcnt(6)
  v_mfma_f32_16x16x32_bf16 v[84:87], v[188:191], v[204:207], v[84:87]
  ds_read_b64_tr_b16 v[180:181], v7 offset:128
  ds_read_b64_tr_b16 v[182:183], v7 offset:1664
  v_mfma_f32_16x16x32_bf16 v[88:91], v[188:191], v[208:211], v[88:91]
  v_mfma_f32_16x16x32_bf16 v[24:27], v[40:43], v[204:207], v[24:27]
  s_waitcnt lgkmcnt(6)
  v_mfma_f32_16x16x32_bf16 v[92:95], v[192:195], v[204:207], v[92:95]
  ds_read_b64_tr_b16 v[184:185], v8 offset:128
  ds_read_b64_tr_b16 v[186:187], v8 offset:1664
  v_mfma_f32_16x16x32_bf16 v[96:99], v[192:195], v[208:211], v[96:99]
  v_mfma_f32_16x16x32_bf16 v[28:31], v[40:43], v[208:211], v[28:31]
  s_waitcnt lgkmcnt(6)
  v_mfma_f32_16x16x32_bf16 v[100:103], v[196:199], v[204:207], v[100:103]
  ds_read_b64_tr_b16 v[188:189], v5 offset:256
  ds_read_b64_tr_b16 v[190:191], v5 offset:1792
  v_mfma_f32_16x16x32_bf16 v[104:107], v[196:199], v[208:211], v[104:107]
  v_mfma_f32_16x16x32_bf16 v[32:35], v[204:207], v[204:207], v[32:35]
  s_waitcnt lgkmcnt(6)
  v_mfma_f32_16x16x32_bf16 v[108:111], v[200:203], v[204:207], v[108:111]
  ds_read_b64_tr_b16 v[192:193], v6 offset:256
  ds_read_b64_tr_b16 v[194:195], v6 offset:1792
  v_mfma_f32_16x16x32_bf16 v[112:115], v[200:203], v[208:211], v[112:115]
  v_mfma_f32_16x16x32_bf16 v[36:39], v[208:211], v[208:211], v[36:39]
  s_waitcnt lgkmcnt(6)
  v_mfma_f32_16x16x32_bf16 v[116:119], v[180:183], v[204:207], v[116:119]
  ds_read_b64_tr_b16 v[196:197], v7 offset:256
  ds_read_b64_tr_b16 v[198:199], v7 offset:1792
  v_mfma_f32_16x16x32_bf16 v[120:123], v[180:183], v[208:211], v[120:123]
  s_waitcnt lgkmcnt(6)
  v_mfma_f32_16x16x32_bf16 v[124:127], v[184:187], v[204:207], v[124:127]
  ds_read_b64_tr_b16 v[200:201], v8 offset:256
  ds_read_b64_tr_b16 v[202:203], v8 offset:1792
  v_mfma_f32_16x16x32_bf16 v[128:131], v[184:187], v[208:211], v[128:131]
  s_waitcnt lgkmcnt(6)
  v_mfma_f32_16x16x32_bf16 v[132:135], v[188:191], v[204:207], v[132:135]
  ds_read_b128 v[212:215], v12 offset:24576
  ds_read_b128 v[216:219], v12 offset:26624
  ds_read_b64_tr_b16 v[180:181], v5 offset:12288
  ds_read_b64_tr_b16 v[182:183], v5 offset:13824
  v_mfma_f32_16x16x32_bf16 v[136:139], v[188:191], v[208:211], v[136:139]
  s_waitcnt lgkmcnt(8)
  v_mfma_f32_16x16x32_bf16 v[140:143], v[192:195], v[204:207], v[140:143]
  ds_read_b64_tr_b16 v[184:185], v6 offset:12288
  ds_read_b64_tr_b16 v[186:187], v6 offset:13824
  v_mfma_f32_16x16x32_bf16 v[144:147], v[192:195], v[208:211], v[144:147]
  s_waitcnt lgkmcnt(8)
  v_mfma_f32_16x16x32_bf16 v[148:151], v[196:199], v[204:207], v[148:151]
  ds_read_b64_tr_b16 v[188:189], v7 offset:12288
  ds_read_b64_tr_b16 v[190:191], v7 offset:13824
  v_mfma_f32_16x16x32_bf16 v[152:155], v[196:199], v[208:211], v[152:155]
  s_waitcnt lgkmcnt(8)
  v_mfma_f32_16x16x32_bf16 v[156:159], v[200:203], v[204:207], v[156:159]
  ds_read_b64_tr_b16 v[192:193], v8 offset:12288
  ds_read_b64_tr_b16 v[194:195], v8 offset:13824
  v_mfma_f32_16x16x32_bf16 v[160:163], v[200:203], v[208:211], v[160:163]
  s_waitcnt lgkmcnt(6)
  v_mfma_f32_16x16x32_bf16 v[68:71], v[180:183], v[212:215], v[68:71]
  ds_read_b64_tr_b16 v[196:197], v5 offset:12416
  ds_read_b64_tr_b16 v[198:199], v5 offset:13952
  v_mfma_f32_16x16x32_bf16 v[72:75], v[180:183], v[216:219], v[72:75]
  s_waitcnt lgkmcnt(6)
  v_mfma_f32_16x16x32_bf16 v[76:79], v[184:187], v[212:215], v[76:79]
  ds_read_b64_tr_b16 v[200:201], v6 offset:12416
  ds_read_b64_tr_b16 v[202:203], v6 offset:13952
  v_mfma_f32_16x16x32_bf16 v[80:83], v[184:187], v[216:219], v[80:83]
  s_waitcnt lgkmcnt(6)
  v_mfma_f32_16x16x32_bf16 v[84:87], v[188:191], v[212:215], v[84:87]
  ds_read_b64_tr_b16 v[180:181], v7 offset:12416
  ds_read_b64_tr_b16 v[182:183], v7 offset:13952
  v_mfma_f32_16x16x32_bf16 v[88:91], v[188:191], v[216:219], v[88:91]
  v_mfma_f32_16x16x32_bf16 v[24:27], v[40:43], v[212:215], v[24:27]
  s_waitcnt lgkmcnt(6)
  v_mfma_f32_16x16x32_bf16 v[92:95], v[192:195], v[212:215], v[92:95]
  ds_read_b64_tr_b16 v[184:185], v8 offset:12416
  ds_read_b64_tr_b16 v[186:187], v8 offset:13952
  v_mfma_f32_16x16x32_bf16 v[96:99], v[192:195], v[216:219], v[96:99]
  v_mfma_f32_16x16x32_bf16 v[28:31], v[40:43], v[216:219], v[28:31]
  s_waitcnt lgkmcnt(6)
  v_mfma_f32_16x16x32_bf16 v[100:103], v[196:199], v[212:215], v[100:103]
  ds_read_b64_tr_b16 v[188:189], v5 offset:12544
  ds_read_b64_tr_b16 v[190:191], v5 offset:14080
  v_mfma_f32_16x16x32_bf16 v[104:107], v[196:199], v[216:219], v[104:107]
  v_mfma_f32_16x16x32_bf16 v[32:35], v[212:215], v[212:215], v[32:35]
  s_waitcnt lgkmcnt(6)
  v_mfma_f32_16x16x32_bf16 v[108:111], v[200:203], v[212:215], v[108:111]
  ds_read_b64_tr_b16 v[192:193], v6 offset:12544
  ds_read_b64_tr_b16 v[194:195], v6 offset:14080
  v_mfma_f32_16x16x32_bf16 v[112:115], v[200:203], v[216:219], v[112:115]
  v_mfma_f32_16x16x32_bf16 v[36:39], v[216:219], v[216:219], v[36:39]
  s_waitcnt lgkmcnt(6)
  v_mfma_f32_16x16x32_bf16 v[116:119], v[180:183], v[212:215], v[116:119]
  ds_read_b64_tr_b16 v[196:197], v7 offset:12544
  ds_read_b64_tr_b16 v[198:199], v7 offset:14080
  v_mfma_f32_16x16x32_bf16 v[120:123], v[180:183], v[216:219], v[120:123]
  ds_read_b64_tr_b16 v[200:201], v8 offset:12544
  ds_read_b64_tr_b16 v[202:203], v8 offset:14080
  s_waitcnt lgkmcnt(8)
  v_mfma_f32_16x16x32_bf16 v[124:127], v[184:187], v[212:215], v[124:127]
  v_mfma_f32_16x16x32_bf16 v[128:131], v[184:187], v[216:219], v[128:131]
  s_waitcnt lgkmcnt(0)
  v_mfma_f32_16x16x32_bf16 v[132:135], v[188:191], v[212:215], v[132:135]
  v_mfma_f32_16x16x32_bf16 v[136:139], v[188:191], v[216:219], v[136:139]
  v_mfma_f32_16x16x32_bf16 v[140:143], v[192:195], v[212:215], v[140:143]
  v_mfma_f32_16x16x32_bf16 v[144:147], v[192:195], v[216:219], v[144:147]
  v_mfma_f32_16x16x32_bf16 v[148:151], v[196:199], v[212:215], v[148:151]
  v_mfma_f32_16x16x32_bf16 v[152:155], v[196:199], v[216:219], v[152:155]
  v_mfma_f32_16x16x32_bf16 v[156:159], v[200:203], v[212:215], v[156:159]
  v_mfma_f32_16x16x32_bf16 v[160:163], v[200:203], v[216:219], v[160:163]
  v_and_b32 v16, 3, v0
  v_lshrrev_b32 v17, 2, v13
  v_lshl_add_u32 v17, v17, 4, v13
  v_lshlrev_b32 v17, 2, v17
  v_cmp_eq_u32 s[52:53], 1, v16
  v_cmp_eq_u32 s[54:55], 2, v16
  v_cmp_eq_u32 s[56:57], 3, v16
  v_cndmask_b32 v32, v32, v33, s[52:53]
  v_cndmask_b32 v32, v32, v34, s[54:55]
  v_cndmask_b32 v32, v32, v35, s[56:57]
  ds_bpermute_b32 v22, v17, v32
  v_mov_b32 v20, v24
  v_cndmask_b32 v36, v36, v37, s[52:53]
  v_cndmask_b32 v36, v36, v38, s[54:55]
  v_cndmask_b32 v36, v36, v39, s[56:57]
  ds_bpermute_b32 v23, v17, v36
  v_mov_b32 v21, v28
  s_waitcnt lgkmcnt(0)
  v_mul_f32 v20, 0x3ae38e39, v20
  v_mul_f32 v22, 0x3ae38e39, v22
  v_fma_f32 v22, -v20, v20, v22
  v_max_f32 v22, 0, v22
  v_cvt_pk_bf16_f32 v20, v20, v20
  v_lshlrev_b32 v20, 16, v20
  v_cvt_pk_bf16_f32 v22, v22, v22
  v_lshlrev_b32 v22, 16, v22
  v_add_f32 v22, 0x3727c5ac, v22
  v_cvt_pk_bf16_f32 v22, v22, v22
  v_lshlrev_b32 v22, 16, v22
  v_sqrt_f32 v22, v22
  s_nop 0
  v_cvt_pk_bf16_f32 v22, v22, v22
  v_lshlrev_b32 v22, 16, v22
  v_rcp_f32 v22, v22
  v_mul_f32 v21, 0x3ae38e39, v21
  v_mul_f32 v23, 0x3ae38e39, v23
  v_fma_f32 v23, -v21, v21, v23
  v_max_f32 v23, 0, v23
  v_cvt_pk_bf16_f32 v21, v21, v21
  v_lshlrev_b32 v21, 16, v21
  v_cvt_pk_bf16_f32 v23, v23, v23
  v_lshlrev_b32 v23, 16, v23
  v_add_f32 v23, 0x3727c5ac, v23
  v_cvt_pk_bf16_f32 v23, v23, v23
  v_lshlrev_b32 v23, 16, v23
  v_sqrt_f32 v23, v23
  s_nop 0
  v_cvt_pk_bf16_f32 v23, v23, v23
  v_lshlrev_b32 v23, 16, v23
  v_rcp_f32 v23, v23
  s_barrier
  v_lshlrev_b32 v16, 4, v14
  v_add_u32 v16, 0, v16
  ds_read_b128 v[164:167], v16 offset:0
  ds_read_b128 v[168:171], v16 offset:64
  ds_read_b128 v[172:175], v16 offset:128
  ds_read_b128 v[176:179], v16 offset:192
  ds_read_b128 v[180:183], v16 offset:256
  ds_read_b128 v[184:187], v16 offset:320
  ds_read_b128 v[188:191], v16 offset:384
  ds_read_b128 v[192:195], v16 offset:448
  ds_read_b128 v[196:199], v16 offset:512
  ds_read_b128 v[200:203], v16 offset:576
  ds_read_b128 v[204:207], v16 offset:640
  ds_read_b128 v[208:211], v16 offset:704
  v_sub_f32 v212, 0, v20
  v_mov_b32 v214, v22
  v_sub_f32 v216, 0, v21
  v_mov_b32 v218, v23
  s_waitcnt lgkmcnt(11)
  v_pk_fma_f32 v[68:69], v[164:165], v[212:213], v[68:69] op_sel_hi:[1,0,1]
  v_pk_fma_f32 v[70:71], v[166:167], v[212:213], v[70:71] op_sel_hi:[1,0,1]
  v_pk_mul_f32 v[68:69], v[68:69], v[214:215] op_sel_hi:[1,0]
  v_pk_mul_f32 v[70:71], v[70:71], v[214:215] op_sel_hi:[1,0]
  v_cvt_pk_bf16_f32 v68, v68, v69
  v_cvt_pk_bf16_f32 v69, v70, v71
  buffer_store_dwordx2 v[68:69], v44, s[16:19], s36 offen
  v_pk_fma_f32 v[72:73], v[164:165], v[216:217], v[72:73] op_sel_hi:[1,0,1]
  v_pk_fma_f32 v[74:75], v[166:167], v[216:217], v[74:75] op_sel_hi:[1,0,1]
  v_pk_mul_f32 v[72:73], v[72:73], v[218:219] op_sel_hi:[1,0]
  v_pk_mul_f32 v[74:75], v[74:75], v[218:219] op_sel_hi:[1,0]
  v_cvt_pk_bf16_f32 v72, v72, v73
  v_cvt_pk_bf16_f32 v73, v74, v75
  buffer_store_dwordx2 v[72:73], v56, s[16:19], s36 offen
  s_waitcnt lgkmcnt(10)
  v_pk_fma_f32 v[76:77], v[168:169], v[212:213], v[76:77] op_sel_hi:[1,0,1]
  v_pk_fma_f32 v[78:79], v[170:171], v[212:213], v[78:79] op_sel_hi:[1,0,1]
  v_pk_mul_f32 v[76:77], v[76:77], v[214:215] op_sel_hi:[1,0]
  v_pk_mul_f32 v[78:79], v[78:79], v[214:215] op_sel_hi:[1,0]
  v_cvt_pk_bf16_f32 v76, v76, v77
  v_cvt_pk_bf16_f32 v77, v78, v79
  buffer_store_dwordx2 v[76:77], v45, s[16:19], s36 offen
  v_pk_fma_f32 v[80:81], v[168:169], v[216:217], v[80:81] op_sel_hi:[1,0,1]
  v_pk_fma_f32 v[82:83], v[170:171], v[216:217], v[82:83] op_sel_hi:[1,0,1]
  v_pk_mul_f32 v[80:81], v[80:81], v[218:219] op_sel_hi:[1,0]
  v_pk_mul_f32 v[82:83], v[82:83], v[218:219] op_sel_hi:[1,0]
  v_cvt_pk_bf16_f32 v80, v80, v81
  v_cvt_pk_bf16_f32 v81, v82, v83
  buffer_store_dwordx2 v[80:81], v57, s[16:19], s36 offen
  s_waitcnt lgkmcnt(9)
  v_pk_fma_f32 v[84:85], v[172:173], v[212:213], v[84:85] op_sel_hi:[1,0,1]
  v_pk_fma_f32 v[86:87], v[174:175], v[212:213], v[86:87] op_sel_hi:[1,0,1]
  v_pk_mul_f32 v[84:85], v[84:85], v[214:215] op_sel_hi:[1,0]
  v_pk_mul_f32 v[86:87], v[86:87], v[214:215] op_sel_hi:[1,0]
  v_cvt_pk_bf16_f32 v84, v84, v85
  v_cvt_pk_bf16_f32 v85, v86, v87
  buffer_store_dwordx2 v[84:85], v46, s[16:19], s36 offen
  v_pk_fma_f32 v[88:89], v[172:173], v[216:217], v[88:89] op_sel_hi:[1,0,1]
  v_pk_fma_f32 v[90:91], v[174:175], v[216:217], v[90:91] op_sel_hi:[1,0,1]
  v_pk_mul_f32 v[88:89], v[88:89], v[218:219] op_sel_hi:[1,0]
  v_pk_mul_f32 v[90:91], v[90:91], v[218:219] op_sel_hi:[1,0]
  v_cvt_pk_bf16_f32 v88, v88, v89
  v_cvt_pk_bf16_f32 v89, v90, v91
  buffer_store_dwordx2 v[88:89], v58, s[16:19], s36 offen
  s_waitcnt lgkmcnt(8)
  v_pk_fma_f32 v[92:93], v[176:177], v[212:213], v[92:93] op_sel_hi:[1,0,1]
  v_pk_fma_f32 v[94:95], v[178:179], v[212:213], v[94:95] op_sel_hi:[1,0,1]
  v_pk_mul_f32 v[92:93], v[92:93], v[214:215] op_sel_hi:[1,0]
  v_pk_mul_f32 v[94:95], v[94:95], v[214:215] op_sel_hi:[1,0]
  v_cvt_pk_bf16_f32 v92, v92, v93
  v_cvt_pk_bf16_f32 v93, v94, v95
  buffer_store_dwordx2 v[92:93], v47, s[16:19], s36 offen
  v_pk_fma_f32 v[96:97], v[176:177], v[216:217], v[96:97] op_sel_hi:[1,0,1]
  v_pk_fma_f32 v[98:99], v[178:179], v[216:217], v[98:99] op_sel_hi:[1,0,1]
  v_pk_mul_f32 v[96:97], v[96:97], v[218:219] op_sel_hi:[1,0]
  v_pk_mul_f32 v[98:99], v[98:99], v[218:219] op_sel_hi:[1,0]
  v_cvt_pk_bf16_f32 v96, v96, v97
  v_cvt_pk_bf16_f32 v97, v98, v99
  buffer_store_dwordx2 v[96:97], v59, s[16:19], s36 offen
  s_waitcnt lgkmcnt(7)
  v_pk_fma_f32 v[100:101], v[180:181], v[212:213], v[100:101] op_sel_hi:[1,0,1]
  v_pk_fma_f32 v[102:103], v[182:183], v[212:213], v[102:103] op_sel_hi:[1,0,1]
  v_pk_mul_f32 v[100:101], v[100:101], v[214:215] op_sel_hi:[1,0]
  v_pk_mul_f32 v[102:103], v[102:103], v[214:215] op_sel_hi:[1,0]
  v_cvt_pk_bf16_f32 v100, v100, v101
  v_cvt_pk_bf16_f32 v101, v102, v103
  buffer_store_dwordx2 v[100:101], v48, s[16:19], s36 offen
  v_pk_fma_f32 v[104:105], v[180:181], v[216:217], v[104:105] op_sel_hi:[1,0,1]
  v_pk_fma_f32 v[106:107], v[182:183], v[216:217], v[106:107] op_sel_hi:[1,0,1]
  v_pk_mul_f32 v[104:105], v[104:105], v[218:219] op_sel_hi:[1,0]
  v_pk_mul_f32 v[106:107], v[106:107], v[218:219] op_sel_hi:[1,0]
  v_cvt_pk_bf16_f32 v104, v104, v105
  v_cvt_pk_bf16_f32 v105, v106, v107
  buffer_store_dwordx2 v[104:105], v60, s[16:19], s36 offen
  s_waitcnt lgkmcnt(6)
  v_pk_fma_f32 v[108:109], v[184:185], v[212:213], v[108:109] op_sel_hi:[1,0,1]
  v_pk_fma_f32 v[110:111], v[186:187], v[212:213], v[110:111] op_sel_hi:[1,0,1]
  v_pk_mul_f32 v[108:109], v[108:109], v[214:215] op_sel_hi:[1,0]
  v_pk_mul_f32 v[110:111], v[110:111], v[214:215] op_sel_hi:[1,0]
  v_cvt_pk_bf16_f32 v108, v108, v109
  v_cvt_pk_bf16_f32 v109, v110, v111
  buffer_store_dwordx2 v[108:109], v49, s[16:19], s36 offen
  v_pk_fma_f32 v[112:113], v[184:185], v[216:217], v[112:113] op_sel_hi:[1,0,1]
  v_pk_fma_f32 v[114:115], v[186:187], v[216:217], v[114:115] op_sel_hi:[1,0,1]
  v_pk_mul_f32 v[112:113], v[112:113], v[218:219] op_sel_hi:[1,0]
  v_pk_mul_f32 v[114:115], v[114:115], v[218:219] op_sel_hi:[1,0]
  v_cvt_pk_bf16_f32 v112, v112, v113
  v_cvt_pk_bf16_f32 v113, v114, v115
  buffer_store_dwordx2 v[112:113], v61, s[16:19], s36 offen
  s_waitcnt lgkmcnt(5)
  v_pk_fma_f32 v[116:117], v[188:189], v[212:213], v[116:117] op_sel_hi:[1,0,1]
  v_pk_fma_f32 v[118:119], v[190:191], v[212:213], v[118:119] op_sel_hi:[1,0,1]
  v_pk_mul_f32 v[116:117], v[116:117], v[214:215] op_sel_hi:[1,0]
  v_pk_mul_f32 v[118:119], v[118:119], v[214:215] op_sel_hi:[1,0]
  v_cvt_pk_bf16_f32 v116, v116, v117
  v_cvt_pk_bf16_f32 v117, v118, v119
  buffer_store_dwordx2 v[116:117], v50, s[16:19], s36 offen
  v_pk_fma_f32 v[120:121], v[188:189], v[216:217], v[120:121] op_sel_hi:[1,0,1]
  v_pk_fma_f32 v[122:123], v[190:191], v[216:217], v[122:123] op_sel_hi:[1,0,1]
  v_pk_mul_f32 v[120:121], v[120:121], v[218:219] op_sel_hi:[1,0]
  v_pk_mul_f32 v[122:123], v[122:123], v[218:219] op_sel_hi:[1,0]
  v_cvt_pk_bf16_f32 v120, v120, v121
  v_cvt_pk_bf16_f32 v121, v122, v123
  buffer_store_dwordx2 v[120:121], v62, s[16:19], s36 offen
  s_waitcnt lgkmcnt(4)
  v_pk_fma_f32 v[124:125], v[192:193], v[212:213], v[124:125] op_sel_hi:[1,0,1]
  v_pk_fma_f32 v[126:127], v[194:195], v[212:213], v[126:127] op_sel_hi:[1,0,1]
  v_pk_mul_f32 v[124:125], v[124:125], v[214:215] op_sel_hi:[1,0]
  v_pk_mul_f32 v[126:127], v[126:127], v[214:215] op_sel_hi:[1,0]
  v_cvt_pk_bf16_f32 v124, v124, v125
  v_cvt_pk_bf16_f32 v125, v126, v127
  buffer_store_dwordx2 v[124:125], v51, s[16:19], s36 offen
  v_pk_fma_f32 v[128:129], v[192:193], v[216:217], v[128:129] op_sel_hi:[1,0,1]
  v_pk_fma_f32 v[130:131], v[194:195], v[216:217], v[130:131] op_sel_hi:[1,0,1]
  v_pk_mul_f32 v[128:129], v[128:129], v[218:219] op_sel_hi:[1,0]
  v_pk_mul_f32 v[130:131], v[130:131], v[218:219] op_sel_hi:[1,0]
  v_cvt_pk_bf16_f32 v128, v128, v129
  v_cvt_pk_bf16_f32 v129, v130, v131
  buffer_store_dwordx2 v[128:129], v63, s[16:19], s36 offen
  s_waitcnt lgkmcnt(3)
  v_pk_fma_f32 v[132:133], v[196:197], v[212:213], v[132:133] op_sel_hi:[1,0,1]
  v_pk_fma_f32 v[134:135], v[198:199], v[212:213], v[134:135] op_sel_hi:[1,0,1]
  v_pk_mul_f32 v[132:133], v[132:133], v[214:215] op_sel_hi:[1,0]
  v_pk_mul_f32 v[134:135], v[134:135], v[214:215] op_sel_hi:[1,0]
  v_cvt_pk_bf16_f32 v132, v132, v133
  v_cvt_pk_bf16_f32 v133, v134, v135
  buffer_store_dwordx2 v[132:133], v52, s[16:19], s36 offen
  v_pk_fma_f32 v[136:137], v[196:197], v[216:217], v[136:137] op_sel_hi:[1,0,1]
  v_pk_fma_f32 v[138:139], v[198:199], v[216:217], v[138:139] op_sel_hi:[1,0,1]
  v_pk_mul_f32 v[136:137], v[136:137], v[218:219] op_sel_hi:[1,0]
  v_pk_mul_f32 v[138:139], v[138:139], v[218:219] op_sel_hi:[1,0]
  v_cvt_pk_bf16_f32 v136, v136, v137
  v_cvt_pk_bf16_f32 v137, v138, v139
  buffer_store_dwordx2 v[136:137], v64, s[16:19], s36 offen
  s_waitcnt lgkmcnt(2)
  v_pk_fma_f32 v[140:141], v[200:201], v[212:213], v[140:141] op_sel_hi:[1,0,1]
  v_pk_fma_f32 v[142:143], v[202:203], v[212:213], v[142:143] op_sel_hi:[1,0,1]
  v_pk_mul_f32 v[140:141], v[140:141], v[214:215] op_sel_hi:[1,0]
  v_pk_mul_f32 v[142:143], v[142:143], v[214:215] op_sel_hi:[1,0]
  v_cvt_pk_bf16_f32 v140, v140, v141
  v_cvt_pk_bf16_f32 v141, v142, v143
  buffer_store_dwordx2 v[140:141], v53, s[16:19], s36 offen
  v_pk_fma_f32 v[144:145], v[200:201], v[216:217], v[144:145] op_sel_hi:[1,0,1]
  v_pk_fma_f32 v[146:147], v[202:203], v[216:217], v[146:147] op_sel_hi:[1,0,1]
  v_pk_mul_f32 v[144:145], v[144:145], v[218:219] op_sel_hi:[1,0]
  v_pk_mul_f32 v[146:147], v[146:147], v[218:219] op_sel_hi:[1,0]
  v_cvt_pk_bf16_f32 v144, v144, v145
  v_cvt_pk_bf16_f32 v145, v146, v147
  buffer_store_dwordx2 v[144:145], v65, s[16:19], s36 offen
  s_waitcnt lgkmcnt(1)
  v_pk_fma_f32 v[148:149], v[204:205], v[212:213], v[148:149] op_sel_hi:[1,0,1]
  v_pk_fma_f32 v[150:151], v[206:207], v[212:213], v[150:151] op_sel_hi:[1,0,1]
  v_pk_mul_f32 v[148:149], v[148:149], v[214:215] op_sel_hi:[1,0]
  v_pk_mul_f32 v[150:151], v[150:151], v[214:215] op_sel_hi:[1,0]
  v_cvt_pk_bf16_f32 v148, v148, v149
  v_cvt_pk_bf16_f32 v149, v150, v151
  buffer_store_dwordx2 v[148:149], v54, s[16:19], s36 offen
  v_pk_fma_f32 v[152:153], v[204:205], v[216:217], v[152:153] op_sel_hi:[1,0,1]
  v_pk_fma_f32 v[154:155], v[206:207], v[216:217], v[154:155] op_sel_hi:[1,0,1]
  v_pk_mul_f32 v[152:153], v[152:153], v[218:219] op_sel_hi:[1,0]
  v_pk_mul_f32 v[154:155], v[154:155], v[218:219] op_sel_hi:[1,0]
  v_cvt_pk_bf16_f32 v152, v152, v153
  v_cvt_pk_bf16_f32 v153, v154, v155
  buffer_store_dwordx2 v[152:153], v66, s[16:19], s36 offen
  s_waitcnt lgkmcnt(0)
  v_pk_fma_f32 v[156:157], v[208:209], v[212:213], v[156:157] op_sel_hi:[1,0,1]
  v_pk_fma_f32 v[158:159], v[210:211], v[212:213], v[158:159] op_sel_hi:[1,0,1]
  v_pk_mul_f32 v[156:157], v[156:157], v[214:215] op_sel_hi:[1,0]
  v_pk_mul_f32 v[158:159], v[158:159], v[214:215] op_sel_hi:[1,0]
  v_cvt_pk_bf16_f32 v156, v156, v157
  v_cvt_pk_bf16_f32 v157, v158, v159
  buffer_store_dwordx2 v[156:157], v55, s[16:19], s36 offen
  v_pk_fma_f32 v[160:161], v[208:209], v[216:217], v[160:161] op_sel_hi:[1,0,1]
  v_pk_fma_f32 v[162:163], v[210:211], v[216:217], v[162:163] op_sel_hi:[1,0,1]
  v_pk_mul_f32 v[160:161], v[160:161], v[218:219] op_sel_hi:[1,0]
  v_pk_mul_f32 v[162:163], v[162:163], v[218:219] op_sel_hi:[1,0]
  v_cvt_pk_bf16_f32 v160, v160, v161
  v_cvt_pk_bf16_f32 v161, v162, v163
  buffer_store_dwordx2 v[160:161], v67, s[16:19], s36 offen
  s_endpgm
k0_cv:
  s_lshr_b32 s36, s32, 5
  s_mul_i32 s36, s36, 36928
  s_add_u32 s36, s36, 15597568
  s_mul_i32 s37, s35, 6144
  s_add_u32 s36, s36, s37
  v_lshlrev_b32 v44, 5, v13
  v_and_b32 v17, 1, v14
  v_lshl_add_u32 v44, v17, 4, v44
  v_lshrrev_b32 v17, 1, v14
  v_lshl_add_u32 v44, v17, 3, v44
  v_add_u32 v44, s36, v44
  v_mov_b32 v68, 0
  v_mov_b32 v69, 0
  v_mov_b32 v70, 0
  v_mov_b32 v71, 0
  v_mov_b32 v72, 0
  v_mov_b32 v73, 0
  v_mov_b32 v74, 0
  v_mov_b32 v75, 0
  v_mov_b32 v76, 0
  v_mov_b32 v77, 0
  v_mov_b32 v78, 0
  v_mov_b32 v79, 0
  v_mov_b32 v80, 0
  v_mov_b32 v81, 0
  v_mov_b32 v82, 0
  v_mov_b32 v83, 0
  v_mov_b32 v84, 0
  v_mov_b32 v85, 0
  v_mov_b32 v86, 0
  v_mov_b32 v87, 0
  v_mov_b32 v88, 0
  v_mov_b32 v89, 0
  v_mov_b32 v90, 0
  v_mov_b32 v91, 0
  v_mov_b32 v92, 0
  v_mov_b32 v93, 0
  v_mov_b32 v94, 0
  v_mov_b32 v95, 0
  v_mov_b32 v96, 0
  v_mov_b32 v97, 0
  v_mov_b32 v98, 0
  v_mov_b32 v99, 0
  v_mov_b32 v100, 0
  v_mov_b32 v101, 0
  v_mov_b32 v102, 0
  v_mov_b32 v103, 0
  v_mov_b32 v104, 0
  v_mov_b32 v105, 0
  v_mov_b32 v106, 0
  v_mov_b32 v107, 0
  v_mov_b32 v108, 0
  v_mov_b32 v109, 0
  v_mov_b32 v110, 0
  v_mov_b32 v111, 0
  v_mov_b32 v112, 0
  v_mov_b32 v113, 0
  v_mov_b32 v114, 0
  v_mov_b32 v115, 0
  v_mov_b32 v116, 0
  v_mov_b32 v117, 0
  v_mov_b32 v118, 0
  v_mov_b32 v119, 0
  v_mov_b32 v120, 0
  v_mov_b32 v121, 0
  v_mov_b32 v122, 0
  v_mov_b32 v123, 0
  v_mov_b32 v124, 0
  v_mov_b32 v125, 0
  v_mov_b32 v126, 0
  v_mov_b32 v127, 0
  v_mov_b32 v128, 0
  v_mov_b32 v129, 0
  v_mov_b32 v130, 0
  v_mov_b32 v131, 0
  v_mov_b32 v132, 0
  v_mov_b32 v133, 0
  v_mov_b32 v134, 0
  v_mov_b32 v135, 0
  v_mov_b32 v136, 0
  v_mov_b32 v137, 0
  v_mov_b32 v138, 0
  v_mov_b32 v139, 0
  v_mov_b32 v140, 0
  v_mov_b32 v141, 0
  v_mov_b32 v142, 0
  v_mov_b32 v143, 0
  v_mov_b32 v144, 0
  v_mov_b32 v145, 0
  v_mov_b32 v146, 0
  v_mov_b32 v147, 0
  v_mov_b32 v148, 0
  v_mov_b32 v149, 0
  v_mov_b32 v150, 0
  v_mov_b32 v151, 0
  v_mov_b32 v152, 0
  v_mov_b32 v153, 0
  v_mov_b32 v154, 0
  v_mov_b32 v155, 0
  v_mov_b32 v156, 0
  v_mov_b32 v157, 0
  v_mov_b32 v158, 0
  v_mov_b32 v159, 0
  v_mov_b32 v160, 0
  v_mov_b32 v161, 0
  v_mov_b32 v162, 0
  v_mov_b32 v163, 0
  s_barrier
  ds_read_b128 v[204:207], v11 offset:24576
  ds_read_b128 v[208:211], v11 offset:26624
  ds_read_b64_tr_b16 v[180:181], v5 offset:0
  ds_read_b64_tr_b16 v[182:183], v5 offset:1536
  ds_read_b64_tr_b16 v[184:185], v6 offset:0
  ds_read_b64_tr_b16 v[186:187], v6 offset:1536
  ds_read_b64_tr_b16 v[188:189], v7 offset:0
  ds_read_b64_tr_b16 v[190:191], v7 offset:1536
  ds_read_b64_tr_b16 v[192:193], v8 offset:0
  ds_read_b64_tr_b16 v[194:195], v8 offset:1536
  s_mov_b32 s45, 8
k0_loop_v:
  s_waitcnt lgkmcnt(6)
  v_mfma_f32_16x16x32_bf16 v[68:71], v[204:207], v[180:183], v[68:71]
  ds_read_b64_tr_b16 v[196:197], v5 offset:128
  ds_read_b64_tr_b16 v[198:199], v5 offset:1664
  v_mfma_f32_16x16x32_bf16 v[72:75], v[208:211], v[180:183], v[72:75]
  s_waitcnt lgkmcnt(6)
  v_mfma_f32_16x16x32_bf16 v[76:79], v[204:207], v[184:187], v[76:79]
  ds_read_b64_tr_b16 v[200:201], v6 offset:128
  ds_read_b64_tr_b16 v[202:203], v6 offset:1664
  v_mfma_f32_16x16x32_bf16 v[80:83], v[208:211], v[184:187], v[80:83]
  s_waitcnt lgkmcnt(6)
  v_mfma_f32_16x16x32_bf16 v[84:87], v[204:207], v[188:191], v[84:87]
  ds_read_b64_tr_b16 v[180:181], v7 offset:128
  ds_read_b64_tr_b16 v[182:183], v7 offset:1664
  v_mfma_f32_16x16x32_bf16 v[88:91], v[208:211], v[188:191], v[88:91]
  v_mfma_f32_16x16x32_bf16 v[24:27], v[40:43], v[204:207], v[24:27]
  s_waitcnt lgkmcnt(6)
  v_mfma_f32_16x16x32_bf16 v[92:95], v[204:207], v[192:195], v[92:95]
  ds_read_b64_tr_b16 v[184:185], v8 offset:128
  ds_read_b64_tr_b16 v[186:187], v8 offset:1664
  v_mfma_f32_16x16x32_bf16 v[96:99], v[208:211], v[192:195], v[96:99]
  v_mfma_f32_16x16x32_bf16 v[28:31], v[40:43], v[208:211], v[28:31]
  s_waitcnt lgkmcnt(6)
  v_mfma_f32_16x16x32_bf16 v[100:103], v[204:207], v[196:199], v[100:103]
  ds_read_b64_tr_b16 v[188:189], v5 offset:256
  ds_read_b64_tr_b16 v[190:191], v5 offset:1792
  v_mfma_f32_16x16x32_bf16 v[104:107], v[208:211], v[196:199], v[104:107]
  v_mfma_f32_16x16x32_bf16 v[32:35], v[204:207], v[204:207], v[32:35]
  s_waitcnt lgkmcnt(6)
  v_mfma_f32_16x16x32_bf16 v[108:111], v[204:207], v[200:203], v[108:111]
  ds_read_b64_tr_b16 v[192:193], v6 offset:256
  ds_read_b64_tr_b16 v[194:195], v6 offset:1792
  v_mfma_f32_16x16x32_bf16 v[112:115], v[208:211], v[200:203], v[112:115]
  v_mfma_f32_16x16x32_bf16 v[36:39], v[208:211], v[208:211], v[36:39]
  s_waitcnt lgkmcnt(6)
  v_mfma_f32_16x16x32_bf16 v[116:119], v[204:207], v[180:183], v[116:119]
  ds_read_b64_tr_b16 v[196:197], v7 offset:256
  ds_read_b64_tr_b16 v[198:199], v7 offset:1792
  v_mfma_f32_16x16x32_bf16 v[120:123], v[208:211], v[180:183], v[120:123]
  s_waitcnt lgkmcnt(6)
  v_mfma_f32_16x16x32_bf16 v[124:127], v[204:207], v[184:187], v[124:127]
  ds_read_b64_tr_b16 v[200:201], v8 offset:256
  ds_read_b64_tr_b16 v[202:203], v8 offset:1792
  v_mfma_f32_16x16x32_bf16 v[128:131], v[208:211], v[184:187], v[128:131]
  s_waitcnt lgkmcnt(6)
  v_mfma_f32_16x16x32_bf16 v[132:135], v[204:207], v[188:191], v[132:135]
  ds_read_b128 v[212:215], v12 offset:24576
  ds_read_b128 v[216:219], v12 offset:26624
  ds_read_b64_tr_b16 v[180:181], v5 offset:12288
  ds_read_b64_tr_b16 v[182:183], v5 offset:13824
  v_mfma_f32_16x16x32_bf16 v[136:139], v[208:211], v[188:191], v[136:139]
  s_waitcnt lgkmcnt(8)
  v_mfma_f32_16x16x32_bf16 v[140:143], v[204:207], v[192:195], v[140:143]
  ds_read_b64_tr_b16 v[184:185], v6 offset:12288
  ds_read_b64_tr_b16 v[186:187], v6 offset:13824
  v_mfma_f32_16x16x32_bf16 v[144:147], v[208:211], v[192:195], v[144:147]
  s_waitcnt lgkmcnt(8)
  v_mfma_f32_16x16x32_bf16 v[148:151], v[204:207], v[196:199], v[148:151]
  ds_read_b64_tr_b16 v[188:189], v7 offset:12288
  ds_read_b64_tr_b16 v[190:191], v7 offset:13824
  v_mfma_f32_16x16x32_bf16 v[152:155], v[208:211], v[196:199], v[152:155]
  s_waitcnt lgkmcnt(8)
  v_mfma_f32_16x16x32_bf16 v[156:159], v[204:207], v[200:203], v[156:159]
  ds_read_b64_tr_b16 v[192:193], v8 offset:12288
  ds_read_b64_tr_b16 v[194:195], v8 offset:13824
  v_mfma_f32_16x16x32_bf16 v[160:163], v[208:211], v[200:203], v[160:163]
  s_waitcnt lgkmcnt(6)
  v_mfma_f32_16x16x32_bf16 v[68:71], v[212:215], v[180:183], v[68:71]
  ds_read_b64_tr_b16 v[196:197], v5 offset:12416
  ds_read_b64_tr_b16 v[198:199], v5 offset:13952
  v_mfma_f32_16x16x32_bf16 v[72:75], v[216:219], v[180:183], v[72:75]
  s_waitcnt lgkmcnt(6)
  v_mfma_f32_16x16x32_bf16 v[76:79], v[212:215], v[184:187], v[76:79]
  ds_read_b64_tr_b16 v[200:201], v6 offset:12416
  ds_read_b64_tr_b16 v[202:203], v6 offset:13952
  v_mfma_f32_16x16x32_bf16 v[80:83], v[216:219], v[184:187], v[80:83]
  s_waitcnt lgkmcnt(6)
  v_mfma_f32_16x16x32_bf16 v[84:87], v[212:215], v[188:191], v[84:87]
  ds_read_b64_tr_b16 v[180:181], v7 offset:12416
  ds_read_b64_tr_b16 v[182:183], v7 offset:13952
  v_mfma_f32_16x16x32_bf16 v[88:91], v[216:219], v[188:191], v[88:91]
  v_mfma_f32_16x16x32_bf16 v[24:27], v[40:43], v[212:215], v[24:27]
  s_waitcnt lgkmcnt(6)
  v_mfma_f32_16x16x32_bf16 v[92:95], v[212:215], v[192:195], v[92:95]
  ds_read_b64_tr_b16 v[184:185], v8 offset:12416
  ds_read_b64_tr_b16 v[186:187], v8 offset:13952
  v_mfma_f32_16x16x32_bf16 v[96:99], v[216:219], v[192:195], v[96:99]
  v_mfma_f32_16x16x32_bf16 v[28:31], v[40:43], v[216:219], v[28:31]
  s_waitcnt lgkmcnt(6)
  v_mfma_f32_16x16x32_bf16 v[100:103], v[212:215], v[196:199], v[100:103]
  ds_read_b64_tr_b16 v[188:189], v5 offset:12544
  ds_read_b64_tr_b16 v[190:191], v5 offset:14080
  v_mfma_f32_16x16x32_bf16 v[104:107], v[216:219], v[196:199], v[104:107]
  v_mfma_f32_16x16x32_bf16 v[32:35], v[212:215], v[212:215], v[32:35]
  s_waitcnt lgkmcnt(6)
  v_mfma_f32_16x16x32_bf16 v[108:111], v[212:215], v[200:203], v[108:111]
  ds_read_b64_tr_b16 v[192:193], v6 offset:12544
  ds_read_b64_tr_b16 v[194:195], v6 offset:14080
  v_mfma_f32_16x16x32_bf16 v[112:115], v[216:219], v[200:203], v[112:115]
  v_mfma_f32_16x16x32_bf16 v[36:39], v[216:219], v[216:219], v[36:39]
  s_waitcnt lgkmcnt(6)
  v_mfma_f32_16x16x32_bf16 v[116:119], v[212:215], v[180:183], v[116:119]
  ds_read_b64_tr_b16 v[196:197], v7 offset:12544
  ds_read_b64_tr_b16 v[198:199], v7 offset:14080
  v_mfma_f32_16x16x32_bf16 v[120:123], v[216:219], v[180:183], v[120:123]
  ds_read_b64_tr_b16 v[200:201], v8 offset:12544
  ds_read_b64_tr_b16 v[202:203], v8 offset:14080
  s_waitcnt lgkmcnt(8)
  v_mfma_f32_16x16x32_bf16 v[124:127], v[212:215], v[184:187], v[124:127]
  v_mfma_f32_16x16x32_bf16 v[128:131], v[216:219], v[184:187], v[128:131]
  s_waitcnt lgkmcnt(0)
  v_mfma_f32_16x16x32_bf16 v[132:135], v[212:215], v[188:191], v[132:135]
  s_add_u32 s44, s44, 40960
  s_cmp_ge_u32 s44, 122880
  s_cselect_b32 s44, 0, s44
  s_barrier
  v_add_u32 v5, s44, v1
  v_add_u32 v6, s44, v2
  v_add_u32 v7, s44, v3
  v_add_u32 v8, s44, v4
  v_add_u32 v11, s44, v9
  v_add_u32 v12, s44, v10
  ds_read_b128 v[204:207], v11 offset:24576
  ds_read_b128 v[208:211], v11 offset:26624
  ds_read_b64_tr_b16 v[180:181], v5 offset:0
  ds_read_b64_tr_b16 v[182:183], v5 offset:1536
  v_mfma_f32_16x16x32_bf16 v[136:139], v[216:219], v[188:191], v[136:139]
  v_mfma_f32_16x16x32_bf16 v[140:143], v[212:215], v[192:195], v[140:143]
  ds_read_b64_tr_b16 v[184:185], v6 offset:0
  ds_read_b64_tr_b16 v[186:187], v6 offset:1536
  v_mfma_f32_16x16x32_bf16 v[144:147], v[216:219], v[192:195], v[144:147]
  v_mfma_f32_16x16x32_bf16 v[148:151], v[212:215], v[196:199], v[148:151]
  ds_read_b64_tr_b16 v[188:189], v7 offset:0
  ds_read_b64_tr_b16 v[190:191], v7 offset:1536
  v_mfma_f32_16x16x32_bf16 v[152:155], v[216:219], v[196:199], v[152:155]
  v_mfma_f32_16x16x32_bf16 v[156:159], v[212:215], v[200:203], v[156:159]
  ds_read_b64_tr_b16 v[192:193], v8 offset:0
  ds_read_b64_tr_b16 v[194:195], v8 offset:1536
  v_mfma_f32_16x16x32_bf16 v[160:163], v[216:219], v[200:203], v[160:163]
  s_sub_u32 s45, s45, 1
  s_cmp_lg_u32 s45, 0
  s_cbranch_scc1 k0_loop_v
  s_waitcnt lgkmcnt(6)
  v_mfma_f32_16x16x32_bf16 v[68:71], v[204:207], v[180:183], v[68:71]
  ds_read_b64_tr_b16 v[196:197], v5 offset:128
  ds_read_b64_tr_b16 v[198:199], v5 offset:1664
  v_mfma_f32_16x16x32_bf16 v[72:75], v[208:211], v[180:183], v[72:75]
  s_waitcnt lgkmcnt(6)
  v_mfma_f32_16x16x32_bf16 v[76:79], v[204:207], v[184:187], v[76:79]
  ds_read_b64_tr_b16 v[200:201], v6 offset:128
  ds_read_b64_tr_b16 v[202:203], v6 offset:1664
  v_mfma_f32_16x16x32_bf16 v[80:83], v[208:211], v[184:187], v[80:83]
  s_waitcnt lgkmcnt(6)
  v_mfma_f32_16x16x32_bf16 v[84:87], v[204:207], v[188:191], v[84:87]
  ds_read_b64_tr_b16 v[180:181], v7 offset:128
  ds_read_b64_tr_b16 v[182:183], v7 offset:1664
  v_mfma_f32_16x16x32_bf16 v[88:91], v[208:211], v[188:191], v[88:91]
  v_mfma_f32_16x16x32_bf16 v[24:27], v[40:43], v[204:207], v[24:27]
  s_waitcnt lgkmcnt(6)
  v_mfma_f32_16x16x32_bf16 v[92:95], v[204:207], v[192:195], v[92:95]
  ds_read_b64_tr_b16 v[184:185], v8 offset:128
  ds_read_b64_tr_b16 v[186:187], v8 offset:1664
  v_mfma_f32_16x16x32_bf16 v[96:99], v[208:211], v[192:195], v[96:99]
  v_mfma_f32_16x16x32_bf16 v[28:31], v[40:43], v[208:211], v[28:31]
  s_waitcnt lgkmcnt(6)
  v_mfma_f32_16x16x32_bf16 v[100:103], v[204:207], v[196:199], v[100:103]
  ds_read_b64_tr_b16 v[188:189], v5 offset:256
  ds_read_b64_tr_b16 v[190:191], v5 offset:1792
  v_mfma_f32_16x16x32_bf16 v[104:107], v[208:211], v[196:199], v[104:107]
  v_mfma_f32_16x16x32_bf16 v[32:35], v[204:207], v[204:207], v[32:35]
  s_waitcnt lgkmcnt(6)
  v_mfma_f32_16x16x32_bf16 v[108:111], v[204:207], v[200:203], v[108:111]
  ds_read_b64_tr_b16 v[192:193], v6 offset:256
  ds_read_b64_tr_b16 v[194:195], v6 offset:1792
  v_mfma_f32_16x16x32_bf16 v[112:115], v[208:211], v[200:203], v[112:115]
  v_mfma_f32_16x16x32_bf16 v[36:39], v[208:211], v[208:211], v[36:39]
  s_waitcnt lgkmcnt(6)
  v_mfma_f32_16x16x32_bf16 v[116:119], v[204:207], v[180:183], v[116:119]
  ds_read_b64_tr_b16 v[196:197], v7 offset:256
  ds_read_b64_tr_b16 v[198:199], v7 offset:1792
  v_mfma_f32_16x16x32_bf16 v[120:123], v[208:211], v[180:183], v[120:123]
  s_waitcnt lgkmcnt(6)
  v_mfma_f32_16x16x32_bf16 v[124:127], v[204:207], v[184:187], v[124:127]
  ds_read_b64_tr_b16 v[200:201], v8 offset:256
  ds_read_b64_tr_b16 v[202:203], v8 offset:1792
  v_mfma_f32_16x16x32_bf16 v[128:131], v[208:211], v[184:187], v[128:131]
  s_waitcnt lgkmcnt(6)
  v_mfma_f32_16x16x32_bf16 v[132:135], v[204:207], v[188:191], v[132:135]
  ds_read_b128 v[212:215], v12 offset:24576
  ds_read_b128 v[216:219], v12 offset:26624
  ds_read_b64_tr_b16 v[180:181], v5 offset:12288
  ds_read_b64_tr_b16 v[182:183], v5 offset:13824
  v_mfma_f32_16x16x32_bf16 v[136:139], v[208:211], v[188:191], v[136:139]
  s_waitcnt lgkmcnt(8)
  v_mfma_f32_16x16x32_bf16 v[140:143], v[204:207], v[192:195], v[140:143]
  ds_read_b64_tr_b16 v[184:185], v6 offset:12288
  ds_read_b64_tr_b16 v[186:187], v6 offset:13824
  v_mfma_f32_16x16x32_bf16 v[144:147], v[208:211], v[192:195], v[144:147]
  s_waitcnt lgkmcnt(8)
  v_mfma_f32_16x16x32_bf16 v[148:151], v[204:207], v[196:199], v[148:151]
  ds_read_b64_tr_b16 v[188:189], v7 offset:12288
  ds_read_b64_tr_b16 v[190:191], v7 offset:13824
  v_mfma_f32_16x16x32_bf16 v[152:155], v[208:211], v[196:199], v[152:155]
  s_waitcnt lgkmcnt(8)
  v_mfma_f32_16x16x32_bf16 v[156:159], v[204:207], v[200:203], v[156:159]
  ds_read_b64_tr_b16 v[192:193], v8 offset:12288
  ds_read_b64_tr_b16 v[194:195], v8 offset:13824
  v_mfma_f32_16x16x32_bf16 v[160:163], v[208:211], v[200:203], v[160:163]
  s_waitcnt lgkmcnt(6)
  v_mfma_f32_16x16x32_bf16 v[68:71], v[212:215], v[180:183], v[68:71]
  ds_read_b64_tr_b16 v[196:197], v5 offset:12416
  ds_read_b64_tr_b16 v[198:199], v5 offset:13952
  v_mfma_f32_16x16x32_bf16 v[72:75], v[216:219], v[180:183], v[72:75]
  s_waitcnt lgkmcnt(6)
  v_mfma_f32_16x16x32_bf16 v[76:79], v[212:215], v[184:187], v[76:79]
  ds_read_b64_tr_b16 v[200:201], v6 offset:12416
  ds_read_b64_tr_b16 v[202:203], v6 offset:13952
  v_mfma_f32_16x16x32_bf16 v[80:83], v[216:219], v[184:187], v[80:83]
  s_waitcnt lgkmcnt(6)
  v_mfma_f32_16x16x32_bf16 v[84:87], v[212:215], v[188:191], v[84:87]
  ds_read_b64_tr_b16 v[180:181], v7 offset:12416
  ds_read_b64_tr_b16 v[182:183], v7 offset:13952
  v_mfma_f32_16x16x32_bf16 v[88:91], v[216:219], v[188:191], v[88:91]
  v_mfma_f32_16x16x32_bf16 v[24:27], v[40:43], v[212:215], v[24:27]
  s_waitcnt lgkmcnt(6)
  v_mfma_f32_16x16x32_bf16 v[92:95], v[212:215], v[192:195], v[92:95]
  ds_read_b64_tr_b16 v[184:185], v8 offset:12416
  ds_read_b64_tr_b16 v[186:187], v8 offset:13952
  v_mfma_f32_16x16x32_bf16 v[96:99], v[216:219], v[192:195], v[96:99]
  v_mfma_f32_16x16x32_bf16 v[28:31], v[40:43], v[216:219], v[28:31]
  s_waitcnt lgkmcnt(6)
  v_mfma_f32_16x16x32_bf16 v[100:103], v[212:215], v[196:199], v[100:103]
  ds_read_b64_tr_b16 v[188:189], v5 offset:12544
  ds_read_b64_tr_b16 v[190:191], v5 offset:14080
  v_mfma_f32_16x16x32_bf16 v[104:107], v[216:219], v[196:199], v[104:107]
  v_mfma_f32_16x16x32_bf16 v[32:35], v[212:215], v[212:215], v[32:35]
  s_waitcnt lgkmcnt(6)
  v_mfma_f32_16x16x32_bf16 v[108:111], v[212:215], v[200:203], v[108:111]
  ds_read_b64_tr_b16 v[192:193], v6 offset:12544
  ds_read_b64_tr_b16 v[194:195], v6 offset:14080
  v_mfma_f32_16x16x32_bf16 v[112:115], v[216:219], v[200:203], v[112:115]
  v_mfma_f32_16x16x32_bf16 v[36:39], v[216:219], v[216:219], v[36:39]
  s_waitcnt lgkmcnt(6)
  v_mfma_f32_16x16x32_bf16 v[116:119], v[212:215], v[180:183], v[116:119]
  ds_read_b64_tr_b16 v[196:197], v7 offset:12544
  ds_read_b64_tr_b16 v[198:199], v7 offset:14080
  v_mfma_f32_16x16x32_bf16 v[120:123], v[216:219], v[180:183], v[120:123]
  ds_read_b64_tr_b16 v[200:201], v8 offset:12544
  ds_read_b64_tr_b16 v[202:203], v8 offset:14080
  s_waitcnt lgkmcnt(8)
  v_mfma_f32_16x16x32_bf16 v[124:127], v[212:215], v[184:187], v[124:127]
  v_mfma_f32_16x16x32_bf16 v[128:131], v[216:219], v[184:187], v[128:131]
  s_waitcnt lgkmcnt(0)
  v_mfma_f32_16x16x32_bf16 v[132:135], v[212:215], v[188:191], v[132:135]
  v_mfma_f32_16x16x32_bf16 v[136:139], v[216:219], v[188:191], v[136:139]
  v_mfma_f32_16x16x32_bf16 v[140:143], v[212:215], v[192:195], v[140:143]
  v_mfma_f32_16x16x32_bf16 v[144:147], v[216:219], v[192:195], v[144:147]
  v_mfma_f32_16x16x32_bf16 v[148:151], v[212:215], v[196:199], v[148:151]
  v_mfma_f32_16x16x32_bf16 v[152:155], v[216:219], v[196:199], v[152:155]
  v_mfma_f32_16x16x32_bf16 v[156:159], v[212:215], v[200:203], v[156:159]
  v_mfma_f32_16x16x32_bf16 v[160:163], v[216:219], v[200:203], v[160:163]
  v_and_b32 v16, 3, v0
  v_lshrrev_b32 v17, 2, v13
  v_lshl_add_u32 v17, v17, 4, v13
  v_lshlrev_b32 v17, 2, v17
  v_cmp_eq_u32 s[52:53], 1, v16
  v_cmp_eq_u32 s[54:55], 2, v16
  v_cmp_eq_u32 s[56:57], 3, v16
  v_cndmask_b32 v32, v32, v33, s[52:53]
  v_cndmask_b32 v32, v32, v34, s[54:55]
  v_cndmask_b32 v32, v32, v35, s[56:57]
  ds_bpermute_b32 v22, v17, v32
  v_mov_b32 v20, v24
  v_cndmask_b32 v36, v36, v37, s[52:53]
  v_cndmask_b32 v36, v36, v38, s[54:55]
  v_cndmask_b32 v36, v36, v39, s[56:57]
  ds_bpermute_b32 v23, v17, v36
  v_mov_b32 v21, v28
  s_waitcnt lgkmcnt(0)
  v_mul_f32 v20, 0x3ae38e39, v20
  v_mul_f32 v22, 0x3ae38e39, v22
  v_fma_f32 v22, -v20, v20, v22
  v_max_f32 v22, 0, v22
  v_cvt_pk_bf16_f32 v20, v20, v20
  v_lshlrev_b32 v20, 16, v20
  v_cvt_pk_bf16_f32 v22, v22, v22
  v_lshlrev_b32 v22, 16, v22
  v_add_f32 v22, 0x3727c5ac, v22
  v_cvt_pk_bf16_f32 v22, v22, v22
  v_lshlrev_b32 v22, 16, v22
  v_sqrt_f32 v22, v22
  s_nop 0
  v_cvt_pk_bf16_f32 v22, v22, v22
  v_lshlrev_b32 v22, 16, v22
  v_rcp_f32 v22, v22
  v_mul_f32 v21, 0x3ae38e39, v21
  v_mul_f32 v23, 0x3ae38e39, v23
  v_fma_f32 v23, -v21, v21, v23
  v_max_f32 v23, 0, v23
  v_cvt_pk_bf16_f32 v21, v21, v21
  v_lshlrev_b32 v21, 16, v21
  v_cvt_pk_bf16_f32 v23, v23, v23
  v_lshlrev_b32 v23, 16, v23
  v_add_f32 v23, 0x3727c5ac, v23
  v_cvt_pk_bf16_f32 v23, v23, v23
  v_lshlrev_b32 v23, 16, v23
  v_sqrt_f32 v23, v23
  s_nop 0
  v_cvt_pk_bf16_f32 v23, v23, v23
  v_lshlrev_b32 v23, 16, v23
  v_rcp_f32 v23, v23
  s_barrier
  s_lshl_b32 s37, s3, 8
  s_add_u32 s37, s37, 1024
  v_lshlrev_b32 v16, 2, v13
  v_add_u32 v16, s37, v16
  v_sub_f32 v20, 0, v20
  ds_write_b32 v16, v20 offset:0
  ds_write_b32 v16, v22 offset:128
  v_sub_f32 v21, 0, v21
  ds_write_b32 v16, v21 offset:64
  ds_write_b32 v16, v23 offset:192
  v_lshlrev_b32 v17, 4, v14
  v_add_u32 v17, s37, v17
  v_lshlrev_b32 v16, 2, v13
  v_add_u32 v16, 0, v16
  s_waitcnt lgkmcnt(0)
  ds_read_b128 v[188:191], v17 offset:0
  ds_read_b128 v[196:199], v17 offset:128
  ds_read_b128 v[192:195], v17 offset:64
  ds_read_b128 v[200:203], v17 offset:192
  s_waitcnt lgkmcnt(0)
  ds_read_b32 v164, v16 offset:0
  ds_read_b32 v166, v16 offset:64
  ds_read_b32 v168, v16 offset:128
  ds_read_b32 v170, v16 offset:192
  ds_read_b32 v172, v16 offset:256
  ds_read_b32 v174, v16 offset:320
  ds_read_b32 v176, v16 offset:384
  ds_read_b32 v178, v16 offset:448
  ds_read_b32 v180, v16 offset:512
  ds_read_b32 v182, v16 offset:576
  ds_read_b32 v184, v16 offset:640
  ds_read_b32 v186, v16 offset:704
  s_mov_b32 s38, 18464
  s_mov_b32 s39, 4096
  s_mov_b32 s40, 22560
  s_waitcnt lgkmcnt(11)
  v_pk_fma_f32 v[68:69], v[188:189], v[164:165], v[68:69] op_sel_hi:[1,0,1]
  v_pk_fma_f32 v[70:71], v[190:191], v[164:165], v[70:71] op_sel_hi:[1,0,1]
  v_pk_mul_f32 v[68:69], v[68:69], v[196:197]
  v_pk_mul_f32 v[70:71], v[70:71], v[198:199]
  v_cvt_pk_bf16_f32 v68, v68, v69
  v_cvt_pk_bf16_f32 v69, v70, v71
  buffer_store_dwordx2 v[68:69], v44, s[16:19], 0 offen offset:0
  v_pk_fma_f32 v[72:73], v[192:193], v[164:165], v[72:73] op_sel_hi:[1,0,1]
  v_pk_fma_f32 v[74:75], v[194:195], v[164:165], v[74:75] op_sel_hi:[1,0,1]
  v_pk_mul_f32 v[72:73], v[72:73], v[200:201]
  v_pk_mul_f32 v[74:75], v[74:75], v[202:203]
  v_cvt_pk_bf16_f32 v72, v72, v73
  v_cvt_pk_bf16_f32 v73, v74, v75
  buffer_store_dwordx2 v[72:73], v44, s[16:19], s38 offen offset:0
  s_waitcnt lgkmcnt(10)
  v_pk_fma_f32 v[76:77], v[188:189], v[166:167], v[76:77] op_sel_hi:[1,0,1]
  v_pk_fma_f32 v[78:79], v[190:191], v[166:167], v[78:79] op_sel_hi:[1,0,1]
  v_pk_mul_f32 v[76:77], v[76:77], v[196:197]
  v_pk_mul_f32 v[78:79], v[78:79], v[198:199]
  v_cvt_pk_bf16_f32 v76, v76, v77
  v_cvt_pk_bf16_f32 v77, v78, v79
  buffer_store_dwordx2 v[76:77], v44, s[16:19], 0 offen offset:512
  v_pk_fma_f32 v[80:81], v[192:193], v[166:167], v[80:81] op_sel_hi:[1,0,1]
  v_pk_fma_f32 v[82:83], v[194:195], v[166:167], v[82:83] op_sel_hi:[1,0,1]
  v_pk_mul_f32 v[80:81], v[80:81], v[200:201]
  v_pk_mul_f32 v[82:83], v[82:83], v[202:203]
  v_cvt_pk_bf16_f32 v80, v80, v81
  v_cvt_pk_bf16_f32 v81, v82, v83
  buffer_store_dwordx2 v[80:81], v44, s[16:19], s38 offen offset:512
  s_waitcnt lgkmcnt(9)
  v_pk_fma_f32 v[84:85], v[188:189], v[168:169], v[84:85] op_sel_hi:[1,0,1]
  v_pk_fma_f32 v[86:87], v[190:191], v[168:169], v[86:87] op_sel_hi:[1,0,1]
  v_pk_mul_f32 v[84:85], v[84:85], v[196:197]
  v_pk_mul_f32 v[86:87], v[86:87], v[198:199]
  v_cvt_pk_bf16_f32 v84, v84, v85
  v_cvt_pk_bf16_f32 v85, v86, v87
  buffer_store_dwordx2 v[84:85], v44, s[16:19], 0 offen offset:1024
  v_pk_fma_f32 v[88:89], v[192:193], v[168:169], v[88:89] op_sel_hi:[1,0,1]
  v_pk_fma_f32 v[90:91], v[194:195], v[168:169], v[90:91] op_sel_hi:[1,0,1]
  v_pk_mul_f32 v[88:89], v[88:89], v[200:201]
  v_pk_mul_f32 v[90:91], v[90:91], v[202:203]
  v_cvt_pk_bf16_f32 v88, v88, v89
  v_cvt_pk_bf16_f32 v89, v90, v91
  buffer_store_dwordx2 v[88:89], v44, s[16:19], s38 offen offset:1024
  s_waitcnt lgkmcnt(8)
  v_pk_fma_f32 v[92:93], v[188:189], v[170:171], v[92:93] op_sel_hi:[1,0,1]
  v_pk_fma_f32 v[94:95], v[190:191], v[170:171], v[94:95] op_sel_hi:[1,0,1]
  v_pk_mul_f32 v[92:93], v[92:93], v[196:197]
  v_pk_mul_f32 v[94:95], v[94:95], v[198:199]
  v_cvt_pk_bf16_f32 v92, v92, v93
  v_cvt_pk_bf16_f32 v93, v94, v95
  buffer_store_dwordx2 v[92:93], v44, s[16:19], 0 offen offset:1536
  v_pk_fma_f32 v[96:97], v[192:193], v[170:171], v[96:97] op_sel_hi:[1,0,1]
  v_pk_fma_f32 v[98:99], v[194:195], v[170:171], v[98:99] op_sel_hi:[1,0,1]
  v_pk_mul_f32 v[96:97], v[96:97], v[200:201]
  v_pk_mul_f32 v[98:99], v[98:99], v[202:203]
  v_cvt_pk_bf16_f32 v96, v96, v97
  v_cvt_pk_bf16_f32 v97, v98, v99
  buffer_store_dwordx2 v[96:97], v44, s[16:19], s38 offen offset:1536
  s_waitcnt lgkmcnt(7)
  v_pk_fma_f32 v[100:101], v[188:189], v[172:173], v[100:101] op_sel_hi:[1,0,1]
  v_pk_fma_f32 v[102:103], v[190:191], v[172:173], v[102:103] op_sel_hi:[1,0,1]
  v_pk_mul_f32 v[100:101], v[100:101], v[196:197]
  v_pk_mul_f32 v[102:103], v[102:103], v[198:199]
  v_cvt_pk_bf16_f32 v100, v100, v101
  v_cvt_pk_bf16_f32 v101, v102, v103
  buffer_store_dwordx2 v[100:101], v44, s[16:19], 0 offen offset:2048
  v_pk_fma_f32 v[104:105], v[192:193], v[172:173], v[104:105] op_sel_hi:[1,0,1]
  v_pk_fma_f32 v[106:107], v[194:195], v[172:173], v[106:107] op_sel_hi:[1,0,1]
  v_pk_mul_f32 v[104:105], v[104:105], v[200:201]
  v_pk_mul_f32 v[106:107], v[106:107], v[202:203]
  v_cvt_pk_bf16_f32 v104, v104, v105
  v_cvt_pk_bf16_f32 v105, v106, v107
  buffer_store_dwordx2 v[104:105], v44, s[16:19], s38 offen offset:2048
  s_waitcnt lgkmcnt(6)
  v_pk_fma_f32 v[108:109], v[188:189], v[174:175], v[108:109] op_sel_hi:[1,0,1]
  v_pk_fma_f32 v[110:111], v[190:191], v[174:175], v[110:111] op_sel_hi:[1,0,1]
  v_pk_mul_f32 v[108:109], v[108:109], v[196:197]
  v_pk_mul_f32 v[110:111], v[110:111], v[198:199]
  v_cvt_pk_bf16_f32 v108, v108, v109
  v_cvt_pk_bf16_f32 v109, v110, v111
  buffer_store_dwordx2 v[108:109], v44, s[16:19], 0 offen offset:2560
  v_pk_fma_f32 v[112:113], v[192:193], v[174:175], v[112:113] op_sel_hi:[1,0,1]
  v_pk_fma_f32 v[114:115], v[194:195], v[174:175], v[114:115] op_sel_hi:[1,0,1]
  v_pk_mul_f32 v[112:113], v[112:113], v[200:201]
  v_pk_mul_f32 v[114:115], v[114:115], v[202:203]
  v_cvt_pk_bf16_f32 v112, v112, v113
  v_cvt_pk_bf16_f32 v113, v114, v115
  buffer_store_dwordx2 v[112:113], v44, s[16:19], s38 offen offset:2560
  s_waitcnt lgkmcnt(5)
  v_pk_fma_f32 v[116:117], v[188:189], v[176:177], v[116:117] op_sel_hi:[1,0,1]
  v_pk_fma_f32 v[118:119], v[190:191], v[176:177], v[118:119] op_sel_hi:[1,0,1]
  v_pk_mul_f32 v[116:117], v[116:117], v[196:197]
  v_pk_mul_f32 v[118:119], v[118:119], v[198:199]
  v_cvt_pk_bf16_f32 v116, v116, v117
  v_cvt_pk_bf16_f32 v117, v118, v119
  buffer_store_dwordx2 v[116:117], v44, s[16:19], 0 offen offset:3072
  v_pk_fma_f32 v[120:121], v[192:193], v[176:177], v[120:121] op_sel_hi:[1,0,1]
  v_pk_fma_f32 v[122:123], v[194:195], v[176:177], v[122:123] op_sel_hi:[1,0,1]
  v_pk_mul_f32 v[120:121], v[120:121], v[200:201]
  v_pk_mul_f32 v[122:123], v[122:123], v[202:203]
  v_cvt_pk_bf16_f32 v120, v120, v121
  v_cvt_pk_bf16_f32 v121, v122, v123
  buffer_store_dwordx2 v[120:121], v44, s[16:19], s38 offen offset:3072
  s_waitcnt lgkmcnt(4)
  v_pk_fma_f32 v[124:125], v[188:189], v[178:179], v[124:125] op_sel_hi:[1,0,1]
  v_pk_fma_f32 v[126:127], v[190:191], v[178:179], v[126:127] op_sel_hi:[1,0,1]
  v_pk_mul_f32 v[124:125], v[124:125], v[196:197]
  v_pk_mul_f32 v[126:127], v[126:127], v[198:199]
  v_cvt_pk_bf16_f32 v124, v124, v125
  v_cvt_pk_bf16_f32 v125, v126, v127
  buffer_store_dwordx2 v[124:125], v44, s[16:19], 0 offen offset:3584
  v_pk_fma_f32 v[128:129], v[192:193], v[178:179], v[128:129] op_sel_hi:[1,0,1]
  v_pk_fma_f32 v[130:131], v[194:195], v[178:179], v[130:131] op_sel_hi:[1,0,1]
  v_pk_mul_f32 v[128:129], v[128:129], v[200:201]
  v_pk_mul_f32 v[130:131], v[130:131], v[202:203]
  v_cvt_pk_bf16_f32 v128, v128, v129
  v_cvt_pk_bf16_f32 v129, v130, v131
  buffer_store_dwordx2 v[128:129], v44, s[16:19], s38 offen offset:3584
  s_waitcnt lgkmcnt(3)
  v_pk_fma_f32 v[132:133], v[188:189], v[180:181], v[132:133] op_sel_hi:[1,0,1]
  v_pk_fma_f32 v[134:135], v[190:191], v[180:181], v[134:135] op_sel_hi:[1,0,1]
  v_pk_mul_f32 v[132:133], v[132:133], v[196:197]
  v_pk_mul_f32 v[134:135], v[134:135], v[198:199]
  v_cvt_pk_bf16_f32 v132, v132, v133
  v_cvt_pk_bf16_f32 v133, v134, v135
  buffer_store_dwordx2 v[132:133], v44, s[16:19], s39 offen offset:0
  v_pk_fma_f32 v[136:137], v[192:193], v[180:181], v[136:137] op_sel_hi:[1,0,1]
  v_pk_fma_f32 v[138:139], v[194:195], v[180:181], v[138:139] op_sel_hi:[1,0,1]
  v_pk_mul_f32 v[136:137], v[136:137], v[200:201]
  v_pk_mul_f32 v[138:139], v[138:139], v[202:203]
  v_cvt_pk_bf16_f32 v136, v136, v137
  v_cvt_pk_bf16_f32 v137, v138, v139
  buffer_store_dwordx2 v[136:137], v44, s[16:19], s40 offen offset:0
  s_waitcnt lgkmcnt(2)
  v_pk_fma_f32 v[140:141], v[188:189], v[182:183], v[140:141] op_sel_hi:[1,0,1]
  v_pk_fma_f32 v[142:143], v[190:191], v[182:183], v[142:143] op_sel_hi:[1,0,1]
  v_pk_mul_f32 v[140:141], v[140:141], v[196:197]
  v_pk_mul_f32 v[142:143], v[142:143], v[198:199]
  v_cvt_pk_bf16_f32 v140, v140, v141
  v_cvt_pk_bf16_f32 v141, v142, v143
  buffer_store_dwordx2 v[140:141], v44, s[16:19], s39 offen offset:512
  v_pk_fma_f32 v[144:145], v[192:193], v[182:183], v[144:145] op_sel_hi:[1,0,1]
  v_pk_fma_f32 v[146:147], v[194:195], v[182:183], v[146:147] op_sel_hi:[1,0,1]
  v_pk_mul_f32 v[144:145], v[144:145], v[200:201]
  v_pk_mul_f32 v[146:147], v[146:147], v[202:203]
  v_cvt_pk_bf16_f32 v144, v144, v145
  v_cvt_pk_bf16_f32 v145, v146, v147
  buffer_store_dwordx2 v[144:145], v44, s[16:19], s40 offen offset:512
  s_waitcnt lgkmcnt(1)
  v_pk_fma_f32 v[148:149], v[188:189], v[184:185], v[148:149] op_sel_hi:[1,0,1]
  v_pk_fma_f32 v[150:151], v[190:191], v[184:185], v[150:151] op_sel_hi:[1,0,1]
  v_pk_mul_f32 v[148:149], v[148:149], v[196:197]
  v_pk_mul_f32 v[150:151], v[150:151], v[198:199]
  v_cvt_pk_bf16_f32 v148, v148, v149
  v_cvt_pk_bf16_f32 v149, v150, v151
  buffer_store_dwordx2 v[148:149], v44, s[16:19], s39 offen offset:1024
  v_pk_fma_f32 v[152:153], v[192:193], v[184:185], v[152:153] op_sel_hi:[1,0,1]
  v_pk_fma_f32 v[154:155], v[194:195], v[184:185], v[154:155] op_sel_hi:[1,0,1]
  v_pk_mul_f32 v[152:153], v[152:153], v[200:201]
  v_pk_mul_f32 v[154:155], v[154:155], v[202:203]
  v_cvt_pk_bf16_f32 v152, v152, v153
  v_cvt_pk_bf16_f32 v153, v154, v155
  buffer_store_dwordx2 v[152:153], v44, s[16:19], s40 offen offset:1024
  s_waitcnt lgkmcnt(0)
  v_pk_fma_f32 v[156:157], v[188:189], v[186:187], v[156:157] op_sel_hi:[1,0,1]
  v_pk_fma_f32 v[158:159], v[190:191], v[186:187], v[158:159] op_sel_hi:[1,0,1]
  v_pk_mul_f32 v[156:157], v[156:157], v[196:197]
  v_pk_mul_f32 v[158:159], v[158:159], v[198:199]
  v_cvt_pk_bf16_f32 v156, v156, v157
  v_cvt_pk_bf16_f32 v157, v158, v159
  buffer_store_dwordx2 v[156:157], v44, s[16:19], s39 offen offset:1536
  v_pk_fma_f32 v[160:161], v[192:193], v[186:187], v[160:161] op_sel_hi:[1,0,1]
  v_pk_fma_f32 v[162:163], v[194:195], v[186:187], v[162:163] op_sel_hi:[1,0,1]
  v_pk_mul_f32 v[160:161], v[160:161], v[200:201]
  v_pk_mul_f32 v[162:163], v[162:163], v[202:203]
  v_cvt_pk_bf16_f32 v160, v160, v161
  v_cvt_pk_bf16_f32 v161, v162, v163
  buffer_store_dwordx2 v[160:161], v44, s[16:19], s40 offen offset:1536
  s_endpgm
k0_loader:
  s_setprio 3
  s_sub_u32 s33, s3, 4
  v_lshrrev_b32 v1, 4, v0
  v_lshrrev_b32 v3, 3, v0
  v_mul_u32_u24 v3, 1152, v3
  v_and_b32 v4, 7, v0
  v_xor_b32 v4, v4, v1
  v_lshl_add_u32 v5, v4, 4, v3
  v_xor_b32 v4, 4, v4
  v_lshl_add_u32 v6, v4, 4, v3
  v_add_u32 v14, 0, v5
  v_add_u32 v15, 8192, v6
  v_add_u32 v16, 16384, v5
  v_add_u32 v17, 24576, v6
  v_add_u32 v1, 0, v0
  v_mul_u32_u24 v2, 2731, v1
  v_lshrrev_b32 v2, 16, v2
  v_mul_u32_u24 v3, 24, v2
  v_sub_u32 v3, v1, v3
  v_bfe_u32 v4, v2, 1, 1
  v_bfe_u32 v5, v2, 3, 1
  v_lshl_add_u32 v4, v5, 1, v4
  v_lshlrev_b32 v4, 1, v4
  v_xor_b32 v3, v3, v4
  v_mul_u32_u24 v2, 3456, v2
  v_lshl_add_u32 v2, v3, 4, v2
  v_subrev_u32 v8, 0, v2
  v_add_u32 v1, 64, v0
  v_mul_u32_u24 v2, 2731, v1
  v_lshrrev_b32 v2, 16, v2
  v_mul_u32_u24 v3, 24, v2
  v_sub_u32 v3, v1, v3
  v_bfe_u32 v4, v2, 1, 1
  v_bfe_u32 v5, v2, 3, 1
  v_lshl_add_u32 v4, v5, 1, v4
  v_lshlrev_b32 v4, 1, v4
  v_xor_b32 v3, v3, v4
  v_mul_u32_u24 v2, 3456, v2
  v_lshl_add_u32 v2, v3, 4, v2
  v_subrev_u32 v9, 1024, v2
  v_add_u32 v1, 128, v0
  v_mul_u32_u24 v2, 2731, v1
  v_lshrrev_b32 v2, 16, v2
  v_mul_u32_u24 v3, 24, v2
  v_sub_u32 v3, v1, v3
  v_bfe_u32 v4, v2, 1, 1
  v_bfe_u32 v5, v2, 3, 1
  v_lshl_add_u32 v4, v5, 1, v4
  v_lshlrev_b32 v4, 1, v4
  v_xor_b32 v3, v3, v4
  v_mul_u32_u24 v2, 3456, v2
  v_lshl_add_u32 v2, v3, 4, v2
  v_subrev_u32 v10, 2048, v2
  v_add_u32 v1, 192, v0
  v_mul_u32_u24 v2, 2731, v1
  v_lshrrev_b32 v2, 16, v2
  v_mul_u32_u24 v3, 24, v2
  v_sub_u32 v3, v1, v3
  v_bfe_u32 v4, v2, 1, 1
  v_bfe_u32 v5, v2, 3, 1
  v_lshl_add_u32 v4, v5, 1, v4
  v_lshlrev_b32 v4, 1, v4
  v_xor_b32 v3, v3, v4
  v_mul_u32_u24 v2, 3456, v2
  v_lshl_add_u32 v2, v3, 4, v2
  v_subrev_u32 v11, 3072, v2
  v_add_u32 v1, 256, v0
  v_mul_u32_u24 v2, 2731, v1
  v_lshrrev_b32 v2, 16, v2
  v_mul_u32_u24 v3, 24, v2
  v_sub_u32 v3, v1, v3
  v_bfe_u32 v4, v2, 1, 1
  v_bfe_u32 v5, v2, 3, 1
  v_lshl_add_u32 v4, v5, 1, v4
  v_lshlrev_b32 v4, 1, v4
  v_xor_b32 v3, v3, v4
  v_mul_u32_u24 v2, 3456, v2
  v_lshl_add_u32 v2, v3, 4, v2
  v_subrev_u32 v12, 0, v2
  v_add_u32 v1, 320, v0
  v_mul_u32_u24 v2, 2731, v1
  v_lshrrev_b32 v2, 16, v2
  v_mul_u32_u24 v3, 24, v2
  v_sub_u32 v3, v1, v3
  v_bfe_u32 v4, v2, 1, 1
  v_bfe_u32 v5, v2, 3, 1
  v_lshl_add_u32 v4, v5, 1, v4
  v_lshlrev_b32 v4, 1, v4
  v_xor_b32 v3, v3, v4
  v_mul_u32_u24 v2, 3456, v2
  v_lshl_add_u32 v2, v3, 4, v2
  v_subrev_u32 v13, 1024, v2
  s_mul_i32 s36, s7, 384
  s_mul_i32 s37, s33, 55296
  s_add_u32 s36, s36, s37
  s_lshl_b32 s37, s6, 7
  s_lshl_b32 s38, s33, 5
  s_add_u32 s37, s37, s38
  s_mul_i32 s37, s37, 1152
  s_mul_i32 s38, s33, 6144
  s_lshl_b32 s39, s33, 12
  s_add_u32 s39, s39, 24576
  s_add_u32 m0, s39, 0
  s_nop 0
  buffer_load_dwordx4 v14, s[8:11], s37 offen offset:0 lds
  buffer_load_dwordx4 v15, s[8:11], s37 offen offset:1024 lds
  buffer_load_dwordx4 v16, s[8:11], s37 offen offset:2048 lds
  buffer_load_dwordx4 v17, s[8:11], s37 offen offset:3072 lds
  s_add_u32 m0, s38, 0
  s_nop 0
  buffer_load_dwordx4 v8, s[12:15], s36 offen offset:0 lds
  buffer_load_dwordx4 v9, s[12:15], s36 offen offset:1024 lds
  buffer_load_dwordx4 v10, s[12:15], s36 offen offset:2048 lds
  buffer_load_dwordx4 v11, s[12:15], s36 offen offset:3072 lds
  s_add_u32 m0, s38, 4096
  s_nop 0
  buffer_load_dwordx4 v12, s[12:15], s36 offen offset:0 lds
  buffer_load_dwordx4 v13, s[12:15], s36 offen offset:1024 lds
  s_add_u32 s36, s36, 221184
  s_add_u32 s37, s37, 128
  s_add_u32 m0, s39, 40960
  s_nop 0
  buffer_load_dwordx4 v14, s[8:11], s37 offen offset:0 lds
  buffer_load_dwordx4 v15, s[8:11], s37 offen offset:1024 lds
  buffer_load_dwordx4 v16, s[8:11], s37 offen offset:2048 lds
  buffer_load_dwordx4 v17, s[8:11], s37 offen offset:3072 lds
  s_add_u32 m0, s38, 40960
  s_nop 0
  buffer_load_dwordx4 v8, s[12:15], s36 offen offset:0 lds
  buffer_load_dwordx4 v9, s[12:15], s36 offen offset:1024 lds
  buffer_load_dwordx4 v10, s[12:15], s36 offen offset:2048 lds
  buffer_load_dwordx4 v11, s[12:15], s36 offen offset:3072 lds
  s_add_u32 m0, s38, 45056
  s_nop 0
  buffer_load_dwordx4 v12, s[12:15], s36 offen offset:0 lds
  buffer_load_dwordx4 v13, s[12:15], s36 offen offset:1024 lds
  s_add_u32 s36, s36, 221184
  s_add_u32 s37, s37, 128
  v_lshrrev_b32 v40, 4, v0
  v_bfe_u32 v41, v0, 2, 2
  v_lshl_add_u32 v42, v40, 3, v41
  v_mul_u32_u24 v42, 384, v42
  v_and_b32 v43, 3, v0
  v_lshl_add_u32 v42, v43, 3, v42
  v_lshrrev_b32 v41, 1, v41
  v_and_b32 v40, 1, v40
  v_lshl_add_u32 v41, v40, 1, v41
  v_xor_b32 v40, s33, v41
  v_lshl_add_u32 v20, v40, 5, v42
  v_add_u32 v21, 40960, v20
  v_add_u32 v22, 81920, v20
  v_mov_b32 v24, 0x3f803f80
  v_mov_b32 v25, 0x3f803f80
  v_mov_b32 v26, 0x3f803f80
  v_mov_b32 v27, 0x3f803f80
  v_mov_b32 v28, 0
  v_mov_b32 v29, 0
  v_mov_b32 v30, 0
  v_mov_b32 v31, 0
  v_mov_b32 v32, 0
  v_mov_b32 v33, 0
  v_mov_b32 v34, 0
  v_mov_b32 v35, 0
  v_mov_b32 v36, 0
  v_mov_b32 v37, 0
  v_mov_b32 v38, 0
  v_mov_b32 v39, 0
  s_waitcnt vmcnt(10)
  s_barrier
  s_add_u32 m0, s39, 81920
  s_nop 0
  buffer_load_dwordx4 v14, s[8:11], s37 offen offset:0 lds
  buffer_load_dwordx4 v15, s[8:11], s37 offen offset:1024 lds
  buffer_load_dwordx4 v16, s[8:11], s37 offen offset:2048 lds
  buffer_load_dwordx4 v17, s[8:11], s37 offen offset:3072 lds
  s_add_u32 m0, s38, 81920
  s_nop 0
  buffer_load_dwordx4 v8, s[12:15], s36 offen offset:0 lds
  buffer_load_dwordx4 v9, s[12:15], s36 offen offset:1024 lds
  buffer_load_dwordx4 v10, s[12:15], s36 offen offset:2048 lds
  buffer_load_dwordx4 v11, s[12:15], s36 offen offset:3072 lds
  s_add_u32 m0, s38, 86016
  s_nop 0
  buffer_load_dwordx4 v12, s[12:15], s36 offen offset:0 lds
  buffer_load_dwordx4 v13, s[12:15], s36 offen offset:1024 lds
  s_add_u32 s36, s36, 221184
  s_add_u32 s37, s37, 128
  ds_read_b64_tr_b16 v[40:41], v20 offset:0
  ds_read_b64_tr_b16 v[42:43], v20 offset:1536
  ds_read_b64_tr_b16 v[44:45], v20 offset:128
  ds_read_b64_tr_b16 v[46:47], v20 offset:1664
  ds_read_b64_tr_b16 v[48:49], v20 offset:256
  ds_read_b64_tr_b16 v[50:51], v20 offset:1792
  ds_read_b64_tr_b16 v[52:53], v20 offset:12288
  ds_read_b64_tr_b16 v[54:55], v20 offset:13824
  ds_read_b64_tr_b16 v[56:57], v20 offset:12416
  ds_read_b64_tr_b16 v[58:59], v20 offset:13952
  ds_read_b64_tr_b16 v[60:61], v20 offset:12544
  ds_read_b64_tr_b16 v[62:63], v20 offset:14080
  s_waitcnt lgkmcnt(0)
  v_mfma_f32_16x16x32_bf16 v[28:31], v[24:27], v[40:43], v[28:31]
  v_mfma_f32_16x16x32_bf16 v[32:35], v[24:27], v[44:47], v[32:35]
  v_mfma_f32_16x16x32_bf16 v[36:39], v[24:27], v[48:51], v[36:39]
  v_mfma_f32_16x16x32_bf16 v[28:31], v[24:27], v[52:55], v[28:31]
  v_mfma_f32_16x16x32_bf16 v[32:35], v[24:27], v[56:59], v[32:35]
  v_mfma_f32_16x16x32_bf16 v[36:39], v[24:27], v[60:63], v[36:39]
  s_waitcnt vmcnt(10)
  s_barrier
  s_add_u32 m0, s39, 0
  s_nop 0
  buffer_load_dwordx4 v14, s[8:11], s37 offen offset:0 lds
  buffer_load_dwordx4 v15, s[8:11], s37 offen offset:1024 lds
  buffer_load_dwordx4 v16, s[8:11], s37 offen offset:2048 lds
  buffer_load_dwordx4 v17, s[8:11], s37 offen offset:3072 lds
  s_add_u32 m0, s38, 0
  s_nop 0
  buffer_load_dwordx4 v8, s[12:15], s36 offen offset:0 lds
  buffer_load_dwordx4 v9, s[12:15], s36 offen offset:1024 lds
  buffer_load_dwordx4 v10, s[12:15], s36 offen offset:2048 lds
  buffer_load_dwordx4 v11, s[12:15], s36 offen offset:3072 lds
  s_add_u32 m0, s38, 4096
  s_nop 0
  buffer_load_dwordx4 v12, s[12:15], s36 offen offset:0 lds
  buffer_load_dwordx4 v13, s[12:15], s36 offen offset:1024 lds
  s_add_u32 s36, s36, 221184
  s_add_u32 s37, s37, 128
  ds_read_b64_tr_b16 v[40:41], v21 offset:0
  ds_read_b64_tr_b16 v[42:43], v21 offset:1536
  ds_read_b64_tr_b16 v[44:45], v21 offset:128
  ds_read_b64_tr_b16 v[46:47], v21 offset:1664
  ds_read_b64_tr_b16 v[48:49], v21 offset:256
  ds_read_b64_tr_b16 v[50:51], v21 offset:1792
  ds_read_b64_tr_b16 v[52:53], v21 offset:12288
  ds_read_b64_tr_b16 v[54:55], v21 offset:13824
  ds_read_b64_tr_b16 v[56:57], v21 offset:12416
  ds_read_b64_tr_b16 v[58:59], v21 offset:13952
  ds_read_b64_tr_b16 v[60:61], v21 offset:12544
  ds_read_b64_tr_b16 v[62:63], v21 offset:14080
  s_waitcnt lgkmcnt(0)
  v_mfma_f32_16x16x32_bf16 v[28:31], v[24:27], v[40:43], v[28:31]
  v_mfma_f32_16x16x32_bf16 v[32:35], v[24:27], v[44:47], v[32:35]
  v_mfma_f32_16x16x32_bf16 v[36:39], v[24:27], v[48:51], v[36:39]
  v_mfma_f32_16x16x32_bf16 v[28:31], v[24:27], v[52:55], v[28:31]
  v_mfma_f32_16x16x32_bf16 v[32:35], v[24:27], v[56:59], v[32:35]
  v_mfma_f32_16x16x32_bf16 v[36:39], v[24:27], v[60:63], v[36:39]
  s_waitcnt vmcnt(10)
  s_barrier
  s_add_u32 m0, s39, 40960
  s_nop 0
  buffer_load_dwordx4 v14, s[8:11], s37 offen offset:0 lds
  buffer_load_dwordx4 v15, s[8:11], s37 offen offset:1024 lds
  buffer_load_dwordx4 v16, s[8:11], s37 offen offset:2048 lds
  buffer_load_dwordx4 v17, s[8:11], s37 offen offset:3072 lds
  s_add_u32 m0, s38, 40960
  s_nop 0
  buffer_load_dwordx4 v8, s[12:15], s36 offen offset:0 lds
  buffer_load_dwordx4 v9, s[12:15], s36 offen offset:1024 lds
  buffer_load_dwordx4 v10, s[12:15], s36 offen offset:2048 lds
  buffer_load_dwordx4 v11, s[12:15], s36 offen offset:3072 lds
  s_add_u32 m0, s38, 45056
  s_nop 0
  buffer_load_dwordx4 v12, s[12:15], s36 offen offset:0 lds
  buffer_load_dwordx4 v13, s[12:15], s36 offen offset:1024 lds
  s_add_u32 s36, s36, 221184
  s_add_u32 s37, s37, 128
  ds_read_b64_tr_b16 v[40:41], v22 offset:0
  ds_read_b64_tr_b16 v[42:43], v22 offset:1536
  ds_read_b64_tr_b16 v[44:45], v22 offset:128
  ds_read_b64_tr_b16 v[46:47], v22 offset:1664
  ds_read_b64_tr_b16 v[48:49], v22 offset:256
  ds_read_b64_tr_b16 v[50:51], v22 offset:1792
  ds_read_b64_tr_b16 v[52:53], v22 offset:12288
  ds_read_b64_tr_b16 v[54:55], v22 offset:13824
  ds_read_b64_tr_b16 v[56:57], v22 offset:12416
  ds_read_b64_tr_b16 v[58:59], v22 offset:13952
  ds_read_b64_tr_b16 v[60:61], v22 offset:12544
  ds_read_b64_tr_b16 v[62:63], v22 offset:14080
  s_waitcnt lgkmcnt(0)
  v_mfma_f32_16x16x32_bf16 v[28:31], v[24:27], v[40:43], v[28:31]
  v_mfma_f32_16x16x32_bf16 v[32:35], v[24:27], v[44:47], v[32:35]
  v_mfma_f32_16x16x32_bf16 v[36:39], v[24:27], v[48:51], v[36:39]
  v_mfma_f32_16x16x32_bf16 v[28:31], v[24:27], v[52:55], v[28:31]
  v_mfma_f32_16x16x32_bf16 v[32:35], v[24:27], v[56:59], v[32:35]
  v_mfma_f32_16x16x32_bf16 v[36:39], v[24:27], v[60:63], v[36:39]
  s_waitcnt vmcnt(10)
  s_barrier
  s_add_u32 m0, s39, 81920
  s_nop 0
  buffer_load_dwordx4 v14, s[8:11], s37 offen offset:0 lds
  buffer_load_dwordx4 v15, s[8:11], s37 offen offset:1024 lds
  buffer_load_dwordx4 v16, s[8:11], s37 offen offset:2048 lds
  buffer_load_dwordx4 v17, s[8:11], s37 offen offset:3072 lds
  s_add_u32 m0, s38, 81920
  s_nop 0
  buffer_load_dwordx4 v8, s[12:15], s36 offen offset:0 lds
  buffer_load_dwordx4 v9, s[12:15], s36 offen offset:1024 lds
  buffer_load_dwordx4 v10, s[12:15], s36 offen offset:2048 lds
  buffer_load_dwordx4 v11, s[12:15], s36 offen offset:3072 lds
  s_add_u32 m0, s38, 86016
  s_nop 0
  buffer_load_dwordx4 v12, s[12:15], s36 offen offset:0 lds
  buffer_load_dwordx4 v13, s[12:15], s36 offen offset:1024 lds
  s_add_u32 s36, s36, 221184
  s_add_u32 s37, s37, 128
  ds_read_b64_tr_b16 v[40:41], v20 offset:0
  ds_read_b64_tr_b16 v[42:43], v20 offset:1536
  ds_read_b64_tr_b16 v[44:45], v20 offset:128
  ds_read_b64_tr_b16 v[46:47], v20 offset:1664
  ds_read_b64_tr_b16 v[48:49], v20 offset:256
  ds_read_b64_tr_b16 v[50:51], v20 offset:1792
  ds_read_b64_tr_b16 v[52:53], v20 offset:12288
  ds_read_b64_tr_b16 v[54:55], v20 offset:13824
  ds_read_b64_tr_b16 v[56:57], v20 offset:12416
  ds_read_b64_tr_b16 v[58:59], v20 offset:13952
  ds_read_b64_tr_b16 v[60:61], v20 offset:12544
  ds_read_b64_tr_b16 v[62:63], v20 offset:14080
  s_waitcnt lgkmcnt(0)
  v_mfma_f32_16x16x32_bf16 v[28:31], v[24:27], v[40:43], v[28:31]
  v_mfma_f32_16x16x32_bf16 v[32:35], v[24:27], v[44:47], v[32:35]
  v_mfma_f32_16x16x32_bf16 v[36:39], v[24:27], v[48:51], v[36:39]
  v_mfma_f32_16x16x32_bf16 v[28:31], v[24:27], v[52:55], v[28:31]
  v_mfma_f32_16x16x32_bf16 v[32:35], v[24:27], v[56:59], v[32:35]
  v_mfma_f32_16x16x32_bf16 v[36:39], v[24:27], v[60:63], v[36:39]
  s_waitcnt vmcnt(10)
  s_barrier
  s_add_u32 m0, s39, 0
  s_nop 0
  buffer_load_dwordx4 v14, s[8:11], s37 offen offset:0 lds
  buffer_load_dwordx4 v15, s[8:11], s37 offen offset:1024 lds
  buffer_load_dwordx4 v16, s[8:11], s37 offen offset:2048 lds
  buffer_load_dwordx4 v17, s[8:11], s37 offen offset:3072 lds
  s_add_u32 m0, s38, 0
  s_nop 0
  buffer_load_dwordx4 v8, s[12:15], s36 offen offset:0 lds
  buffer_load_dwordx4 v9, s[12:15], s36 offen offset:1024 lds
  buffer_load_dwordx4 v10, s[12:15], s36 offen offset:2048 lds
  buffer_load_dwordx4 v11, s[12:15], s36 offen offset:3072 lds
  s_add_u32 m0, s38, 4096
  s_nop 0
  buffer_load_dwordx4 v12, s[12:15], s36 offen offset:0 lds
  buffer_load_dwordx4 v13, s[12:15], s36 offen offset:1024 lds
  s_add_u32 s36, s36, 221184
  s_add_u32 s37, s37, 128
  ds_read_b64_tr_b16 v[40:41], v21 offset:0
  ds_read_b64_tr_b16 v[42:43], v21 offset:1536
  ds_read_b64_tr_b16 v[44:45], v21 offset:128
  ds_read_b64_tr_b16 v[46:47], v21 offset:1664
  ds_read_b64_tr_b16 v[48:49], v21 offset:256
  ds_read_b64_tr_b16 v[50:51], v21 offset:1792
  ds_read_b64_tr_b16 v[52:53], v21 offset:12288
  ds_read_b64_tr_b16 v[54:55], v21 offset:13824
  ds_read_b64_tr_b16 v[56:57], v21 offset:12416
  ds_read_b64_tr_b16 v[58:59], v21 offset:13952
  ds_read_b64_tr_b16 v[60:61], v21 offset:12544
  ds_read_b64_tr_b16 v[62:63], v21 offset:14080
  s_waitcnt lgkmcnt(0)
  v_mfma_f32_16x16x32_bf16 v[28:31], v[24:27], v[40:43], v[28:31]
  v_mfma_f32_16x16x32_bf16 v[32:35], v[24:27], v[44:47], v[32:35]
  v_mfma_f32_16x16x32_bf16 v[36:39], v[24:27], v[48:51], v[36:39]
  v_mfma_f32_16x16x32_bf16 v[28:31], v[24:27], v[52:55], v[28:31]
  v_mfma_f32_16x16x32_bf16 v[32:35], v[24:27], v[56:59], v[32:35]
  v_mfma_f32_16x16x32_bf16 v[36:39], v[24:27], v[60:63], v[36:39]
  s_waitcnt vmcnt(10)
  s_barrier
  s_add_u32 m0, s39, 40960
  s_nop 0
  buffer_load_dwordx4 v14, s[8:11], s37 offen offset:0 lds
  buffer_load_dwordx4 v15, s[8:11], s37 offen offset:1024 lds
  buffer_load_dwordx4 v16, s[8:11], s37 offen offset:2048 lds
  buffer_load_dwordx4 v17, s[8:11], s37 offen offset:3072 lds
  s_add_u32 m0, s38, 40960
  s_nop 0
  buffer_load_dwordx4 v8, s[12:15], s36 offen offset:0 lds
  buffer_load_dwordx4 v9, s[12:15], s36 offen offset:1024 lds
  buffer_load_dwordx4 v10, s[12:15], s36 offen offset:2048 lds
  buffer_load_dwordx4 v11, s[12:15], s36 offen offset:3072 lds
  s_add_u32 m0, s38, 45056
  s_nop 0
  buffer_load_dwordx4 v12, s[12:15], s36 offen offset:0 lds
  buffer_load_dwordx4 v13, s[12:15], s36 offen offset:1024 lds
  s_add_u32 s36, s36, 221184
  s_add_u32 s37, s37, 128
  ds_read_b64_tr_b16 v[40:41], v22 offset:0
  ds_read_b64_tr_b16 v[42:43], v22 offset:1536
  ds_read_b64_tr_b16 v[44:45], v22 offset:128
  ds_read_b64_tr_b16 v[46:47], v22 offset:1664
  ds_read_b64_tr_b16 v[48:49], v22 offset:256
  ds_read_b64_tr_b16 v[50:51], v22 offset:1792
  ds_read_b64_tr_b16 v[52:53], v22 offset:12288
  ds_read_b64_tr_b16 v[54:55], v22 offset:13824
  ds_read_b64_tr_b16 v[56:57], v22 offset:12416
  ds_read_b64_tr_b16 v[58:59], v22 offset:13952
  ds_read_b64_tr_b16 v[60:61], v22 offset:12544
  ds_read_b64_tr_b16 v[62:63], v22 offset:14080
  s_waitcnt lgkmcnt(0)
  v_mfma_f32_16x16x32_bf16 v[28:31], v[24:27], v[40:43], v[28:31]
  v_mfma_f32_16x16x32_bf16 v[32:35], v[24:27], v[44:47], v[32:35]
  v_mfma_f32_16x16x32_bf16 v[36:39], v[24:27], v[48:51], v[36:39]
  v_mfma_f32_16x16x32_bf16 v[28:31], v[24:27], v[52:55], v[28:31]
  v_mfma_f32_16x16x32_bf16 v[32:35], v[24:27], v[56:59], v[32:35]
  v_mfma_f32_16x16x32_bf16 v[36:39], v[24:27], v[60:63], v[36:39]
  s_waitcnt vmcnt(10)
  s_barrier
  s_add_u32 m0, s39, 81920
  s_nop 0
  buffer_load_dwordx4 v14, s[8:11], s37 offen offset:0 lds
  buffer_load_dwordx4 v15, s[8:11], s37 offen offset:1024 lds
  buffer_load_dwordx4 v16, s[8:11], s37 offen offset:2048 lds
  buffer_load_dwordx4 v17, s[8:11], s37 offen offset:3072 lds
  s_add_u32 m0, s38, 81920
  s_nop 0
  buffer_load_dwordx4 v8, s[12:15], s36 offen offset:0 lds
  buffer_load_dwordx4 v9, s[12:15], s36 offen offset:1024 lds
  buffer_load_dwordx4 v10, s[12:15], s36 offen offset:2048 lds
  buffer_load_dwordx4 v11, s[12:15], s36 offen offset:3072 lds
  s_add_u32 m0, s38, 86016
  s_nop 0
  buffer_load_dwordx4 v12, s[12:15], s36 offen offset:0 lds
  buffer_load_dwordx4 v13, s[12:15], s36 offen offset:1024 lds
  s_add_u32 s36, s36, 221184
  s_add_u32 s37, s37, 128
  ds_read_b64_tr_b16 v[40:41], v20 offset:0
  ds_read_b64_tr_b16 v[42:43], v20 offset:1536
  ds_read_b64_tr_b16 v[44:45], v20 offset:128
  ds_read_b64_tr_b16 v[46:47], v20 offset:1664
  ds_read_b64_tr_b16 v[48:49], v20 offset:256
  ds_read_b64_tr_b16 v[50:51], v20 offset:1792
  ds_read_b64_tr_b16 v[52:53], v20 offset:12288
  ds_read_b64_tr_b16 v[54:55], v20 offset:13824
  ds_read_b64_tr_b16 v[56:57], v20 offset:12416
  ds_read_b64_tr_b16 v[58:59], v20 offset:13952
  ds_read_b64_tr_b16 v[60:61], v20 offset:12544
  ds_read_b64_tr_b16 v[62:63], v20 offset:14080
  s_waitcnt lgkmcnt(0)
  v_mfma_f32_16x16x32_bf16 v[28:31], v[24:27], v[40:43], v[28:31]
  v_mfma_f32_16x16x32_bf16 v[32:35], v[24:27], v[44:47], v[32:35]
  v_mfma_f32_16x16x32_bf16 v[36:39], v[24:27], v[48:51], v[36:39]
  v_mfma_f32_16x16x32_bf16 v[28:31], v[24:27], v[52:55], v[28:31]
  v_mfma_f32_16x16x32_bf16 v[32:35], v[24:27], v[56:59], v[32:35]
  v_mfma_f32_16x16x32_bf16 v[36:39], v[24:27], v[60:63], v[36:39]
  s_waitcnt vmcnt(10)
  s_barrier
  ds_read_b64_tr_b16 v[40:41], v21 offset:0
  ds_read_b64_tr_b16 v[42:43], v21 offset:1536
  ds_read_b64_tr_b16 v[44:45], v21 offset:128
  ds_read_b64_tr_b16 v[46:47], v21 offset:1664
  ds_read_b64_tr_b16 v[48:49], v21 offset:256
  ds_read_b64_tr_b16 v[50:51], v21 offset:1792
  ds_read_b64_tr_b16 v[52:53], v21 offset:12288
  ds_read_b64_tr_b16 v[54:55], v21 offset:13824
  ds_read_b64_tr_b16 v[56:57], v21 offset:12416
  ds_read_b64_tr_b16 v[58:59], v21 offset:13952
  ds_read_b64_tr_b16 v[60:61], v21 offset:12544
  ds_read_b64_tr_b16 v[62:63], v21 offset:14080
  s_waitcnt lgkmcnt(0)
  v_mfma_f32_16x16x32_bf16 v[28:31], v[24:27], v[40:43], v[28:31]
  v_mfma_f32_16x16x32_bf16 v[32:35], v[24:27], v[44:47], v[32:35]
  v_mfma_f32_16x16x32_bf16 v[36:39], v[24:27], v[48:51], v[36:39]
  v_mfma_f32_16x16x32_bf16 v[28:31], v[24:27], v[52:55], v[28:31]
  v_mfma_f32_16x16x32_bf16 v[32:35], v[24:27], v[56:59], v[32:35]
  v_mfma_f32_16x16x32_bf16 v[36:39], v[24:27], v[60:63], v[36:39]
  s_waitcnt vmcnt(0)
  s_barrier
  ds_read_b64_tr_b16 v[40:41], v22 offset:0
  ds_read_b64_tr_b16 v[42:43], v22 offset:1536
  ds_read_b64_tr_b16 v[44:45], v22 offset:128
  ds_read_b64_tr_b16 v[46:47], v22 offset:1664
  ds_read_b64_tr_b16 v[48:49], v22 offset:256
  ds_read_b64_tr_b16 v[50:51], v22 offset:1792
  ds_read_b64_tr_b16 v[52:53], v22 offset:12288
  ds_read_b64_tr_b16 v[54:55], v22 offset:13824
  ds_read_b64_tr_b16 v[56:57], v22 offset:12416
  ds_read_b64_tr_b16 v[58:59], v22 offset:13952
  ds_read_b64_tr_b16 v[60:61], v22 offset:12544
  ds_read_b64_tr_b16 v[62:63], v22 offset:14080
  s_waitcnt lgkmcnt(0)
  v_mfma_f32_16x16x32_bf16 v[28:31], v[24:27], v[40:43], v[28:31]
  v_mfma_f32_16x16x32_bf16 v[32:35], v[24:27], v[44:47], v[32:35]
  v_mfma_f32_16x16x32_bf16 v[36:39], v[24:27], v[48:51], v[36:39]
  v_mfma_f32_16x16x32_bf16 v[28:31], v[24:27], v[52:55], v[28:31]
  v_mfma_f32_16x16x32_bf16 v[32:35], v[24:27], v[56:59], v[32:35]
  v_mfma_f32_16x16x32_bf16 v[36:39], v[24:27], v[60:63], v[36:39]
  v_and_b32 v1, 15, v0
  v_lshlrev_b32 v1, 2, v1
  s_lshl_b32 s38, s33, 6
  s_add_u32 s38, s38, 0
  v_add_u32 v1, s38, v1
  s_nop 0
  ds_write_b32 v1, v28 offset:0
  ds_write_b32 v1, v32 offset:256
  ds_write_b32 v1, v36 offset:512
  s_waitcnt lgkmcnt(0)
  s_barrier
  s_endpgm
k0_pf:
  s_mul_i32 s46, s4, 6
  s_add_u32 s46, s46, s5
  s_sub_u32 s46, s46, 26
  s_lshl_b32 s46, s46, 3
  s_add_u32 s46, s46, s3
  v_lshlrev_b32 v1, 7, v0
  s_lshl_b32 s47, s46, 13
  s_cmp_ge_u32 s46, 243
  s_cselect_b32 s46, 1990656, 0
  s_sub_u32 s46, s47, s46
  buffer_load_dword v3, v1, s[12:15], s46 offen
  s_mov_b32 s46, 12582912
  s_waitcnt vmcnt(0)
k0_pf2:
  buffer_load_dword v3, v1, s[48:51], s47 offen
  s_add_u32 s47, s47, 3145728
  s_cmp_lt_u32 s47, s46
  s_cbranch_scc1 k0_pf2
  s_waitcnt vmcnt(0)
  s_endpgm
k0_ln:
  s_lshl_b32 s6, s4, 3
  s_add_u32 s6, s6, s5
  s_sub_u32 s6, s6, 18
  v_lshrrev_b32 v1, 4, v0
  v_and_b32 v2, 15, v0
  s_lshl_b32 s7, s3, 2
  v_add_u32 v3, s7, v1
  v_mul_u32_u24 v4, 1152, v3
  v_lshl_add_u32 v4, v2, 3, v4
  v_mul_u32_u24 v5, 1184, v3
  v_lshl_add_u32 v5, v2, 3, v5
  s_mul_i32 s32, s6, 36864
  v_mov_b32 v8, 0
  v_mov_b32 v9, 0
  v_mov_b32 v10, 0
  v_mov_b32 v11, 0
  v_lshrrev_b32 v6, 3, v0
  v_mul_u32_u24 v6, 4224, v6
  v_and_b32 v7, 7, v0
  v_lshl_add_u32 v6, v7, 4, v6
  s_lshr_b32 s34, s3, 1
  s_mul_i32 s33, s6, 9
  s_add_u32 s33, s33, s34
  s_mul_i32 s33, s33, 4224
  s_add_u32 s33, s33, 8192
  s_and_b32 s34, s3, 5
  s_cmp_eq_u32 s34, 0
  s_cbranch_scc0 k0_ln_nf
  buffer_store_dwordx4 v[8:11], v6, s[16:19], s33 offen
k0_ln_nf:
  v_mov_b32 v12, 0x3f803f80
  v_mov_b32 v13, 0x3f803f80
  v_mov_b32 v14, 0x3f803f80
  v_mov_b32 v15, 0x3f803f80
  v_bfe_u32 v6, v0, 1, 1
  v_mul_u32_u24 v6, 18464, v6
  v_and_b32 v7, 1, v0
  v_lshl_add_u32 v6, v7, 4, v6
  s_mul_i32 s33, s6, 36928
  s_add_u32 s33, s33, 15616000
  s_cmp_eq_u32 s3, 1
  s_cbranch_scc0 k0_ln_no
  buffer_store_dwordx4 v[12:15], v6, s[16:19], s33 offen
k0_ln_no:
  buffer_load_dwordx2 v[16:17], v4, s[8:11], s32 offen offset:0
  buffer_load_dwordx2 v[18:19], v4, s[8:11], s32 offen offset:128
  buffer_load_dwordx2 v[20:21], v4, s[8:11], s32 offen offset:256
  buffer_load_dwordx2 v[22:23], v4, s[8:11], s32 offen offset:384
  buffer_load_dwordx2 v[24:25], v4, s[8:11], s32 offen offset:512
  buffer_load_dwordx2 v[26:27], v4, s[8:11], s32 offen offset:640
  buffer_load_dwordx2 v[28:29], v4, s[8:11], s32 offen offset:768
  buffer_load_dwordx2 v[30:31], v4, s[8:11], s32 offen offset:896
  buffer_load_dwordx2 v[32:33], v4, s[8:11], s32 offen offset:1024
  buffer_load_dwordx2 v[34:35], v4, s[20:23], s32 offen offset:0
  buffer_load_dwordx2 v[36:37], v4, s[20:23], s32 offen offset:128
  buffer_load_dwordx2 v[38:39], v4, s[20:23], s32 offen offset:256
  buffer_load_dwordx2 v[40:41], v4, s[20:23], s32 offen offset:384
  buffer_load_dwordx2 v[42:43], v4, s[20:23], s32 offen offset:512
  buffer_load_dwordx2 v[44:45], v4, s[20:23], s32 offen offset:640
  buffer_load_dwordx2 v[46:47], v4, s[20:23], s32 offen offset:768
  buffer_load_dwordx2 v[48:49], v4, s[20:23], s32 offen offset:896
  buffer_load_dwordx2 v[50:51], v4, s[20:23], s32 offen offset:1024
  s_lshl_b32 s46, s6, 3
  s_add_u32 s46, s46, s3
  s_add_u32 s46, s46, 1536
  s_lshl_b32 s46, s46, 13
  v_lshlrev_b32 v92, 7, v0
  s_waitcnt vmcnt(9)
  buffer_load_dword v93, v92, s[48:51], s46 offen
  s_add_u32 s46, s46, 4194304
  v_lshlrev_b32 v52, 16, v16
  v_and_b32 v53, 0xffff0000, v16
  v_lshlrev_b32 v54, 16, v17
  v_and_b32 v55, 0xffff0000, v17
  v_lshlrev_b32 v56, 16, v18
  v_and_b32 v57, 0xffff0000, v18
  v_lshlrev_b32 v58, 16, v19
  v_and_b32 v59, 0xffff0000, v19
  v_lshlrev_b32 v60, 16, v20
  v_and_b32 v61, 0xffff0000, v20
  v_lshlrev_b32 v62, 16, v21
  v_and_b32 v63, 0xffff0000, v21
  v_lshlrev_b32 v64, 16, v22
  v_and_b32 v65, 0xffff0000, v22
  v_lshlrev_b32 v66, 16, v23
  v_and_b32 v67, 0xffff0000, v23
  v_lshlrev_b32 v68, 16, v24
  v_and_b32 v69, 0xffff0000, v24
  v_lshlrev_b32 v70, 16, v25
  v_and_b32 v71, 0xffff0000, v25
  v_lshlrev_b32 v72, 16, v26
  v_and_b32 v73, 0xffff0000, v26
  v_lshlrev_b32 v74, 16, v27
  v_and_b32 v75, 0xffff0000, v27
  v_lshlrev_b32 v76, 16, v28
  v_and_b32 v77, 0xffff0000, v28
  v_lshlrev_b32 v78, 16, v29
  v_and_b32 v79, 0xffff0000, v29
  v_lshlrev_b32 v80, 16, v30
  v_and_b32 v81, 0xffff0000, v30
  v_lshlrev_b32 v82, 16, v31
  v_and_b32 v83, 0xffff0000, v31
  v_lshlrev_b32 v84, 16, v32
  v_and_b32 v85, 0xffff0000, v32
  v_lshlrev_b32 v86, 16, v33
  v_and_b32 v87, 0xffff0000, v33
  v_pk_add_f32 v[8:9], v[52:53], v[54:55]
  v_pk_add_f32 v[10:11], v[56:57], v[58:59]
  v_pk_add_f32 v[8:9], v[8:9], v[60:61]
  v_pk_add_f32 v[10:11], v[10:11], v[62:63]
  v_pk_add_f32 v[8:9], v[8:9], v[64:65]
  v_pk_add_f32 v[10:11], v[10:11], v[66:67]
  v_pk_add_f32 v[8:9], v[8:9], v[68:69]
  v_pk_add_f32 v[10:11], v[10:11], v[70:71]
  v_pk_add_f32 v[8:9], v[8:9], v[72:73]
  v_pk_add_f32 v[10:11], v[10:11], v[74:75]
  v_pk_add_f32 v[8:9], v[8:9], v[76:77]
  v_pk_add_f32 v[10:11], v[10:11], v[78:79]
  v_pk_add_f32 v[8:9], v[8:9], v[80:81]
  v_pk_add_f32 v[10:11], v[10:11], v[82:83]
  v_pk_add_f32 v[8:9], v[8:9], v[84:85]
  v_pk_add_f32 v[10:11], v[10:11], v[86:87]
  v_pk_add_f32 v[8:9], v[8:9], v[10:11]
  v_add_f32 v8, v8, v9
  s_nop 1
  v_add_f32_dpp v8, v8, v8 quad_perm:[1,0,3,2] row_mask:0xf bank_mask:0xf
  s_nop 1
  v_add_f32_dpp v8, v8, v8 quad_perm:[2,3,0,1] row_mask:0xf bank_mask:0xf
  s_nop 1
  v_add_f32_dpp v8, v8, v8 row_half_mirror row_mask:0xf bank_mask:0xf
  s_nop 1
  v_add_f32_dpp v8, v8, v8 row_mirror row_mask:0xf bank_mask:0xf
  v_mul_f32 v12, 0x3ae38e39, v8
  v_sub_f32 v14, 0, v12
  v_mov_b32 v8, 0
  v_mov_b32 v9, 0
  v_mov_b32 v10, 0
  v_mov_b32 v11, 0
  v_pk_add_f32 v[88:89], v[52:53], v[14:15] op_sel_hi:[1,0]
  s_nop 0
  v_pk_fma_f32 v[8:9], v[88:89], v[88:89], v[8:9]
  v_pk_add_f32 v[90:91], v[54:55], v[14:15] op_sel_hi:[1,0]
  s_nop 0
  v_pk_fma_f32 v[10:11], v[90:91], v[90:91], v[10:11]
  v_pk_add_f32 v[88:89], v[56:57], v[14:15] op_sel_hi:[1,0]
  s_nop 0
  v_pk_fma_f32 v[8:9], v[88:89], v[88:89], v[8:9]
  v_pk_add_f32 v[90:91], v[58:59], v[14:15] op_sel_hi:[1,0]
  s_nop 0
  v_pk_fma_f32 v[10:11], v[90:91], v[90:91], v[10:11]
  v_pk_add_f32 v[88:89], v[60:61], v[14:15] op_sel_hi:[1,0]
  s_nop 0
  v_pk_fma_f32 v[8:9], v[88:89], v[88:89], v[8:9]
  v_pk_add_f32 v[90:91], v[62:63], v[14:15] op_sel_hi:[1,0]
  s_nop 0
  v_pk_fma_f32 v[10:11], v[90:91], v[90:91], v[10:11]
  v_pk_add_f32 v[88:89], v[64:65], v[14:15] op_sel_hi:[1,0]
  s_nop 0
  v_pk_fma_f32 v[8:9], v[88:89], v[88:89], v[8:9]
  v_pk_add_f32 v[90:91], v[66:67], v[14:15] op_sel_hi:[1,0]
  s_nop 0
  v_pk_fma_f32 v[10:11], v[90:91], v[90:91], v[10:11]
  v_pk_add_f32 v[88:89], v[68:69], v[14:15] op_sel_hi:[1,0]
  s_nop 0
  v_pk_fma_f32 v[8:9], v[88:89], v[88:89], v[8:9]
  v_pk_add_f32 v[90:91], v[70:71], v[14:15] op_sel_hi:[1,0]
  s_nop 0
  v_pk_fma_f32 v[10:11], v[90:91], v[90:91], v[10:11]
  v_pk_add_f32 v[88:89], v[72:73], v[14:15] op_sel_hi:[1,0]
  s_nop 0
  v_pk_fma_f32 v[8:9], v[88:89], v[88:89], v[8:9]
  v_pk_add_f32 v[90:91], v[74:75], v[14:15] op_sel_hi:[1,0]
  s_nop 0
  v_pk_fma_f32 v[10:11], v[90:91], v[90:91], v[10:11]
  v_pk_add_f32 v[88:89], v[76:77], v[14:15] op_sel_hi:[1,0]
  s_nop 0
  v_pk_fma_f32 v[8:9], v[88:89], v[88:89], v[8:9]
  v_pk_add_f32 v[90:91], v[78:79], v[14:15] op_sel_hi:[1,0]
  s_nop 0
  v_pk_fma_f32 v[10:11], v[90:91], v[90:91], v[10:11]
  v_pk_add_f32 v[88:89], v[80:81], v[14:15] op_sel_hi:[1,0]
  s_nop 0
  v_pk_fma_f32 v[8:9], v[88:89], v[88:89], v[8:9]
  v_pk_add_f32 v[90:91], v[82:83], v[14:15] op_sel_hi:[1,0]
  s_nop 0
  v_pk_fma_f32 v[10:11], v[90:91], v[90:91], v[10:11]
  v_pk_add_f32 v[88:89], v[84:85], v[14:15] op_sel_hi:[1,0]
  s_nop 0
  v_pk_fma_f32 v[8:9], v[88:89], v[88:89], v[8:9]
  v_pk_add_f32 v[90:91], v[86:87], v[14:15] op_sel_hi:[1,0]
  s_nop 0
  v_pk_fma_f32 v[10:11], v[90:91], v[90:91], v[10:11]
  v_pk_add_f32 v[8:9], v[8:9], v[10:11]
  v_add_f32 v8, v8, v9
  s_nop 1
  v_add_f32_dpp v8, v8, v8 quad_perm:[1,0,3,2] row_mask:0xf bank_mask:0xf
  s_nop 1
  v_add_f32_dpp v8, v8, v8 quad_perm:[2,3,0,1] row_mask:0xf bank_mask:0xf
  s_nop 1
  v_add_f32_dpp v8, v8, v8 row_half_mirror row_mask:0xf bank_mask:0xf
  s_nop 1
  v_add_f32_dpp v8, v8, v8 row_mirror row_mask:0xf bank_mask:0xf
  v_mul_f32 v10, 0x3ae38e39, v8
  v_cvt_pk_bf16_f32 v12, v12, v12
  v_lshlrev_b32 v12, 16, v12
  v_cvt_pk_bf16_f32 v10, v10, v10
  v_lshlrev_b32 v10, 16, v10
  v_add_f32 v10, 0x3727c5ac, v10
  v_cvt_pk_bf16_f32 v10, v10, v10
  v_lshlrev_b32 v10, 16, v10
  v_sqrt_f32 v10, v10
  s_nop 0
  v_cvt_pk_bf16_f32 v10, v10, v10
  v_lshlrev_b32 v10, 16, v10
  v_rcp_f32 v10, v10
  v_sub_f32 v14, 0, v12
  v_pk_add_f32 v[52:53], v[52:53], v[14:15] op_sel_hi:[1,0]
  s_nop 0
  v_cvt_pk_bf16_f32 v16, v52, v53
  v_pk_add_f32 v[54:55], v[54:55], v[14:15] op_sel_hi:[1,0]
  s_nop 0
  v_cvt_pk_bf16_f32 v17, v54, v55
  v_pk_add_f32 v[56:57], v[56:57], v[14:15] op_sel_hi:[1,0]
  s_nop 0
  v_cvt_pk_bf16_f32 v18, v56, v57
  v_pk_add_f32 v[58:59], v[58:59], v[14:15] op_sel_hi:[1,0]
  s_nop 0
  v_cvt_pk_bf16_f32 v19, v58, v59
  v_pk_add_f32 v[60:61], v[60:61], v[14:15] op_sel_hi:[1,0]
  s_nop 0
  v_cvt_pk_bf16_f32 v20, v60, v61
  v_pk_add_f32 v[62:63], v[62:63], v[14:15] op_sel_hi:[1,0]
  s_nop 0
  v_cvt_pk_bf16_f32 v21, v62, v63
  v_pk_add_f32 v[64:65], v[64:65], v[14:15] op_sel_hi:[1,0]
  s_nop 0
  v_cvt_pk_bf16_f32 v22, v64, v65
  v_pk_add_f32 v[66:67], v[66:67], v[14:15] op_sel_hi:[1,0]
  s_nop 0
  v_cvt_pk_bf16_f32 v23, v66, v67
  v_pk_add_f32 v[68:69], v[68:69], v[14:15] op_sel_hi:[1,0]
  s_nop 0
  v_cvt_pk_bf16_f32 v24, v68, v69
  v_pk_add_f32 v[70:71], v[70:71], v[14:15] op_sel_hi:[1,0]
  s_nop 0
  v_cvt_pk_bf16_f32 v25, v70, v71
  v_pk_add_f32 v[72:73], v[72:73], v[14:15] op_sel_hi:[1,0]
  s_nop 0
  v_cvt_pk_bf16_f32 v26, v72, v73
  v_pk_add_f32 v[74:75], v[74:75], v[14:15] op_sel_hi:[1,0]
  s_nop 0
  v_cvt_pk_bf16_f32 v27, v74, v75
  v_pk_add_f32 v[76:77], v[76:77], v[14:15] op_sel_hi:[1,0]
  s_nop 0
  v_cvt_pk_bf16_f32 v28, v76, v77
  v_pk_add_f32 v[78:79], v[78:79], v[14:15] op_sel_hi:[1,0]
  s_nop 0
  v_cvt_pk_bf16_f32 v29, v78, v79
  v_pk_add_f32 v[80:81], v[80:81], v[14:15] op_sel_hi:[1,0]
  s_nop 0
  v_cvt_pk_bf16_f32 v30, v80, v81
  v_pk_add_f32 v[82:83], v[82:83], v[14:15] op_sel_hi:[1,0]
  s_nop 0
  v_cvt_pk_bf16_f32 v31, v82, v83
  v_pk_add_f32 v[84:85], v[84:85], v[14:15] op_sel_hi:[1,0]
  s_nop 0
  v_cvt_pk_bf16_f32 v32, v84, v85
  v_pk_add_f32 v[86:87], v[86:87], v[14:15] op_sel_hi:[1,0]
  s_nop 0
  v_cvt_pk_bf16_f32 v33, v86, v87
  v_lshlrev_b32 v52, 16, v16
  v_and_b32 v53, 0xffff0000, v16
  v_lshlrev_b32 v54, 16, v17
  v_and_b32 v55, 0xffff0000, v17
  v_lshlrev_b32 v56, 16, v18
  v_and_b32 v57, 0xffff0000, v18
  v_lshlrev_b32 v58, 16, v19
  v_and_b32 v59, 0xffff0000, v19
  v_lshlrev_b32 v60, 16, v20
  v_and_b32 v61, 0xffff0000, v20
  v_lshlrev_b32 v62, 16, v21
  v_and_b32 v63, 0xffff0000, v21
  v_lshlrev_b32 v64, 16, v22
  v_and_b32 v65, 0xffff0000, v22
  v_lshlrev_b32 v66, 16, v23
  v_and_b32 v67, 0xffff0000, v23
  v_lshlrev_b32 v68, 16, v24
  v_and_b32 v69, 0xffff0000, v24
  v_lshlrev_b32 v70, 16, v25
  v_and_b32 v71, 0xffff0000, v25
  v_lshlrev_b32 v72, 16, v26
  v_and_b32 v73, 0xffff0000, v26
  v_lshlrev_b32 v74, 16, v27
  v_and_b32 v75, 0xffff0000, v27
  v_lshlrev_b32 v76, 16, v28
  v_and_b32 v77, 0xffff0000, v28
  v_lshlrev_b32 v78, 16, v29
  v_and_b32 v79, 0xffff0000, v29
  v_lshlrev_b32 v80, 16, v30
  v_and_b32 v81, 0xffff0000, v30
  v_lshlrev_b32 v82, 16, v31
  v_and_b32 v83, 0xffff0000, v31
  v_lshlrev_b32 v84, 16, v32
  v_and_b32 v85, 0xffff0000, v32
  v_lshlrev_b32 v86, 16, v33
  v_and_b32 v87, 0xffff0000, v33
  v_pk_mul_f32 v[52:53], v[52:53], v[10:11] op_sel_hi:[1,0]
  s_nop 0
  v_cvt_pk_bf16_f32 v16, v52, v53
  v_pk_mul_f32 v[54:55], v[54:55], v[10:11] op_sel_hi:[1,0]
  s_nop 0
  v_cvt_pk_bf16_f32 v17, v54, v55
  v_pk_mul_f32 v[56:57], v[56:57], v[10:11] op_sel_hi:[1,0]
  s_nop 0
  v_cvt_pk_bf16_f32 v18, v56, v57
  v_pk_mul_f32 v[58:59], v[58:59], v[10:11] op_sel_hi:[1,0]
  s_nop 0
  v_cvt_pk_bf16_f32 v19, v58, v59
  v_pk_mul_f32 v[60:61], v[60:61], v[10:11] op_sel_hi:[1,0]
  s_nop 0
  v_cvt_pk_bf16_f32 v20, v60, v61
  v_pk_mul_f32 v[62:63], v[62:63], v[10:11] op_sel_hi:[1,0]
  s_nop 0
  v_cvt_pk_bf16_f32 v21, v62, v63
  v_pk_mul_f32 v[64:65], v[64:65], v[10:11] op_sel_hi:[1,0]
  s_nop 0
  v_cvt_pk_bf16_f32 v22, v64, v65
  v_pk_mul_f32 v[66:67], v[66:67], v[10:11] op_sel_hi:[1,0]
  s_nop 0
  v_cvt_pk_bf16_f32 v23, v66, v67
  v_pk_mul_f32 v[68:69], v[68:69], v[10:11] op_sel_hi:[1,0]
  s_nop 0
  v_cvt_pk_bf16_f32 v24, v68, v69
  v_pk_mul_f32 v[70:71], v[70:71], v[10:11] op_sel_hi:[1,0]
  s_nop 0
  v_cvt_pk_bf16_f32 v25, v70, v71
  v_pk_mul_f32 v[72:73], v[72:73], v[10:11] op_sel_hi:[1,0]
  s_nop 0
  v_cvt_pk_bf16_f32 v26, v72, v73
  v_pk_mul_f32 v[74:75], v[74:75], v[10:11] op_sel_hi:[1,0]
  s_nop 0
  v_cvt_pk_bf16_f32 v27, v74, v75
  v_pk_mul_f32 v[76:77], v[76:77], v[10:11] op_sel_hi:[1,0]
  s_nop 0
  v_cvt_pk_bf16_f32 v28, v76, v77
  v_pk_mul_f32 v[78:79], v[78:79], v[10:11] op_sel_hi:[1,0]
  s_nop 0
  v_cvt_pk_bf16_f32 v29, v78, v79
  v_pk_mul_f32 v[80:81], v[80:81], v[10:11] op_sel_hi:[1,0]
  s_nop 0
  v_cvt_pk_bf16_f32 v30, v80, v81
  v_pk_mul_f32 v[82:83], v[82:83], v[10:11] op_sel_hi:[1,0]
  s_nop 0
  v_cvt_pk_bf16_f32 v31, v82, v83
  v_pk_mul_f32 v[84:85], v[84:85], v[10:11] op_sel_hi:[1,0]
  s_nop 0
  v_cvt_pk_bf16_f32 v32, v84, v85
  v_pk_mul_f32 v[86:87], v[86:87], v[10:11] op_sel_hi:[1,0]
  s_nop 0
  v_cvt_pk_bf16_f32 v33, v86, v87
  v_lshlrev_b32 v52, 16, v16
  v_and_b32 v53, 0xffff0000, v16
  v_lshlrev_b32 v54, 16, v17
  v_and_b32 v55, 0xffff0000, v17
  v_lshlrev_b32 v56, 16, v18
  v_and_b32 v57, 0xffff0000, v18
  v_lshlrev_b32 v58, 16, v19
  v_and_b32 v59, 0xffff0000, v19
  v_lshlrev_b32 v60, 16, v20
  v_and_b32 v61, 0xffff0000, v20
  v_lshlrev_b32 v62, 16, v21
  v_and_b32 v63, 0xffff0000, v21
  v_lshlrev_b32 v64, 16, v22
  v_and_b32 v65, 0xffff0000, v22
  v_lshlrev_b32 v66, 16, v23
  v_and_b32 v67, 0xffff0000, v23
  v_lshlrev_b32 v68, 16, v24
  v_and_b32 v69, 0xffff0000, v24
  v_lshlrev_b32 v70, 16, v25
  v_and_b32 v71, 0xffff0000, v25
  v_lshlrev_b32 v72, 16, v26
  v_and_b32 v73, 0xffff0000, v26
  v_lshlrev_b32 v74, 16, v27
  v_and_b32 v75, 0xffff0000, v27
  v_lshlrev_b32 v76, 16, v28
  v_and_b32 v77, 0xffff0000, v28
  v_lshlrev_b32 v78, 16, v29
  v_and_b32 v79, 0xffff0000, v29
  v_lshlrev_b32 v80, 16, v30
  v_and_b32 v81, 0xffff0000, v30
  v_lshlrev_b32 v82, 16, v31
  v_and_b32 v83, 0xffff0000, v31
  v_lshlrev_b32 v84, 16, v32
  v_and_b32 v85, 0xffff0000, v32
  v_lshlrev_b32 v86, 16, v33
  v_and_b32 v87, 0xffff0000, v33
  v_pk_add_f32 v[8:9], v[52:53], v[54:55]
  v_pk_add_f32 v[10:11], v[56:57], v[58:59]
  v_pk_add_f32 v[8:9], v[8:9], v[60:61]
  v_pk_add_f32 v[10:11], v[10:11], v[62:63]
  v_pk_add_f32 v[8:9], v[8:9], v[64:65]
  v_pk_add_f32 v[10:11], v[10:11], v[66:67]
  v_pk_add_f32 v[8:9], v[8:9], v[68:69]
  v_pk_add_f32 v[10:11], v[10:11], v[70:71]
  v_pk_add_f32 v[8:9], v[8:9], v[72:73]
  v_pk_add_f32 v[10:11], v[10:11], v[74:75]
  v_pk_add_f32 v[8:9], v[8:9], v[76:77]
  v_pk_add_f32 v[10:11], v[10:11], v[78:79]
  v_pk_add_f32 v[8:9], v[8:9], v[80:81]
  v_pk_add_f32 v[10:11], v[10:11], v[82:83]
  v_pk_add_f32 v[8:9], v[8:9], v[84:85]
  v_pk_add_f32 v[10:11], v[10:11], v[86:87]
  v_pk_add_f32 v[8:9], v[8:9], v[10:11]
  v_add_f32 v8, v8, v9
  s_nop 1
  v_add_f32_dpp v8, v8, v8 quad_perm:[1,0,3,2] row_mask:0xf bank_mask:0xf
  s_nop 1
  v_add_f32_dpp v8, v8, v8 quad_perm:[2,3,0,1] row_mask:0xf bank_mask:0xf
  s_nop 1
  v_add_f32_dpp v8, v8, v8 row_half_mirror row_mask:0xf bank_mask:0xf
  s_nop 1
  v_add_f32_dpp v8, v8, v8 row_mirror row_mask:0xf bank_mask:0xf
  v_mul_f32 v12, 0x3ae38e39, v8
  v_sub_f32 v14, 0, v12
  v_mov_b32 v8, 0
  v_mov_b32 v9, 0
  v_mov_b32 v10, 0
  v_mov_b32 v11, 0
  v_pk_add_f32 v[88:89], v[52:53], v[14:15] op_sel_hi:[1,0]
  s_nop 0
  v_pk_fma_f32 v[8:9], v[88:89], v[88:89], v[8:9]
  v_pk_add_f32 v[90:91], v[54:55], v[14:15] op_sel_hi:[1,0]
  s_nop 0
  v_pk_fma_f32 v[10:11], v[90:91], v[90:91], v[10:11]
  v_pk_add_f32 v[88:89], v[56:57], v[14:15] op_sel_hi:[1,0]
  s_nop 0
  v_pk_fma_f32 v[8:9], v[88:89], v[88:89], v[8:9]
  v_pk_add_f32 v[90:91], v[58:59], v[14:15] op_sel_hi:[1,0]
  s_nop 0
  v_pk_fma_f32 v[10:11], v[90:91], v[90:91], v[10:11]
  v_pk_add_f32 v[88:89], v[60:61], v[14:15] op_sel_hi:[1,0]
  s_nop 0
  v_pk_fma_f32 v[8:9], v[88:89], v[88:89], v[8:9]
  v_pk_add_f32 v[90:91], v[62:63], v[14:15] op_sel_hi:[1,0]
  s_nop 0
  v_pk_fma_f32 v[10:11], v[90:91], v[90:91], v[10:11]
  v_pk_add_f32 v[88:89], v[64:65], v[14:15] op_sel_hi:[1,0]
  s_nop 0
  v_pk_fma_f32 v[8:9], v[88:89], v[88:89], v[8:9]
  v_pk_add_f32 v[90:91], v[66:67], v[14:15] op_sel_hi:[1,0]
  s_nop 0
  v_pk_fma_f32 v[10:11], v[90:91], v[90:91], v[10:11]
  v_pk_add_f32 v[88:89], v[68:69], v[14:15] op_sel_hi:[1,0]
  s_nop 0
  v_pk_fma_f32 v[8:9], v[88:89], v[88:89], v[8:9]
  v_pk_add_f32 v[90:91], v[70:71], v[14:15] op_sel_hi:[1,0]
  s_nop 0
  v_pk_fma_f32 v[10:11], v[90:91], v[90:91], v[10:11]
  v_pk_add_f32 v[88:89], v[72:73], v[14:15] op_sel_hi:[1,0]
  s_nop 0
  v_pk_fma_f32 v[8:9], v[88:89], v[88:89], v[8:9]
  v_pk_add_f32 v[90:91], v[74:75], v[14:15] op_sel_hi:[1,0]
  s_nop 0
  v_pk_fma_f32 v[10:11], v[90:91], v[90:91], v[10:11]
  v_pk_add_f32 v[88:89], v[76:77], v[14:15] op_sel_hi:[1,0]
  s_nop 0
  v_pk_fma_f32 v[8:9], v[88:89], v[88:89], v[8:9]
  v_pk_add_f32 v[90:91], v[78:79], v[14:15] op_sel_hi:[1,0]
  s_nop 0
  v_pk_fma_f32 v[10:11], v[90:91], v[90:91], v[10:11]
  v_pk_add_f32 v[88:89], v[80:81], v[14:15] op_sel_hi:[1,0]
  s_nop 0
  v_pk_fma_f32 v[8:9], v[88:89], v[88:89], v[8:9]
  v_pk_add_f32 v[90:91], v[82:83], v[14:15] op_sel_hi:[1,0]
  s_nop 0
  v_pk_fma_f32 v[10:11], v[90:91], v[90:91], v[10:11]
  v_pk_add_f32 v[88:89], v[84:85], v[14:15] op_sel_hi:[1,0]
  s_nop 0
  v_pk_fma_f32 v[8:9], v[88:89], v[88:89], v[8:9]
  v_pk_add_f32 v[90:91], v[86:87], v[14:15] op_sel_hi:[1,0]
  s_nop 0
  v_pk_fma_f32 v[10:11], v[90:91], v[90:91], v[10:11]
  v_pk_add_f32 v[8:9], v[8:9], v[10:11]
  v_add_f32 v8, v8, v9
  s_nop 1
  v_add_f32_dpp v8, v8, v8 quad_perm:[1,0,3,2] row_mask:0xf bank_mask:0xf
  s_nop 1
  v_add_f32_dpp v8, v8, v8 quad_perm:[2,3,0,1] row_mask:0xf bank_mask:0xf
  s_nop 1
  v_add_f32_dpp v8, v8, v8 row_half_mirror row_mask:0xf bank_mask:0xf
  s_nop 1
  v_add_f32_dpp v8, v8, v8 row_mirror row_mask:0xf bank_mask:0xf
  v_mul_f32 v10, 0x3ae38e39, v8
  v_cvt_pk_bf16_f32 v12, v12, v12
  v_lshlrev_b32 v12, 16, v12
  v_cvt_pk_bf16_f32 v10, v10, v10
  v_lshlrev_b32 v10, 16, v10
  v_add_f32 v10, 0x3727c5ac, v10
  v_cvt_pk_bf16_f32 v10, v10, v10
  v_lshlrev_b32 v10, 16, v10
  v_sqrt_f32 v10, v10
  s_nop 0
  v_cvt_pk_bf16_f32 v10, v10, v10
  v_lshlrev_b32 v10, 16, v10
  v_rcp_f32 v10, v10
  v_sub_f32 v14, 0, v12
  v_pk_add_f32 v[52:53], v[52:53], v[14:15] op_sel_hi:[1,0]
  s_nop 0
  v_cvt_pk_bf16_f32 v16, v52, v53
  v_pk_add_f32 v[54:55], v[54:55], v[14:15] op_sel_hi:[1,0]
  s_nop 0
  v_cvt_pk_bf16_f32 v17, v54, v55
  v_pk_add_f32 v[56:57], v[56:57], v[14:15] op_sel_hi:[1,0]
  s_nop 0
  v_cvt_pk_bf16_f32 v18, v56, v57
  v_pk_add_f32 v[58:59], v[58:59], v[14:15] op_sel_hi:[1,0]
  s_nop 0
  v_cvt_pk_bf16_f32 v19, v58, v59
  v_pk_add_f32 v[60:61], v[60:61], v[14:15] op_sel_hi:[1,0]
  s_nop 0
  v_cvt_pk_bf16_f32 v20, v60, v61
  v_pk_add_f32 v[62:63], v[62:63], v[14:15] op_sel_hi:[1,0]
  s_nop 0
  v_cvt_pk_bf16_f32 v21, v62, v63
  v_pk_add_f32 v[64:65], v[64:65], v[14:15] op_sel_hi:[1,0]
  s_nop 0
  v_cvt_pk_bf16_f32 v22, v64, v65
  v_pk_add_f32 v[66:67], v[66:67], v[14:15] op_sel_hi:[1,0]
  s_nop 0
  v_cvt_pk_bf16_f32 v23, v66, v67
  v_pk_add_f32 v[68:69], v[68:69], v[14:15] op_sel_hi:[1,0]
  s_nop 0
  v_cvt_pk_bf16_f32 v24, v68, v69
  v_pk_add_f32 v[70:71], v[70:71], v[14:15] op_sel_hi:[1,0]
  s_nop 0
  v_cvt_pk_bf16_f32 v25, v70, v71
  v_pk_add_f32 v[72:73], v[72:73], v[14:15] op_sel_hi:[1,0]
  s_nop 0
  v_cvt_pk_bf16_f32 v26, v72, v73
  v_pk_add_f32 v[74:75], v[74:75], v[14:15] op_sel_hi:[1,0]
  s_nop 0
  v_cvt_pk_bf16_f32 v27, v74, v75
  v_pk_add_f32 v[76:77], v[76:77], v[14:15] op_sel_hi:[1,0]
  s_nop 0
  v_cvt_pk_bf16_f32 v28, v76, v77
  v_pk_add_f32 v[78:79], v[78:79], v[14:15] op_sel_hi:[1,0]
  s_nop 0
  v_cvt_pk_bf16_f32 v29, v78, v79
  v_pk_add_f32 v[80:81], v[80:81], v[14:15] op_sel_hi:[1,0]
  s_nop 0
  v_cvt_pk_bf16_f32 v30, v80, v81
  v_pk_add_f32 v[82:83], v[82:83], v[14:15] op_sel_hi:[1,0]
  s_nop 0
  v_cvt_pk_bf16_f32 v31, v82, v83
  v_pk_add_f32 v[84:85], v[84:85], v[14:15] op_sel_hi:[1,0]
  s_nop 0
  v_cvt_pk_bf16_f32 v32, v84, v85
  v_pk_add_f32 v[86:87], v[86:87], v[14:15] op_sel_hi:[1,0]
  s_nop 0
  v_cvt_pk_bf16_f32 v33, v86, v87
  v_lshlrev_b32 v52, 16, v16
  v_and_b32 v53, 0xffff0000, v16
  v_lshlrev_b32 v54, 16, v17
  v_and_b32 v55, 0xffff0000, v17
  v_lshlrev_b32 v56, 16, v18
  v_and_b32 v57, 0xffff0000, v18
  v_lshlrev_b32 v58, 16, v19
  v_and_b32 v59, 0xffff0000, v19
  v_lshlrev_b32 v60, 16, v20
  v_and_b32 v61, 0xffff0000, v20
  v_lshlrev_b32 v62, 16, v21
  v_and_b32 v63, 0xffff0000, v21
  v_lshlrev_b32 v64, 16, v22
  v_and_b32 v65, 0xffff0000, v22
  v_lshlrev_b32 v66, 16, v23
  v_and_b32 v67, 0xffff0000, v23
  v_lshlrev_b32 v68, 16, v24
  v_and_b32 v69, 0xffff0000, v24
  v_lshlrev_b32 v70, 16, v25
  v_and_b32 v71, 0xffff0000, v25
  v_lshlrev_b32 v72, 16, v26
  v_and_b32 v73, 0xffff0000, v26
  v_lshlrev_b32 v74, 16, v27
  v_and_b32 v75, 0xffff0000, v27
  v_lshlrev_b32 v76, 16, v28
  v_and_b32 v77, 0xffff0000, v28
  v_lshlrev_b32 v78, 16, v29
  v_and_b32 v79, 0xffff0000, v29
  v_lshlrev_b32 v80, 16, v30
  v_and_b32 v81, 0xffff0000, v30
  v_lshlrev_b32 v82, 16, v31
  v_and_b32 v83, 0xffff0000, v31
  v_lshlrev_b32 v84, 16, v32
  v_and_b32 v85, 0xffff0000, v32
  v_lshlrev_b32 v86, 16, v33
  v_and_b32 v87, 0xffff0000, v33
  v_pk_mul_f32 v[52:53], v[52:53], v[10:11] op_sel_hi:[1,0]
  s_nop 0
  v_cvt_pk_bf16_f32 v16, v52, v53
  v_pk_mul_f32 v[54:55], v[54:55], v[10:11] op_sel_hi:[1,0]
  s_nop 0
  v_cvt_pk_bf16_f32 v17, v54, v55
  v_pk_mul_f32 v[56:57], v[56:57], v[10:11] op_sel_hi:[1,0]
  s_nop 0
  v_cvt_pk_bf16_f32 v18, v56, v57
  v_pk_mul_f32 v[58:59], v[58:59], v[10:11] op_sel_hi:[1,0]
  s_nop 0
  v_cvt_pk_bf16_f32 v19, v58, v59
  v_pk_mul_f32 v[60:61], v[60:61], v[10:11] op_sel_hi:[1,0]
  s_nop 0
  v_cvt_pk_bf16_f32 v20, v60, v61
  v_pk_mul_f32 v[62:63], v[62:63], v[10:11] op_sel_hi:[1,0]
  s_nop 0
  v_cvt_pk_bf16_f32 v21, v62, v63
  v_pk_mul_f32 v[64:65], v[64:65], v[10:11] op_sel_hi:[1,0]
  s_nop 0
  v_cvt_pk_bf16_f32 v22, v64, v65
  v_pk_mul_f32 v[66:67], v[66:67], v[10:11] op_sel_hi:[1,0]
  s_nop 0
  v_cvt_pk_bf16_f32 v23, v66, v67
  v_pk_mul_f32 v[68:69], v[68:69], v[10:11] op_sel_hi:[1,0]
  s_nop 0
  v_cvt_pk_bf16_f32 v24, v68, v69
  v_pk_mul_f32 v[70:71], v[70:71], v[10:11] op_sel_hi:[1,0]
  s_nop 0
  v_cvt_pk_bf16_f32 v25, v70, v71
  v_pk_mul_f32 v[72:73], v[72:73], v[10:11] op_sel_hi:[1,0]
  s_nop 0
  v_cvt_pk_bf16_f32 v26, v72, v73
  v_pk_mul_f32 v[74:75], v[74:75], v[10:11] op_sel_hi:[1,0]
  s_nop 0
  v_cvt_pk_bf16_f32 v27, v74, v75
  v_pk_mul_f32 v[76:77], v[76:77], v[10:11] op_sel_hi:[1,0]
  s_nop 0
  v_cvt_pk_bf16_f32 v28, v76, v77
  v_pk_mul_f32 v[78:79], v[78:79], v[10:11] op_sel_hi:[1,0]
  s_nop 0
  v_cvt_pk_bf16_f32 v29, v78, v79
  v_pk_mul_f32 v[80:81], v[80:81], v[10:11] op_sel_hi:[1,0]
  s_nop 0
  v_cvt_pk_bf16_f32 v30, v80, v81
  v_pk_mul_f32 v[82:83], v[82:83], v[10:11] op_sel_hi:[1,0]
  s_nop 0
  v_cvt_pk_bf16_f32 v31, v82, v83
  v_pk_mul_f32 v[84:85], v[84:85], v[10:11] op_sel_hi:[1,0]
  s_nop 0
  v_cvt_pk_bf16_f32 v32, v84, v85
  v_pk_mul_f32 v[86:87], v[86:87], v[10:11] op_sel_hi:[1,0]
  s_nop 0
  v_cvt_pk_bf16_f32 v33, v86, v87
  ds_write_b64 v5, v[16:17] offset:0
  ds_write_b64 v5, v[18:19] offset:128
  ds_write_b64 v5, v[20:21] offset:256
  ds_write_b64 v5, v[22:23] offset:384
  ds_write_b64 v5, v[24:25] offset:512
  ds_write_b64 v5, v[26:27] offset:640
  ds_write_b64 v5, v[28:29] offset:768
  ds_write_b64 v5, v[30:31] offset:896
  ds_write_b64 v5, v[32:33] offset:1024
  s_waitcnt vmcnt(1)
  v_add_u32 v5, 37888, v5
  ds_write_b64 v5, v[34:35] offset:0
  ds_write_b64 v5, v[36:37] offset:128
  ds_write_b64 v5, v[38:39] offset:256
  ds_write_b64 v5, v[40:41] offset:384
  ds_write_b64 v5, v[42:43] offset:512
  ds_write_b64 v5, v[44:45] offset:640
  ds_write_b64 v5, v[46:47] offset:768
  ds_write_b64 v5, v[48:49] offset:896
  ds_write_b64 v5, v[50:51] offset:1024
  v_lshlrev_b32 v6, 3, v1
  v_bfe_u32 v7, v0, 2, 2
  v_add_u32 v6, v6, v7
  v_mul_u32_u24 v6, 1184, v6
  v_and_b32 v7, 3, v0
  v_lshl_add_u32 v6, v7, 3, v6
  s_lshl_b32 s33, s3, 5
  v_add_u32 v6, s33, v6
  s_lshl_b32 s33, s3, 4
  v_add_u32 v7, s33, v2
  v_mul_u32_u24 v8, 4224, v7
  v_lshl_add_u32 v8, v1, 4, v8
  v_mul_u32_u24 v9, 10368, v7
  v_lshl_add_u32 v9, v1, 4, v9
  s_waitcnt lgkmcnt(0)
  s_barrier
  s_lshl_b32 s33, s6, 6
  s_add_u32 s33, s33, 4096
  ds_read_b64_tr_b16 v[16:17], v6 offset:0
  ds_read_b64_tr_b16 v[18:19], v6 offset:4736
  s_add_u32 s34, s33, 0
  s_waitcnt lgkmcnt(0)
  buffer_store_dwordx4 v[16:19], v8, s[16:19], s34 offen sc1
  ds_read_b64_tr_b16 v[20:21], v6 offset:256
  ds_read_b64_tr_b16 v[22:23], v6 offset:4992
  s_add_u32 s34, s33, 540672
  s_waitcnt lgkmcnt(0)
  buffer_store_dwordx4 v[20:23], v8, s[16:19], s34 offen sc1
  ds_read_b64_tr_b16 v[24:25], v6 offset:512
  ds_read_b64_tr_b16 v[26:27], v6 offset:5248
  s_add_u32 s34, s33, 1081344
  s_waitcnt lgkmcnt(0)
  buffer_store_dwordx4 v[24:27], v8, s[16:19], s34 offen sc1
  ds_read_b64_tr_b16 v[28:29], v6 offset:768
  ds_read_b64_tr_b16 v[30:31], v6 offset:5504
  s_add_u32 s34, s33, 1622016
  s_waitcnt lgkmcnt(0)
  buffer_store_dwordx4 v[28:31], v8, s[16:19], s34 offen sc1
  s_cmp_ge_u32 s3, 4
  s_cbranch_scc1 k0_tr_1
  ds_read_b64_tr_b16 v[32:33], v6 offset:1024
  ds_read_b64_tr_b16 v[34:35], v6 offset:5760
  s_add_u32 s34, s33, 2162688
  s_waitcnt lgkmcnt(0)
  buffer_store_dwordx4 v[32:35], v8, s[16:19], s34 offen sc1
k0_tr_1:
  s_nop 1
  s_cmp_ge_u32 s6, 18
  s_cbranch_scc1 k0_done
  v_add_u32 v6, 37888, v6
  s_lshl_b32 s33, s6, 6
  s_add_u32 s33, s33, 2499584
  ds_read_b64_tr_b16 v[16:17], v6 offset:0
  ds_read_b64_tr_b16 v[18:19], v6 offset:4736
  s_add_u32 s34, s33, 0
  s_waitcnt lgkmcnt(0)
  buffer_store_dwordx4 v[16:19], v9, s[16:19], s34 offen sc1
  ds_read_b64_tr_b16 v[20:21], v6 offset:256
  ds_read_b64_tr_b16 v[22:23], v6 offset:4992
  s_add_u32 s34, s33, 1327104
  s_waitcnt lgkmcnt(0)
  buffer_store_dwordx4 v[20:23], v9, s[16:19], s34 offen sc1
  ds_read_b64_tr_b16 v[24:25], v6 offset:512
  ds_read_b64_tr_b16 v[26:27], v6 offset:5248
  s_add_u32 s34, s33, 2654208
  s_waitcnt lgkmcnt(0)
  buffer_store_dwordx4 v[24:27], v9, s[16:19], s34 offen sc1
  ds_read_b64_tr_b16 v[28:29], v6 offset:768
  ds_read_b64_tr_b16 v[30:31], v6 offset:5504
  s_add_u32 s34, s33, 3981312
  s_waitcnt lgkmcnt(0)
  buffer_store_dwordx4 v[28:31], v9, s[16:19], s34 offen sc1
  s_cmp_ge_u32 s3, 4
  s_cbranch_scc1 k0_tr_2
  ds_read_b64_tr_b16 v[32:33], v6 offset:1024
  ds_read_b64_tr_b16 v[34:35], v6 offset:5760
  s_add_u32 s34, s33, 5308416
  s_waitcnt lgkmcnt(0)
  buffer_store_dwordx4 v[32:35], v9, s[16:19], s34 offen sc1
k0_tr_2:
  s_nop 1
k0_done:
  s_waitcnt vmcnt(0)
  s_endpgm
k0_exit:
  s_endpgm
.p2align 8
.globl k1_gemm1_attn_kernel
.type k1_gemm1_attn_kernel,@function
k1_gemm1_attn_kernel:
  s_cmp_ge_u32 s2, 256
  s_cbranch_scc1 k1_exit
  s_load_dwordx4 s[24:27], s[0:1], 32
  s_load_dwordx2 s[30:31], s[0:1], 80
  s_load_dwordx2 s[28:29], s[0:1], 48
  v_lshrrev_b32 v1, 6, v0
  v_and_b32 v0, 63, v0
  v_readfirstlane_b32 s3, v1
  s_and_b32 s4, s2, 7
  s_lshr_b32 s5, s2, 3
  s_waitcnt lgkmcnt(0)
  s_mov_b32 s8, s24
  s_and_b32 s9, s25, 0xffff
  s_mov_b32 s10, 18874368
  s_mov_b32 s11, 0x20000
  s_mov_b32 s16, s26
  s_and_b32 s17, s27, 0xffff
  s_mov_b32 s18, 9216
  s_mov_b32 s19, 0x20000
  s_mov_b32 s12, s30
  s_and_b32 s13, s31, 0xffff
  s_mov_b32 s14, 37355520
  s_mov_b32 s15, 0x20000
  s_cmp_ge_u32 s5, 27
  s_cbranch_scc1 k1_free
  s_mul_i32 s6, s4, 27
  s_add_u32 s6, s6, s5
  s_mul_i32 s7, s6, 171
  s_lshr_b32 s7, s7, 10
  s_mul_i32 s20, s7, 6
  s_sub_u32 s6, s6, s20
  s_cmp_ge_u32 s3, 4
  s_cbranch_scc1 k1_loader
  s_setprio 2
  s_lshl_b32 s20, s7, 8
  s_lshl_b32 s21, s3, 6
  s_add_u32 s20, s20, s21
  v_lshrrev_b32 v16, 5, v0
  v_lshlrev_b32 v17, 3, v16
  buffer_load_dwordx2 v[248:249], v17, s[16:19], s20 offen offset:0
  buffer_load_dwordx2 v[250:251], v17, s[16:19], s20 offen offset:16
  buffer_load_dwordx2 v[252:253], v17, s[16:19], s20 offen offset:32
  buffer_load_dwordx2 v[254:255], v17, s[16:19], s20 offen offset:48
  v_bfe_u32 v18, v0, 2, 2
  v_add_u32 v19, v17, v18
  v_lshlrev_b32 v1, 8, v19
  v_xor_b32 v19, s3, v18
  v_lshl_add_u32 v1, v19, 6, v1
  v_bfe_u32 v19, v0, 4, 1
  v_lshl_add_u32 v1, v19, 5, v1
  v_and_b32 v19, 3, v0
  v_lshl_add_u32 v1, v19, 3, v1
  v_and_b32 v20, 31, v0
  v_bfe_u32 v19, v0, 1, 3
  v_xor_b32 v19, v19, v16
  v_xor_b32 v21, 0, v19
  v_lshlrev_b32 v21, 4, v21
  v_lshl_add_u32 v4, v20, 7, v21
  v_xor_b32 v21, 2, v19
  v_lshlrev_b32 v21, 4, v21
  v_lshl_add_u32 v5, v20, 7, v21
  v_xor_b32 v21, 4, v19
  v_lshlrev_b32 v21, 4, v21
  v_lshl_add_u32 v6, v20, 7, v21
  v_xor_b32 v21, 6, v19
  v_lshlrev_b32 v21, 4, v21
  v_lshl_add_u32 v7, v20, 7, v21
  v_add_u32 v2, 57344, v1
  v_add_u32 v8, 57344, v4
  v_add_u32 v9, 57344, v5
  v_add_u32 v10, 57344, v6
  v_add_u32 v11, 57344, v7
  v_add_u32 v3, 114688, v1
  v_add_u32 v12, 114688, v4
  v_add_u32 v13, 114688, v5
  v_add_u32 v14, 114688, v6
  v_add_u32 v15, 114688, v7
  s_mul_i32 s21, s6, 96
  v_add_u32 v20, s21, v20
  v_mul_u32_u24 v22, 10368, v20
  v_lshl_add_u32 v22, v16, 4, v22
  s_add_u32 s22, s20, 2490368
  s_waitcnt vmcnt(0)
  v_lshlrev_b32 v32, 16, v248
  v_and_b32 v33, 0xffff0000, v248
  v_lshlrev_b32 v34, 16, v249
  v_and_b32 v35, 0xffff0000, v249
  v_lshlrev_b32 v36, 16, v250
  v_and_b32 v37, 0xffff0000, v250
  v_lshlrev_b32 v38, 16, v251
  v_and_b32 v39, 0xffff0000, v251
  v_lshlrev_b32 v40, 16, v252
  v_and_b32 v41, 0xffff0000, v252
  v_lshlrev_b32 v42, 16, v253
  v_and_b32 v43, 0xffff0000, v253
  v_lshlrev_b32 v44, 16, v254
  v_and_b32 v45, 0xffff0000, v254
  v_lshlrev_b32 v46, 16, v255
  v_and_b32 v47, 0xffff0000, v255
  v_mov_b32 v48, v32
  v_mov_b32 v64, v32
  v_mov_b32 v49, v33
  v_mov_b32 v65, v33
  v_mov_b32 v50, v34
  v_mov_b32 v66, v34
  v_mov_b32 v51, v35
  v_mov_b32 v67, v35
  v_mov_b32 v52, v36
  v_mov_b32 v68, v36
  v_mov_b32 v53, v37
  v_mov_b32 v69, v37
  v_mov_b32 v54, v38
  v_mov_b32 v70, v38
  v_mov_b32 v55, v39
  v_mov_b32 v71, v39
  v_mov_b32 v56, v40
  v_mov_b32 v72, v40
  v_mov_b32 v57, v41
  v_mov_b32 v73, v41
  v_mov_b32 v58, v42
  v_mov_b32 v74, v42
  v_mov_b32 v59, v43
  v_mov_b32 v75, v43
  v_mov_b32 v60, v44
  v_mov_b32 v76, v44
  v_mov_b32 v61, v45
  v_mov_b32 v77, v45
  v_mov_b32 v62, v46
  v_mov_b32 v78, v46
  v_mov_b32 v63, v47
  v_mov_b32 v79, v47
  s_mul_i32 s24, s7, 6
  s_add_u32 s24, s24, s6
  s_lshl_b32 s24, s24, 2
  s_add_u32 s24, s24, s3
  v_mov_b32 v248, 0
  v_mov_b32 v249, 0
  v_mov_b32 v250, 0
  v_mov_b32 v251, 0
  s_barrier
  ds_read_b64_tr_b16 v[80:81], v1 offset:0
  ds_read_b64_tr_b16 v[82:83], v1 offset:1024
  ds_read_b128 v[84:87], v4 offset:16384
  ds_read_b128 v[88:91], v4 offset:20480
  ds_read_b128 v[92:95], v4 offset:24576
  ds_read_b64_tr_b16 v[96:97], v1 offset:4096
  ds_read_b64_tr_b16 v[98:99], v1 offset:5120
  ds_read_b128 v[100:103], v5 offset:16384
  ds_read_b128 v[104:107], v5 offset:20480
  ds_read_b128 v[108:111], v5 offset:24576
  s_mov_b32 s23, 6
k1_cloop:
  s_waitcnt lgkmcnt(5)
  v_mfma_f32_32x32x16_bf16 v[32:47], v[80:83], v[84:87], v[32:47]
  ds_read_b64_tr_b16 v[112:113], v1 offset:8192
  ds_read_b64_tr_b16 v[114:115], v1 offset:9216
  v_mfma_f32_32x32x16_bf16 v[48:63], v[80:83], v[88:91], v[48:63]
  ds_read_b128 v[116:119], v6 offset:16384
  ds_read_b128 v[120:123], v6 offset:20480
  v_mfma_f32_32x32x16_bf16 v[64:79], v[80:83], v[92:95], v[64:79]
  ds_read_b128 v[124:127], v6 offset:24576
  s_waitcnt lgkmcnt(5)
  v_mfma_f32_32x32x16_bf16 v[32:47], v[96:99], v[100:103], v[32:47]
  ds_read_b64_tr_b16 v[128:129], v1 offset:12288
  ds_read_b64_tr_b16 v[130:131], v1 offset:13312
  v_mfma_f32_32x32x16_bf16 v[48:63], v[96:99], v[104:107], v[48:63]
  ds_read_b128 v[132:135], v7 offset:16384
  ds_read_b128 v[136:139], v7 offset:20480
  v_mfma_f32_32x32x16_bf16 v[64:79], v[96:99], v[108:111], v[64:79]
  ds_read_b128 v[140:143], v7 offset:24576
  s_waitcnt lgkmcnt(0)
  v_mfma_f32_32x32x16_bf16 v[32:47], v[112:115], v[116:119], v[32:47]
  s_barrier
  ds_read_b64_tr_b16 v[80:81], v1 offset:28672
  ds_read_b64_tr_b16 v[82:83], v1 offset:29696
  v_mfma_f32_32x32x16_bf16 v[48:63], v[112:115], v[120:123], v[48:63]
  ds_read_b128 v[84:87], v4 offset:45056
  ds_read_b128 v[88:91], v4 offset:49152
  v_mfma_f32_32x32x16_bf16 v[64:79], v[112:115], v[124:127], v[64:79]
  ds_read_b128 v[92:95], v4 offset:53248
  v_mfma_f32_32x32x16_bf16 v[32:47], v[128:131], v[132:135], v[32:47]
  ds_read_b64_tr_b16 v[96:97], v1 offset:32768
  ds_read_b64_tr_b16 v[98:99], v1 offset:33792
  v_mfma_f32_32x32x16_bf16 v[48:63], v[128:131], v[136:139], v[48:63]
  ds_read_b128 v[100:103], v5 offset:45056
  ds_read_b128 v[104:107], v5 offset:49152
  v_mfma_f32_32x32x16_bf16 v[64:79], v[128:131], v[140:143], v[64:79]
  ds_read_b128 v[108:111], v5 offset:53248
  s_waitcnt lgkmcnt(5)
  v_mfma_f32_32x32x16_bf16 v[32:47], v[80:83], v[84:87], v[32:47]
  ds_read_b64_tr_b16 v[112:113], v1 offset:36864
  ds_read_b64_tr_b16 v[114:115], v1 offset:37888
  v_mfma_f32_32x32x16_bf16 v[48:63], v[80:83], v[88:91], v[48:63]
  ds_read_b128 v[116:119], v6 offset:45056
  ds_read_b128 v[120:123], v6 offset:49152
  v_mfma_f32_32x32x16_bf16 v[64:79], v[80:83], v[92:95], v[64:79]
  ds_read_b128 v[124:127], v6 offset:53248
  s_waitcnt lgkmcnt(5)
  v_mfma_f32_32x32x16_bf16 v[32:47], v[96:99], v[100:103], v[32:47]
  ds_read_b64_tr_b16 v[128:129], v1 offset:40960
  ds_read_b64_tr_b16 v[130:131], v1 offset:41984
  v_mfma_f32_32x32x16_bf16 v[48:63], v[96:99], v[104:107], v[48:63]
  ds_read_b128 v[132:135], v7 offset:45056
  ds_read_b128 v[136:139], v7 offset:49152
  v_mfma_f32_32x32x16_bf16 v[64:79], v[96:99], v[108:111], v[64:79]
  ds_read_b128 v[140:143], v7 offset:53248
  s_waitcnt lgkmcnt(0)
  v_mfma_f32_32x32x16_bf16 v[32:47], v[112:115], v[116:119], v[32:47]
  s_barrier
  ds_read_b64_tr_b16 v[80:81], v2 offset:0
  ds_read_b64_tr_b16 v[82:83], v2 offset:1024
  v_mfma_f32_32x32x16_bf16 v[48:63], v[112:115], v[120:123], v[48:63]
  ds_read_b128 v[84:87], v8 offset:16384
  ds_read_b128 v[88:91], v8 offset:20480
  v_mfma_f32_32x32x16_bf16 v[64:79], v[112:115], v[124:127], v[64:79]
  ds_read_b128 v[92:95], v8 offset:24576
  v_mfma_f32_32x32x16_bf16 v[32:47], v[128:131], v[132:135], v[32:47]
  ds_read_b64_tr_b16 v[96:97], v2 offset:4096
  ds_read_b64_tr_b16 v[98:99], v2 offset:5120
  v_mfma_f32_32x32x16_bf16 v[48:63], v[128:131], v[136:139], v[48:63]
  ds_read_b128 v[100:103], v9 offset:16384
  ds_read_b128 v[104:107], v9 offset:20480
  v_mfma_f32_32x32x16_bf16 v[64:79], v[128:131], v[140:143], v[64:79]
  ds_read_b128 v[108:111], v9 offset:24576
  s_waitcnt lgkmcnt(5)
  v_mfma_f32_32x32x16_bf16 v[32:47], v[80:83], v[84:87], v[32:47]
  ds_read_b64_tr_b16 v[112:113], v2 offset:8192
  ds_read_b64_tr_b16 v[114:115], v2 offset:9216
  v_mfma_f32_32x32x16_bf16 v[48:63], v[80:83], v[88:91], v[48:63]
  ds_read_b128 v[116:119], v10 offset:16384
  ds_read_b128 v[120:123], v10 offset:20480
  v_mfma_f32_32x32x16_bf16 v[64:79], v[80:83], v[92:95], v[64:79]
  ds_read_b128 v[124:127], v10 offset:24576
  s_waitcnt lgkmcnt(5)
  v_mfma_f32_32x32x16_bf16 v[32:47], v[96:99], v[100:103], v[32:47]
  ds_read_b64_tr_b16 v[128:129], v2 offset:12288
  ds_read_b64_tr_b16 v[130:131], v2 offset:13312
  v_mfma_f32_32x32x16_bf16 v[48:63], v[96:99], v[104:107], v[48:63]
  ds_read_b128 v[132:135], v11 offset:16384
  ds_read_b128 v[136:139], v11 offset:20480
  v_mfma_f32_32x32x16_bf16 v[64:79], v[96:99], v[108:111], v[64:79]
  ds_read_b128 v[140:143], v11 offset:24576
  s_waitcnt lgkmcnt(0)
  v_mfma_f32_32x32x16_bf16 v[32:47], v[112:115], v[116:119], v[32:47]
  s_barrier
  ds_read_b64_tr_b16 v[80:81], v2 offset:28672
  ds_read_b64_tr_b16 v[82:83], v2 offset:29696
  v_mfma_f32_32x32x16_bf16 v[48:63], v[112:115], v[120:123], v[48:63]
  ds_read_b128 v[84:87], v8 offset:45056
  ds_read_b128 v[88:91], v8 offset:49152
  v_mfma_f32_32x32x16_bf16 v[64:79], v[112:115], v[124:127], v[64:79]
  ds_read_b128 v[92:95], v8 offset:53248
  v_mfma_f32_32x32x16_bf16 v[32:47], v[128:131], v[132:135], v[32:47]
  ds_read_b64_tr_b16 v[96:97], v2 offset:32768
  ds_read_b64_tr_b16 v[98:99], v2 offset:33792
  v_mfma_f32_32x32x16_bf16 v[48:63], v[128:131], v[136:139], v[48:63]
  ds_read_b128 v[100:103], v9 offset:45056
  ds_read_b128 v[104:107], v9 offset:49152
  v_mfma_f32_32x32x16_bf16 v[64:79], v[128:131], v[140:143], v[64:79]
  ds_read_b128 v[108:111], v9 offset:53248
  s_waitcnt lgkmcnt(5)
  v_mfma_f32_32x32x16_bf16 v[32:47], v[80:83], v[84:87], v[32:47]
  ds_read_b64_tr_b16 v[112:113], v2 offset:36864
  ds_read_b64_tr_b16 v[114:115], v2 offset:37888
  v_mfma_f32_32x32x16_bf16 v[48:63], v[80:83], v[88:91], v[48:63]
  ds_read_b128 v[116:119], v10 offset:45056
  ds_read_b128 v[120:123], v10 offset:49152
  v_mfma_f32_32x32x16_bf16 v[64:79], v[80:83], v[92:95], v[64:79]
  ds_read_b128 v[124:127], v10 offset:53248
  s_waitcnt lgkmcnt(5)
  v_mfma_f32_32x32x16_bf16 v[32:47], v[96:99], v[100:103], v[32:47]
  ds_read_b64_tr_b16 v[128:129], v2 offset:40960
  ds_read_b64_tr_b16 v[130:131], v2 offset:41984
  v_mfma_f32_32x32x16_bf16 v[48:63], v[96:99], v[104:107], v[48:63]
  ds_read_b128 v[132:135], v11 offset:45056
  ds_read_b128 v[136:139], v11 offset:49152
  v_mfma_f32_32x32x16_bf16 v[64:79], v[96:99], v[108:111], v[64:79]
  ds_read_b128 v[140:143], v11 offset:53248
  s_waitcnt lgkmcnt(0)
  v_mfma_f32_32x32x16_bf16 v[32:47], v[112:115], v[116:119], v[32:47]
  s_barrier
  ds_read_b64_tr_b16 v[80:81], v3 offset:0
  ds_read_b64_tr_b16 v[82:83], v3 offset:1024
  v_mfma_f32_32x32x16_bf16 v[48:63], v[112:115], v[120:123], v[48:63]
  ds_read_b128 v[84:87], v12 offset:16384
  ds_read_b128 v[88:91], v12 offset:20480
  v_mfma_f32_32x32x16_bf16 v[64:79], v[112:115], v[124:127], v[64:79]
  ds_read_b128 v[92:95], v12 offset:24576
  v_mfma_f32_32x32x16_bf16 v[32:47], v[128:131], v[132:135], v[32:47]
  ds_read_b64_tr_b16 v[96:97], v3 offset:4096
  ds_read_b64_tr_b16 v[98:99], v3 offset:5120
  v_mfma_f32_32x32x16_bf16 v[48:63], v[128:131], v[136:139], v[48:63]
  ds_read_b128 v[100:103], v13 offset:16384
  ds_read_b128 v[104:107], v13 offset:20480
  v_mfma_f32_32x32x16_bf16 v[64:79], v[128:131], v[140:143], v[64:79]
  ds_read_b128 v[108:111], v13 offset:24576
  s_waitcnt lgkmcnt(5)
  v_mfma_f32_32x32x16_bf16 v[32:47], v[80:83], v[84:87], v[32:47]
  ds_read_b64_tr_b16 v[112:113], v3 offset:8192
  ds_read_b64_tr_b16 v[114:115], v3 offset:9216
  v_mfma_f32_32x32x16_bf16 v[48:63], v[80:83], v[88:91], v[48:63]
  ds_read_b128 v[116:119], v14 offset:16384
  ds_read_b128 v[120:123], v14 offset:20480
  v_mfma_f32_32x32x16_bf16 v[64:79], v[80:83], v[92:95], v[64:79]
  ds_read_b128 v[124:127], v14 offset:24576
  s_waitcnt lgkmcnt(5)
  v_mfma_f32_32x32x16_bf16 v[32:47], v[96:99], v[100:103], v[32:47]
  ds_read_b64_tr_b16 v[128:129], v3 offset:12288
  ds_read_b64_tr_b16 v[130:131], v3 offset:13312
  v_mfma_f32_32x32x16_bf16 v[48:63], v[96:99], v[104:107], v[48:63]
  ds_read_b128 v[132:135], v15 offset:16384
  ds_read_b128 v[136:139], v15 offset:20480
  v_mfma_f32_32x32x16_bf16 v[64:79], v[96:99], v[108:111], v[64:79]
  ds_read_b128 v[140:143], v15 offset:24576
  s_waitcnt lgkmcnt(0)
  v_mfma_f32_32x32x16_bf16 v[32:47], v[112:115], v[116:119], v[32:47]
  s_barrier
  ds_read_b64_tr_b16 v[80:81], v1 offset:0
  ds_read_b64_tr_b16 v[82:83], v1 offset:1024
  v_mfma_f32_32x32x16_bf16 v[48:63], v[112:115], v[120:123], v[48:63]
  ds_read_b128 v[84:87], v4 offset:16384
  ds_read_b128 v[88:91], v4 offset:20480
  v_mfma_f32_32x32x16_bf16 v[64:79], v[112:115], v[124:127], v[64:79]
  ds_read_b128 v[92:95], v4 offset:24576
  v_mfma_f32_32x32x16_bf16 v[32:47], v[128:131], v[132:135], v[32:47]
  ds_read_b64_tr_b16 v[96:97], v1 offset:4096
  ds_read_b64_tr_b16 v[98:99], v1 offset:5120
  v_mfma_f32_32x32x16_bf16 v[48:63], v[128:131], v[136:139], v[48:63]
  ds_read_b128 v[100:103], v5 offset:16384
  ds_read_b128 v[104:107], v5 offset:20480
  v_mfma_f32_32x32x16_bf16 v[64:79], v[128:131], v[140:143], v[64:79]
  ds_read_b128 v[108:111], v5 offset:24576
  s_sub_u32 s23, s23, 1
  s_cmp_lg_u32 s23, 0
  s_cbranch_scc1 k1_cloop
  s_waitcnt lgkmcnt(5)
  v_mfma_f32_32x32x16_bf16 v[32:47], v[80:83], v[84:87], v[32:47]
  ds_read_b64_tr_b16 v[112:113], v1 offset:8192
  ds_read_b64_tr_b16 v[114:115], v1 offset:9216
  v_mfma_f32_32x32x16_bf16 v[48:63], v[80:83], v[88:91], v[48:63]
  ds_read_b128 v[116:119], v6 offset:16384
  ds_read_b128 v[120:123], v6 offset:20480
  v_mfma_f32_32x32x16_bf16 v[64:79], v[80:83], v[92:95], v[64:79]
  ds_read_b128 v[124:127], v6 offset:24576
  s_waitcnt lgkmcnt(5)
  v_mfma_f32_32x32x16_bf16 v[32:47], v[96:99], v[100:103], v[32:47]
  ds_read_b64_tr_b16 v[128:129], v1 offset:12288
  ds_read_b64_tr_b16 v[130:131], v1 offset:13312
  v_mfma_f32_32x32x16_bf16 v[48:63], v[96:99], v[104:107], v[48:63]
  ds_read_b128 v[132:135], v7 offset:16384
  ds_read_b128 v[136:139], v7 offset:20480
  v_mfma_f32_32x32x16_bf16 v[64:79], v[96:99], v[108:111], v[64:79]
  ds_read_b128 v[140:143], v7 offset:24576
  s_waitcnt lgkmcnt(0)
  v_mfma_f32_32x32x16_bf16 v[32:47], v[112:115], v[116:119], v[32:47]
  s_barrier
  ds_read_b64_tr_b16 v[80:81], v1 offset:28672
  ds_read_b64_tr_b16 v[82:83], v1 offset:29696
  v_mfma_f32_32x32x16_bf16 v[48:63], v[112:115], v[120:123], v[48:63]
  ds_read_b128 v[84:87], v4 offset:45056
  ds_read_b128 v[88:91], v4 offset:49152
  v_mfma_f32_32x32x16_bf16 v[64:79], v[112:115], v[124:127], v[64:79]
  ds_read_b128 v[92:95], v4 offset:53248
  v_mfma_f32_32x32x16_bf16 v[32:47], v[128:131], v[132:135], v[32:47]
  ds_read_b64_tr_b16 v[96:97], v1 offset:32768
  ds_read_b64_tr_b16 v[98:99], v1 offset:33792
  v_mfma_f32_32x32x16_bf16 v[48:63], v[128:131], v[136:139], v[48:63]
  ds_read_b128 v[100:103], v5 offset:45056
  ds_read_b128 v[104:107], v5 offset:49152
  v_mfma_f32_32x32x16_bf16 v[64:79], v[128:131], v[140:143], v[64:79]
  ds_read_b128 v[108:111], v5 offset:53248
  s_waitcnt lgkmcnt(5)
  v_mfma_f32_32x32x16_bf16 v[32:47], v[80:83], v[84:87], v[32:47]
  ds_read_b64_tr_b16 v[112:113], v1 offset:36864
  ds_read_b64_tr_b16 v[114:115], v1 offset:37888
  v_mfma_f32_32x32x16_bf16 v[48:63], v[80:83], v[88:91], v[48:63]
  ds_read_b128 v[116:119], v6 offset:45056
  ds_read_b128 v[120:123], v6 offset:49152
  v_mfma_f32_32x32x16_bf16 v[64:79], v[80:83], v[92:95], v[64:79]
  ds_read_b128 v[124:127], v6 offset:53248
  s_waitcnt lgkmcnt(5)
  v_mfma_f32_32x32x16_bf16 v[32:47], v[96:99], v[100:103], v[32:47]
  ds_read_b64_tr_b16 v[128:129], v1 offset:40960
  ds_read_b64_tr_b16 v[130:131], v1 offset:41984
  v_mfma_f32_32x32x16_bf16 v[48:63], v[96:99], v[104:107], v[48:63]
  ds_read_b128 v[132:135], v7 offset:45056
  ds_read_b128 v[136:139], v7 offset:49152
  v_mfma_f32_32x32x16_bf16 v[64:79], v[96:99], v[108:111], v[64:79]
  ds_read_b128 v[140:143], v7 offset:53248
  s_waitcnt lgkmcnt(0)
  v_mfma_f32_32x32x16_bf16 v[32:47], v[112:115], v[116:119], v[32:47]
  v_mfma_f32_32x32x16_bf16 v[48:63], v[112:115], v[120:123], v[48:63]
  v_mfma_f32_32x32x16_bf16 v[64:79], v[112:115], v[124:127], v[64:79]
  v_mfma_f32_32x32x16_bf16 v[32:47], v[128:131], v[132:135], v[32:47]
  v_mfma_f32_32x32x16_bf16 v[48:63], v[128:131], v[136:139], v[48:63]
  v_mfma_f32_32x32x16_bf16 v[64:79], v[128:131], v[140:143], v[64:79]
  v_mov_b32 v24, 0xc0135761
  v_mov_b32 v26, 0xbdd2d3e8
  v_mov_b32 v28, 1.0
  s_add_u32 s24, s22, 331776
  s_add_u32 s25, s22, 663552
  s_nop 4
  v_pk_mul_f32 v[80:81], v[32:33], v[32:33]
  v_pk_mul_f32 v[82:83], v[34:35], v[34:35]
  v_pk_mul_f32 v[84:85], v[36:37], v[36:37]
  v_pk_mul_f32 v[86:87], v[38:39], v[38:39]
  v_pk_mul_f32 v[88:89], v[40:41], v[40:41]
  v_pk_mul_f32 v[90:91], v[42:43], v[42:43]
  v_pk_mul_f32 v[92:93], v[44:45], v[44:45]
  v_pk_mul_f32 v[94:95], v[46:47], v[46:47]
  v_pk_fma_f32 v[80:81], v[80:81], v[26:27], v[24:25] op_sel_hi:[1,0,0]
  v_pk_fma_f32 v[82:83], v[82:83], v[26:27], v[24:25] op_sel_hi:[1,0,0]
  v_pk_fma_f32 v[84:85], v[84:85], v[26:27], v[24:25] op_sel_hi:[1,0,0]
  v_pk_fma_f32 v[86:87], v[86:87], v[26:27], v[24:25] op_sel_hi:[1,0,0]
  v_pk_fma_f32 v[88:89], v[88:89], v[26:27], v[24:25] op_sel_hi:[1,0,0]
  v_pk_fma_f32 v[90:91], v[90:91], v[26:27], v[24:25] op_sel_hi:[1,0,0]
  v_pk_fma_f32 v[92:93], v[92:93], v[26:27], v[24:25] op_sel_hi:[1,0,0]
  v_pk_fma_f32 v[94:95], v[94:95], v[26:27], v[24:25] op_sel_hi:[1,0,0]
  v_pk_mul_f32 v[80:81], v[80:81], v[32:33]
  v_pk_mul_f32 v[82:83], v[82:83], v[34:35]
  v_pk_mul_f32 v[84:85], v[84:85], v[36:37]
  v_pk_mul_f32 v[86:87], v[86:87], v[38:39]
  v_pk_mul_f32 v[88:89], v[88:89], v[40:41]
  v_pk_mul_f32 v[90:91], v[90:91], v[42:43]
  v_pk_mul_f32 v[92:93], v[92:93], v[44:45]
  v_pk_mul_f32 v[94:95], v[94:95], v[46:47]
  v_exp_f32 v80, v80
  v_exp_f32 v81, v81
  v_exp_f32 v82, v82
  v_exp_f32 v83, v83
  v_exp_f32 v84, v84
  v_exp_f32 v85, v85
  v_exp_f32 v86, v86
  v_exp_f32 v87, v87
  v_exp_f32 v88, v88
  v_exp_f32 v89, v89
  v_exp_f32 v90, v90
  v_exp_f32 v91, v91
  v_exp_f32 v92, v92
  v_exp_f32 v93, v93
  v_exp_f32 v94, v94
  v_exp_f32 v95, v95
  v_pk_add_f32 v[80:81], v[80:81], v[28:29] op_sel_hi:[1,0]
  v_pk_add_f32 v[82:83], v[82:83], v[28:29] op_sel_hi:[1,0]
  v_pk_add_f32 v[84:85], v[84:85], v[28:29] op_sel_hi:[1,0]
  v_pk_add_f32 v[86:87], v[86:87], v[28:29] op_sel_hi:[1,0]
  v_pk_add_f32 v[88:89], v[88:89], v[28:29] op_sel_hi:[1,0]
  v_pk_add_f32 v[90:91], v[90:91], v[28:29] op_sel_hi:[1,0]
  v_pk_add_f32 v[92:93], v[92:93], v[28:29] op_sel_hi:[1,0]
  v_pk_add_f32 v[94:95], v[94:95], v[28:29] op_sel_hi:[1,0]
  v_rcp_f32 v80, v80
  v_rcp_f32 v81, v81
  v_rcp_f32 v82, v82
  v_rcp_f32 v83, v83
  v_rcp_f32 v84, v84
  v_rcp_f32 v85, v85
  v_rcp_f32 v86, v86
  v_rcp_f32 v87, v87
  v_rcp_f32 v88, v88
  v_rcp_f32 v89, v89
  v_rcp_f32 v90, v90
  v_rcp_f32 v91, v91
  v_rcp_f32 v92, v92
  v_rcp_f32 v93, v93
  v_rcp_f32 v94, v94
  v_rcp_f32 v95, v95
  v_pk_mul_f32 v[32:33], v[32:33], v[80:81]
  v_pk_mul_f32 v[34:35], v[34:35], v[82:83]
  v_pk_mul_f32 v[36:37], v[36:37], v[84:85]
  v_pk_mul_f32 v[38:39], v[38:39], v[86:87]
  v_pk_mul_f32 v[40:41], v[40:41], v[88:89]
  v_pk_mul_f32 v[42:43], v[42:43], v[90:91]
  v_pk_mul_f32 v[44:45], v[44:45], v[92:93]
  v_pk_mul_f32 v[46:47], v[46:47], v[94:95]
  v_cvt_pk_bf16_f32 v32, v32, v33
  v_cvt_pk_bf16_f32 v33, v34, v35
  v_cvt_pk_bf16_f32 v34, v36, v37
  v_cvt_pk_bf16_f32 v35, v38, v39
  v_cvt_pk_bf16_f32 v36, v40, v41
  v_cvt_pk_bf16_f32 v37, v42, v43
  v_cvt_pk_bf16_f32 v38, v44, v45
  v_cvt_pk_bf16_f32 v39, v46, v47
  v_permlane32_swap_b32 v32, v34
  v_permlane32_swap_b32 v33, v35
  buffer_store_dwordx4 v[32:35], v22, s[12:15], s22 offen offset:0
  v_permlane32_swap_b32 v36, v38
  v_permlane32_swap_b32 v37, v39
  buffer_store_dwordx4 v[36:39], v22, s[12:15], s22 offen offset:32
  v_pk_mul_f32 v[96:97], v[48:49], v[48:49]
  v_pk_mul_f32 v[98:99], v[50:51], v[50:51]
  v_pk_mul_f32 v[100:101], v[52:53], v[52:53]
  v_pk_mul_f32 v[102:103], v[54:55], v[54:55]
  v_pk_mul_f32 v[104:105], v[56:57], v[56:57]
  v_pk_mul_f32 v[106:107], v[58:59], v[58:59]
  v_pk_mul_f32 v[108:109], v[60:61], v[60:61]
  v_pk_mul_f32 v[110:111], v[62:63], v[62:63]
  v_pk_fma_f32 v[96:97], v[96:97], v[26:27], v[24:25] op_sel_hi:[1,0,0]
  v_pk_fma_f32 v[98:99], v[98:99], v[26:27], v[24:25] op_sel_hi:[1,0,0]
  v_pk_fma_f32 v[100:101], v[100:101], v[26:27], v[24:25] op_sel_hi:[1,0,0]
  v_pk_fma_f32 v[102:103], v[102:103], v[26:27], v[24:25] op_sel_hi:[1,0,0]
  v_pk_fma_f32 v[104:105], v[104:105], v[26:27], v[24:25] op_sel_hi:[1,0,0]
  v_pk_fma_f32 v[106:107], v[106:107], v[26:27], v[24:25] op_sel_hi:[1,0,0]
  v_pk_fma_f32 v[108:109], v[108:109], v[26:27], v[24:25] op_sel_hi:[1,0,0]
  v_pk_fma_f32 v[110:111], v[110:111], v[26:27], v[24:25] op_sel_hi:[1,0,0]
  v_pk_mul_f32 v[96:97], v[96:97], v[48:49]
  v_pk_mul_f32 v[98:99], v[98:99], v[50:51]
  v_pk_mul_f32 v[100:101], v[100:101], v[52:53]
  v_pk_mul_f32 v[102:103], v[102:103], v[54:55]
  v_pk_mul_f32 v[104:105], v[104:105], v[56:57]
  v_pk_mul_f32 v[106:107], v[106:107], v[58:59]
  v_pk_mul_f32 v[108:109], v[108:109], v[60:61]
  v_pk_mul_f32 v[110:111], v[110:111], v[62:63]
  v_exp_f32 v96, v96
  v_exp_f32 v97, v97
  v_exp_f32 v98, v98
  v_exp_f32 v99, v99
  v_exp_f32 v100, v100
  v_exp_f32 v101, v101
  v_exp_f32 v102, v102
  v_exp_f32 v103, v103
  v_exp_f32 v104, v104
  v_exp_f32 v105, v105
  v_exp_f32 v106, v106
  v_exp_f32 v107, v107
  v_exp_f32 v108, v108
  v_exp_f32 v109, v109
  v_exp_f32 v110, v110
  v_exp_f32 v111, v111
  v_pk_add_f32 v[96:97], v[96:97], v[28:29] op_sel_hi:[1,0]
  v_pk_add_f32 v[98:99], v[98:99], v[28:29] op_sel_hi:[1,0]
  v_pk_add_f32 v[100:101], v[100:101], v[28:29] op_sel_hi:[1,0]
  v_pk_add_f32 v[102:103], v[102:103], v[28:29] op_sel_hi:[1,0]
  v_pk_add_f32 v[104:105], v[104:105], v[28:29] op_sel_hi:[1,0]
  v_pk_add_f32 v[106:107], v[106:107], v[28:29] op_sel_hi:[1,0]
  v_pk_add_f32 v[108:109], v[108:109], v[28:29] op_sel_hi:[1,0]
  v_pk_add_f32 v[110:111], v[110:111], v[28:29] op_sel_hi:[1,0]
  v_rcp_f32 v96, v96
  v_rcp_f32 v97, v97
  v_rcp_f32 v98, v98
  v_rcp_f32 v99, v99
  v_rcp_f32 v100, v100
  v_rcp_f32 v101, v101
  v_rcp_f32 v102, v102
  v_rcp_f32 v103, v103
  v_rcp_f32 v104, v104
  v_rcp_f32 v105, v105
  v_rcp_f32 v106, v106
  v_rcp_f32 v107, v107
  v_rcp_f32 v108, v108
  v_rcp_f32 v109, v109
  v_rcp_f32 v110, v110
  v_rcp_f32 v111, v111
  v_pk_mul_f32 v[48:49], v[48:49], v[96:97]
  v_pk_mul_f32 v[50:51], v[50:51], v[98:99]
  v_pk_mul_f32 v[52:53], v[52:53], v[100:101]
  v_pk_mul_f32 v[54:55], v[54:55], v[102:103]
  v_pk_mul_f32 v[56:57], v[56:57], v[104:105]
  v_pk_mul_f32 v[58:59], v[58:59], v[106:107]
  v_pk_mul_f32 v[60:61], v[60:61], v[108:109]
  v_pk_mul_f32 v[62:63], v[62:63], v[110:111]
  v_cvt_pk_bf16_f32 v48, v48, v49
  v_cvt_pk_bf16_f32 v49, v50, v51
  v_cvt_pk_bf16_f32 v50, v52, v53
  v_cvt_pk_bf16_f32 v51, v54, v55
  v_cvt_pk_bf16_f32 v52, v56, v57
  v_cvt_pk_bf16_f32 v53, v58, v59
  v_cvt_pk_bf16_f32 v54, v60, v61
  v_cvt_pk_bf16_f32 v55, v62, v63
  v_permlane32_swap_b32 v48, v50
  v_permlane32_swap_b32 v49, v51
  buffer_store_dwordx4 v[48:51], v22, s[12:15], s24 offen offset:0
  v_permlane32_swap_b32 v52, v54
  v_permlane32_swap_b32 v53, v55
  buffer_store_dwordx4 v[52:55], v22, s[12:15], s24 offen offset:32
  v_pk_mul_f32 v[112:113], v[64:65], v[64:65]
  v_pk_mul_f32 v[114:115], v[66:67], v[66:67]
  v_pk_mul_f32 v[116:117], v[68:69], v[68:69]
  v_pk_mul_f32 v[118:119], v[70:71], v[70:71]
  v_pk_mul_f32 v[120:121], v[72:73], v[72:73]
  v_pk_mul_f32 v[122:123], v[74:75], v[74:75]
  v_pk_mul_f32 v[124:125], v[76:77], v[76:77]
  v_pk_mul_f32 v[126:127], v[78:79], v[78:79]
  v_pk_fma_f32 v[112:113], v[112:113], v[26:27], v[24:25] op_sel_hi:[1,0,0]
  v_pk_fma_f32 v[114:115], v[114:115], v[26:27], v[24:25] op_sel_hi:[1,0,0]
  v_pk_fma_f32 v[116:117], v[116:117], v[26:27], v[24:25] op_sel_hi:[1,0,0]
  v_pk_fma_f32 v[118:119], v[118:119], v[26:27], v[24:25] op_sel_hi:[1,0,0]
  v_pk_fma_f32 v[120:121], v[120:121], v[26:27], v[24:25] op_sel_hi:[1,0,0]
  v_pk_fma_f32 v[122:123], v[122:123], v[26:27], v[24:25] op_sel_hi:[1,0,0]
  v_pk_fma_f32 v[124:125], v[124:125], v[26:27], v[24:25] op_sel_hi:[1,0,0]
  v_pk_fma_f32 v[126:127], v[126:127], v[26:27], v[24:25] op_sel_hi:[1,0,0]
  v_pk_mul_f32 v[112:113], v[112:113], v[64:65]
  v_pk_mul_f32 v[114:115], v[114:115], v[66:67]
  v_pk_mul_f32 v[116:117], v[116:117], v[68:69]
  v_pk_mul_f32 v[118:119], v[118:119], v[70:71]
  v_pk_mul_f32 v[120:121], v[120:121], v[72:73]
  v_pk_mul_f32 v[122:123], v[122:123], v[74:75]
  v_pk_mul_f32 v[124:125], v[124:125], v[76:77]
  v_pk_mul_f32 v[126:127], v[126:127], v[78:79]
  v_exp_f32 v112, v112
  v_exp_f32 v113, v113
  v_exp_f32 v114, v114
  v_exp_f32 v115, v115
  v_exp_f32 v116, v116
  v_exp_f32 v117, v117
  v_exp_f32 v118, v118
  v_exp_f32 v119, v119
  v_exp_f32 v120, v120
  v_exp_f32 v121, v121
  v_exp_f32 v122, v122
  v_exp_f32 v123, v123
  v_exp_f32 v124, v124
  v_exp_f32 v125, v125
  v_exp_f32 v126, v126
  v_exp_f32 v127, v127
  v_pk_add_f32 v[112:113], v[112:113], v[28:29] op_sel_hi:[1,0]
  v_pk_add_f32 v[114:115], v[114:115], v[28:29] op_sel_hi:[1,0]
  v_pk_add_f32 v[116:117], v[116:117], v[28:29] op_sel_hi:[1,0]
  v_pk_add_f32 v[118:119], v[118:119], v[28:29] op_sel_hi:[1,0]
  v_pk_add_f32 v[120:121], v[120:121], v[28:29] op_sel_hi:[1,0]
  v_pk_add_f32 v[122:123], v[122:123], v[28:29] op_sel_hi:[1,0]
  v_pk_add_f32 v[124:125], v[124:125], v[28:29] op_sel_hi:[1,0]
  v_pk_add_f32 v[126:127], v[126:127], v[28:29] op_sel_hi:[1,0]
  v_rcp_f32 v112, v112
  v_rcp_f32 v113, v113
  v_rcp_f32 v114, v114
  v_rcp_f32 v115, v115
  v_rcp_f32 v116, v116
  v_rcp_f32 v117, v117
  v_rcp_f32 v118, v118
  v_rcp_f32 v119, v119
  v_rcp_f32 v120, v120
  v_rcp_f32 v121, v121
  v_rcp_f32 v122, v122
  v_rcp_f32 v123, v123
  v_rcp_f32 v124, v124
  v_rcp_f32 v125, v125
  v_rcp_f32 v126, v126
  v_rcp_f32 v127, v127
  v_pk_mul_f32 v[64:65], v[64:65], v[112:113]
  v_pk_mul_f32 v[66:67], v[66:67], v[114:115]
  v_pk_mul_f32 v[68:69], v[68:69], v[116:117]
  v_pk_mul_f32 v[70:71], v[70:71], v[118:119]
  v_pk_mul_f32 v[72:73], v[72:73], v[120:121]
  v_pk_mul_f32 v[74:75], v[74:75], v[122:123]
  v_pk_mul_f32 v[76:77], v[76:77], v[124:125]
  v_pk_mul_f32 v[78:79], v[78:79], v[126:127]
  v_cvt_pk_bf16_f32 v64, v64, v65
  v_cvt_pk_bf16_f32 v65, v66, v67
  v_cvt_pk_bf16_f32 v66, v68, v69
  v_cvt_pk_bf16_f32 v67, v70, v71
  v_cvt_pk_bf16_f32 v68, v72, v73
  v_cvt_pk_bf16_f32 v69, v74, v75
  v_cvt_pk_bf16_f32 v70, v76, v77
  v_cvt_pk_bf16_f32 v71, v78, v79
  v_permlane32_swap_b32 v64, v66
  v_permlane32_swap_b32 v65, v67
  buffer_store_dwordx4 v[64:67], v22, s[12:15], s25 offen offset:0
  v_permlane32_swap_b32 v68, v70
  v_permlane32_swap_b32 v69, v71
  buffer_store_dwordx4 v[68:71], v22, s[12:15], s25 offen offset:32
  s_endpgm
k1_loader:
  s_setprio 3
  s_mov_b32 s16, s28
  s_and_b32 s17, s29, 0xffff
  s_mov_b32 s18, 18874368
  s_mov_b32 s19, 0x20000
  v_lshrrev_b32 v1, 4, v0
  v_bfe_u32 v2, v0, 2, 2
  v_xor_b32 v2, v2, v1
  v_lshlrev_b32 v2, 6, v2
  v_and_b32 v3, 3, v0
  v_lshl_add_u32 v2, v3, 4, v2
  v_mul_u32_u24 v3, 9216, v1
  v_add_u32 v2, v2, v3
  v_lshrrev_b32 v3, 3, v0
  v_mul_u32_u24 v3, 4224, v3
  v_and_b32 v4, 7, v0
  v_xor_b32 v4, v4, v1
  v_lshl_add_u32 v5, v4, 4, v3
  v_xor_b32 v4, 4, v4
  v_lshl_add_u32 v6, v4, 4, v3
  s_lshl_b32 s22, s7, 8
  s_mul_i32 s23, s6, 405504
  s_sub_u32 s39, s3, 4
  s_mul_i32 s39, s39, 7168
  s_cmp_eq_u32 s3, 5
  s_cbranch_scc1 k1_ls1
  s_cmp_eq_u32 s3, 6
  s_cbranch_scc1 k1_ls2
  s_cmp_eq_u32 s3, 7
  s_cbranch_scc1 k1_ls3
  v_add_u32 v248, 0, v2
  v_add_u32 v249, 35840, v2
  v_add_u32 v250, 71680, v2
  v_add_u32 v251, 107520, v2
  v_add_u32 v252, 147456, v2
  v_add_u32 v253, 183296, v2
  v_add_u32 v254, 219136, v2
  s_mov_b32 s76, s24
  s_and_b32 s77, s25, 0xffff
  s_mov_b32 s78, 18874368
  s_mov_b32 s79, 0x20000
  s_mov_b32 s74, s22
  s_mov_b32 s100, 589824
  s_mov_b32 s96, s24
  s_and_b32 s97, s25, 0xffff
  s_mov_b32 s98, 18874368
  s_mov_b32 s99, 0x20000
  s_mov_b32 s75, s22
  s_mov_b32 s101, 589824
  s_branch k1_lgo
k1_ls1:
  v_add_u32 v248, 258048, v2
  v_add_u32 v249, 293888, v2
  v_add_u32 v250, 329728, v2
  v_add_u32 v251, 365568, v2
  v_add_u32 v252, 405504, v2
  v_add_u32 v253, 441344, v2
  v_add_u32 v254, 477184, v2
  s_mov_b32 s76, s24
  s_and_b32 s77, s25, 0xffff
  s_mov_b32 s78, 18874368
  s_mov_b32 s79, 0x20000
  s_mov_b32 s74, s22
  s_mov_b32 s100, 589824
  s_mov_b32 s96, s24
  s_and_b32 s97, s25, 0xffff
  s_mov_b32 s98, 18874368
  s_mov_b32 s99, 0x20000
  s_mov_b32 s75, s22
  s_mov_b32 s101, 589824
  s_branch k1_lgo
k1_ls2:
  v_add_u32 v248, 516096, v2
  v_add_u32 v249, 551936, v2
  v_add_u32 v250, 2048, v5
  v_add_u32 v251, 34816, v6
  v_add_u32 v252, 71680, v5
  v_add_u32 v253, 104448, v6
  v_add_u32 v254, 137216, v5
  s_mov_b32 s76, s24
  s_and_b32 s77, s25, 0xffff
  s_mov_b32 s78, 18874368
  s_mov_b32 s79, 0x20000
  s_mov_b32 s74, s22
  s_mov_b32 s100, 589824
  s_mov_b32 s96, s30
  s_and_b32 s97, s31, 0xffff
  s_mov_b32 s98, 37355520
  s_mov_b32 s99, 0x20000
  s_mov_b32 s75, s23
  s_mov_b32 s101, 128
  s_branch k1_lgo
k1_ls3:
  v_add_u32 v248, 173056, v6
  v_add_u32 v249, 205824, v5
  v_add_u32 v250, 238592, v6
  v_add_u32 v251, 271360, v5
  v_add_u32 v252, 308224, v6
  v_add_u32 v253, 340992, v5
  v_add_u32 v254, 373760, v6
  s_mov_b32 s76, s30
  s_and_b32 s77, s31, 0xffff
  s_mov_b32 s78, 37355520
  s_mov_b32 s79, 0x20000
  s_mov_b32 s74, s23
  s_mov_b32 s100, 128
  s_mov_b32 s96, s30
  s_and_b32 s97, s31, 0xffff
  s_mov_b32 s98, 37355520
  s_mov_b32 s99, 0x20000
  s_mov_b32 s75, s23
  s_mov_b32 s101, 128
k1_lgo:
  s_mul_i32 s34, s4, 27
  s_add_u32 s34, s34, s5
  s_lshl_b32 s34, s34, 2
  s_add_u32 s34, s34, s3
  s_sub_u32 s34, s34, 4
  s_add_u32 s35, s34, 384
  s_add_u32 s33, s34, 0
  s_cmp_ge_u32 s33, 288
  s_cselect_b32 s32, 384, 0
  s_add_u32 s35, s35, s32
  s_cmp_ge_u32 s33, 544
  s_cselect_b32 s32, 384, 0
  s_add_u32 s35, s35, s32
  s_cmp_ge_u32 s33, 800
  s_cselect_b32 s32, 384, 0
  s_add_u32 s35, s35, s32
  s_lshl_b32 s35, s35, 13
  v_lshlrev_b32 v255, 7, v0
  s_mul_i32 s20, s5, 8
  s_add_u32 s22, s20, 8
  s_add_u32 s20, s20, s3
  s_sub_u32 s20, s20, 4
  s_mov_b32 s21, 4
  s_add_u32 m0, s39, 0
  s_nop 0
  buffer_load_dwordx4 v248, s[76:79], s74 offen offset:0 lds
  buffer_load_dwordx4 v249, s[76:79], s74 offen offset:1024 lds
  buffer_load_dwordx4 v250, s[96:99], s75 offen offset:2048 lds
  buffer_load_dwordx4 v251, s[96:99], s75 offen offset:3072 lds
  s_add_u32 m0, s39, 4096
  s_nop 0
  buffer_load_dwordx4 v252, s[96:99], s75 offen offset:0 lds
  buffer_load_dwordx4 v253, s[96:99], s75 offen offset:1024 lds
  buffer_load_dwordx4 v254, s[96:99], s75 offen offset:2048 lds
  s_add_u32 s74, s74, s100
  s_add_u32 s75, s75, s101
  s_add_u32 m0, s39, 28672
  s_nop 0
  buffer_load_dwordx4 v248, s[76:79], s74 offen offset:0 lds
  buffer_load_dwordx4 v249, s[76:79], s74 offen offset:1024 lds
  buffer_load_dwordx4 v250, s[96:99], s75 offen offset:2048 lds
  buffer_load_dwordx4 v251, s[96:99], s75 offen offset:3072 lds
  s_add_u32 m0, s39, 32768
  s_nop 0
  buffer_load_dwordx4 v252, s[96:99], s75 offen offset:0 lds
  buffer_load_dwordx4 v253, s[96:99], s75 offen offset:1024 lds
  buffer_load_dwordx4 v254, s[96:99], s75 offen offset:2048 lds
  s_add_u32 s74, s74, s100
  s_add_u32 s75, s75, s101
  v_and_b32 v10, 31, v0
  v_lshrrev_b32 v9, 5, v0
  v_lshlrev_b32 v1, 5, v10
  v_lshl_add_u32 v1, v9, 4, v1
  v_lshlrev_b32 v2, 3, v10
  v_lshl_add_u32 v2, v9, 8, v2
  v_cmp_gt_u32 vcc, 18, v10
  v_lshlrev_b32 v3, 4, v9
  v_add_u32 v3, 18432, v3
  v_cndmask_b32 v3, v3, v1, vcc
  v_mov_b32 v5, 576
  v_cndmask_b32 v4, 0, v5, vcc
  v_lshlrev_b32 v6, 1, v10
  v_lshl_add_u32 v6, v9, 14, v6
  v_lshl_add_u32 v7, v9, 30, v6
  v_lshlrev_b32 v12, 2, v9
  v_sub_u32 v12, v10, v12
  v_cmp_gt_i32 s[40:41], 0, v12
  v_cmp_gt_i32 s[42:43], 1, v12
  v_cmp_gt_i32 s[44:45], 2, v12
  v_cmp_gt_i32 s[46:47], 3, v12
  v_cmp_gt_i32 s[48:49], 8, v12
  v_cmp_gt_i32 s[50:51], 9, v12
  v_cmp_gt_i32 s[52:53], 10, v12
  v_cmp_gt_i32 s[54:55], 11, v12
  v_cmp_gt_i32 s[56:57], 16, v12
  v_cmp_gt_i32 s[58:59], 17, v12
  v_cmp_gt_i32 s[60:61], 18, v12
  v_cmp_gt_i32 s[62:63], 19, v12
  v_cmp_gt_i32 s[64:65], 24, v12
  v_cmp_gt_i32 s[66:67], 25, v12
  v_cmp_gt_i32 s[68:69], 26, v12
  v_cmp_gt_i32 s[70:71], 27, v12
  v_mov_b32 v12, 0xffff
  v_mov_b32 v13, 0xffff0000
  v_cndmask_b32 v16, 0, v12, s[40:41]
  v_cndmask_b32 v10, 0, v13, s[42:43]
  v_or_b32 v16, v16, v10
  v_cndmask_b32 v17, 0, v12, s[44:45]
  v_cndmask_b32 v10, 0, v13, s[46:47]
  v_or_b32 v17, v17, v10
  v_cndmask_b32 v18, 0, v12, s[48:49]
  v_cndmask_b32 v10, 0, v13, s[50:51]
  v_or_b32 v18, v18, v10
  v_cndmask_b32 v19, 0, v12, s[52:53]
  v_cndmask_b32 v10, 0, v13, s[54:55]
  v_or_b32 v19, v19, v10
  v_cndmask_b32 v20, 0, v12, s[56:57]
  v_cndmask_b32 v10, 0, v13, s[58:59]
  v_or_b32 v20, v20, v10
  v_cndmask_b32 v21, 0, v12, s[60:61]
  v_cndmask_b32 v10, 0, v13, s[62:63]
  v_or_b32 v21, v21, v10
  v_cndmask_b32 v22, 0, v12, s[64:65]
  v_cndmask_b32 v10, 0, v13, s[66:67]
  v_or_b32 v22, v22, v10
  v_cndmask_b32 v23, 0, v12, s[68:69]
  v_cndmask_b32 v10, 0, v13, s[70:71]
  v_or_b32 v23, v23, v10
  v_mov_b32 v37, 0
  v_mov_b32 v39, 0
  v_mov_b32 v40, 0
  v_mov_b32 v42, 0
  v_mov_b32 v29, 0
  v_mov_b32 v48, 0x3f803f80
  v_mov_b32 v49, 0x3f803f80
  v_mov_b32 v50, 0x3f803f80
  v_mov_b32 v51, 0x3f803f80
  v_mov_b32 v52, 0x3f803f80
  v_mov_b32 v53, 0x3f803f80
  v_mov_b32 v54, 0x3f803f80
  v_mov_b32 v55, 0x3f803f80
  v_mov_b32 v56, 0x3f803f80
  v_mov_b32 v57, 0x3f803f80
  v_mov_b32 v58, 0x3f803f80
  v_mov_b32 v59, 0x3f803f80
  v_mov_b32 v60, 0x3f803f80
  v_mov_b32 v61, 0x3f803f80
  v_mov_b32 v62, 0x3f803f80
  v_mov_b32 v63, 0x3f803f80
  v_mov_b32 v64, 0x3f803f80
  v_mov_b32 v65, 0x3f803f80
  v_mov_b32 v66, 0x3f803f80
  v_mov_b32 v67, 0x3f803f80
  v_mov_b32 v68, 0x3f803f80
  v_mov_b32 v69, 0x3f803f80
  v_mov_b32 v70, 0x3f803f80
  v_mov_b32 v71, 0x3f803f80
  v_mov_b32 v72, 0x3f803f80
  v_mov_b32 v73, 0x3f803f80
  v_mov_b32 v74, 0x3f803f80
  v_mov_b32 v75, 0x3f803f80
  v_mov_b32 v76, 0x3f803f80
  v_mov_b32 v77, 0x3f803f80
  v_mov_b32 v78, 0x3f803f80
  v_mov_b32 v79, 0x3f803f80
  v_mov_b32 v80, 0x3f803f80
  v_mov_b32 v81, 0x3f803f80
  v_mov_b32 v82, 0x3f803f80
  v_mov_b32 v83, 0x3f803f80
  v_mov_b32 v84, 0x3f803f80
  v_mov_b32 v85, 0x3f803f80
  v_mov_b32 v86, 0x3f803f80
  v_mov_b32 v87, 0x3f803f80
  v_mov_b32 v88, 0x3f803f80
  v_mov_b32 v89, 0x3f803f80
  v_mov_b32 v90, 0x3f803f80
  v_mov_b32 v91, 0x3f803f80
  v_mov_b32 v92, 0x3f803f80
  v_mov_b32 v93, 0x3f803f80
  v_mov_b32 v94, 0x3f803f80
  v_mov_b32 v95, 0x3f803f80
  v_mov_b32 v96, 0x3f803f80
  v_mov_b32 v97, 0x3f803f80
  v_mov_b32 v98, 0x3f803f80
  v_mov_b32 v99, 0x3f803f80
  v_mov_b32 v100, 0x3f803f80
  v_mov_b32 v101, 0x3f803f80
  v_mov_b32 v102, 0x3f803f80
  v_mov_b32 v103, 0x3f803f80
  v_cmp_gt_u32 s[72:73], 32, v0
  v_mov_b32 v14, 0x3eae1a93
  s_mov_b32 s38, 0xff800000
  s_lshr_b32 s30, s20, 6
  s_lshl_b32 s31, s4, 2
  s_add_u32 s30, s30, s31
  s_and_b32 s31, s20, 63
  s_lshl_b32 s24, s30, 16
  s_lshl_b32 s25, s31, 10
  s_add_u32 s24, s24, s25
  s_add_u32 s27, s24, 10878976
  s_add_u32 s24, s24, 13230080
  s_add_u32 s25, s24, 4096
  s_add_u32 s26, s24, 8192
  s_lshr_b32 s28, s30, 1
  s_lshl_b32 s28, s28, 14
  s_and_b32 s29, s30, 1
  s_lshl_b32 s29, s29, 2
  s_add_u32 s28, s28, s29
  s_lshl_b32 s29, s31, 8
  s_add_u32 s28, s28, s29
  s_add_u32 s29, s28, 12976128
  s_add_u32 s28, s28, 15333376
  buffer_load_dwordx4 v[32:35], v1, s[12:15], s27 offen
  v_and_b32 v10, 0xff, v2
  buffer_load_dword v8, v10, s[12:15], s29 offen
  buffer_load_dword v24, v2, s[12:15], s28 offen offset:0
  buffer_load_dword v25, v2, s[12:15], s28 offen offset:512
  buffer_load_dword v26, v2, s[12:15], s28 offen offset:1024
  buffer_load_dword v27, v2, s[12:15], s28 offen offset:1536
  buffer_load_dword v28, v2, s[12:15], s28 offen offset:2048
  buffer_load_dwordx4 v[44:47], v1, s[12:15], s24 offen offset:1024
  buffer_load_dwordx4 v[176:179], v1, s[12:15], s26 offen offset:0
  buffer_load_dwordx4 v[180:183], v1, s[12:15], s24 offen offset:0
  buffer_load_dwordx4 v[164:167], v1, s[12:15], s25 offen offset:3072
  buffer_load_dwordx4 v[160:163], v1, s[12:15], s25 offen offset:2048
  buffer_load_dwordx4 v[148:151], v1, s[12:15], s25 offen offset:1024
  buffer_load_dwordx4 v[144:147], v1, s[12:15], s25 offen offset:0
  buffer_load_dwordx4 v[132:135], v1, s[12:15], s24 offen offset:3072
  buffer_load_dwordx4 v[128:131], v1, s[12:15], s24 offen offset:2048
  s_waitcnt vmcnt(23)
  s_barrier
  s_add_u32 m0, s39, 57344
  s_nop 0
  buffer_load_dwordx4 v248, s[76:79], s74 offen offset:0 lds
  buffer_load_dwordx4 v249, s[76:79], s74 offen offset:1024 lds
  buffer_load_dwordx4 v250, s[96:99], s75 offen offset:2048 lds
  buffer_load_dwordx4 v251, s[96:99], s75 offen offset:3072 lds
  s_add_u32 m0, s39, 61440
  s_nop 0
  buffer_load_dwordx4 v252, s[96:99], s75 offen offset:0 lds
  buffer_load_dwordx4 v253, s[96:99], s75 offen offset:1024 lds
  buffer_load_dwordx4 v254, s[96:99], s75 offen offset:2048 lds
  s_add_u32 s74, s74, s100
  s_add_u32 s75, s75, s101
  s_mov_b32 s32, s30
  s_mov_b32 s33, s31
  v_mad_u32_u24 v5, v4, s32, v3
  s_add_i32 s36, s33, -8
  s_max_i32 s36, s36, 0
  s_mul_i32 s36, s36, 36928
  s_add_u32 s36, s36, 15597568
  s_add_u32 s37, s36, 18464
  s_mov_b32 exec_lo, 0x3ffff
  s_mov_b32 exec_hi, 0x3ffff
  buffer_load_dwordx4 v[48:51], v5, s[12:15], s36 offen
  buffer_load_dwordx4 v[52:55], v5, s[12:15], s37 offen
  s_mov_b64 exec, -1
  s_add_i32 s36, s33, 0
  s_max_i32 s36, s36, 0
  s_mul_i32 s36, s36, 36928
  s_add_u32 s36, s36, 15597568
  s_add_u32 s37, s36, 18464
  s_mov_b32 exec_lo, 0x3ffff
  s_mov_b32 exec_hi, 0x3ffff
  buffer_load_dwordx4 v[56:59], v5, s[12:15], s36 offen
  buffer_load_dwordx4 v[60:63], v5, s[12:15], s37 offen
  s_mov_b64 exec, -1
  s_add_i32 s36, s33, -7
  s_max_i32 s36, s36, 0
  s_mul_i32 s36, s36, 36928
  s_add_u32 s36, s36, 15597568
  s_add_u32 s37, s36, 18464
  s_mov_b32 exec_lo, 0x3ffff
  s_mov_b32 exec_hi, 0x3ffff
  buffer_load_dwordx4 v[64:67], v5, s[12:15], s36 offen
  buffer_load_dwordx4 v[68:71], v5, s[12:15], s37 offen
  s_mov_b64 exec, -1
  s_add_i32 s36, s33, -6
  s_max_i32 s36, s36, 0
  s_mul_i32 s36, s36, 36928
  s_add_u32 s36, s36, 15597568
  s_add_u32 s37, s36, 18464
  s_mov_b32 exec_lo, 0x3ffff
  s_mov_b32 exec_hi, 0x3ffff
  buffer_load_dwordx4 v[72:75], v5, s[12:15], s36 offen
  buffer_load_dwordx4 v[76:79], v5, s[12:15], s37 offen
  s_mov_b64 exec, -1
  s_add_i32 s36, s33, -5
  s_max_i32 s36, s36, 0
  s_mul_i32 s36, s36, 36928
  s_add_u32 s36, s36, 15597568
  s_add_u32 s37, s36, 18464
  s_mov_b32 exec_lo, 0x3ffff
  s_mov_b32 exec_hi, 0x3ffff
  buffer_load_dwordx4 v[80:83], v5, s[12:15], s36 offen
  buffer_load_dwordx4 v[84:87], v5, s[12:15], s37 offen
  s_mov_b64 exec, -1
  s_add_i32 s36, s33, -4
  s_max_i32 s36, s36, 0
  s_mul_i32 s36, s36, 36928
  s_add_u32 s36, s36, 15597568
  s_add_u32 s37, s36, 18464
  s_mov_b32 exec_lo, 0x3ffff
  s_mov_b32 exec_hi, 0x3ffff
  buffer_load_dwordx4 v[88:91], v5, s[12:15], s36 offen
  buffer_load_dwordx4 v[92:95], v5, s[12:15], s37 offen
  s_mov_b64 exec, -1
  s_add_i32 s36, s33, -3
  s_max_i32 s36, s36, 0
  s_mul_i32 s36, s36, 36928
  s_add_u32 s36, s36, 15597568
  s_add_u32 s37, s36, 18464
  s_mov_b32 exec_lo, 0x3ffff
  s_mov_b32 exec_hi, 0x3ffff
  buffer_load_dwordx4 v[96:99], v5, s[12:15], s36 offen
  buffer_load_dwordx4 v[100:103], v5, s[12:15], s37 offen
  s_mov_b64 exec, -1
  s_add_u32 m0, s39, 86016
  s_nop 0
  buffer_load_dwordx4 v248, s[76:79], s74 offen offset:0 lds
  buffer_load_dwordx4 v249, s[76:79], s74 offen offset:1024 lds
  buffer_load_dwordx4 v250, s[96:99], s75 offen offset:2048 lds
  buffer_load_dwordx4 v251, s[96:99], s75 offen offset:3072 lds
  s_add_u32 m0, s39, 90112
  s_nop 0
  buffer_load_dwordx4 v252, s[96:99], s75 offen offset:0 lds
  buffer_load_dwordx4 v253, s[96:99], s75 offen offset:1024 lds
  buffer_load_dwordx4 v254, s[96:99], s75 offen offset:2048 lds
  s_add_u32 s74, s74, s100
  s_add_u32 s75, s75, s101
  s_add_u32 m0, s39, 114688
  s_nop 0
  buffer_load_dwordx4 v248, s[76:79], s74 offen offset:0 lds
  buffer_load_dwordx4 v249, s[76:79], s74 offen offset:1024 lds
  buffer_load_dwordx4 v250, s[96:99], s75 offen offset:2048 lds
  buffer_load_dwordx4 v251, s[96:99], s75 offen offset:3072 lds
  s_add_u32 m0, s39, 118784
  s_nop 0
  buffer_load_dwordx4 v252, s[96:99], s75 offen offset:0 lds
  buffer_load_dwordx4 v253, s[96:99], s75 offen offset:1024 lds
  buffer_load_dwordx4 v254, s[96:99], s75 offen offset:2048 lds
  s_add_u32 s74, s74, s100
  s_add_u32 s75, s75, s101
  s_setprio 1
  s_add_u32 s20, s20, s21
  s_sub_u32 s34, s22, 1
  s_min_u32 s34, s34, s20
  s_lshr_b32 s30, s34, 6
  s_lshl_b32 s31, s4, 2
  s_add_u32 s30, s30, s31
  s_and_b32 s31, s34, 63
  s_lshl_b32 s24, s30, 16
  s_lshl_b32 s25, s31, 10
  s_add_u32 s24, s24, s25
  s_add_u32 s27, s24, 10878976
  s_add_u32 s24, s24, 13230080
  s_add_u32 s25, s24, 4096
  s_add_u32 s26, s24, 8192
  s_lshr_b32 s28, s30, 1
  s_lshl_b32 s28, s28, 14
  s_and_b32 s29, s30, 1
  s_lshl_b32 s29, s29, 2
  s_add_u32 s28, s28, s29
  s_lshl_b32 s29, s31, 8
  s_add_u32 s28, s28, s29
  s_add_u32 s29, s28, 12976128
  s_add_u32 s28, s28, 15333376
  s_waitcnt vmcnt(35)
  v_cndmask_b32 v36, 0, v8, s[72:73]
  v_cndmask_b32 v41, 0, v8, s[72:73]
  v_cndmask_b32 v38, v8, 0, s[72:73]
  v_cndmask_b32 v43, v8, 0, s[72:73]
  v_mfma_f32_32x32x16_bf16 v[232:247], v[176:179], v[32:35], 0
  v_mfma_f32_32x32x8bf16_1k v[232:247], v[28:29], v[36:37], v[232:247]
  v_mfma_f32_32x32x16_bf16 v[104:119], v[180:183], v[32:35], 0
  v_mfma_f32_32x32x8bf16_1k v[104:119], v[24:25], v[36:37], v[104:119]
  v_mfma_f32_32x32x16_bf16 v[216:231], v[164:167], v[32:35], 0
  v_mfma_f32_32x32x8bf16_1k v[216:231], v[26:27], v[42:43], v[216:231]
  v_mfma_f32_32x32x16_bf16 v[200:215], v[160:163], v[32:35], 0
  s_setprio 3
  s_waitcnt vmcnt(51)
  s_barrier
  s_add_u32 m0, s39, 0
  s_nop 0
  buffer_load_dwordx4 v248, s[76:79], s74 offen offset:0 lds
  buffer_load_dwordx4 v249, s[76:79], s74 offen offset:1024 lds
  buffer_load_dwordx4 v250, s[96:99], s75 offen offset:2048 lds
  buffer_load_dwordx4 v251, s[96:99], s75 offen offset:3072 lds
  s_add_u32 m0, s39, 4096
  s_nop 0
  buffer_load_dwordx4 v252, s[96:99], s75 offen offset:0 lds
  buffer_load_dwordx4 v253, s[96:99], s75 offen offset:1024 lds
  buffer_load_dwordx4 v254, s[96:99], s75 offen offset:2048 lds
  s_add_u32 s74, s74, s100
  s_add_u32 s75, s75, s101
  s_setprio 1
  v_mfma_f32_32x32x8bf16_1k v[200:215], v[26:27], v[40:41], v[200:215]
  s_cmp_ge_u32 s33, 8
  s_cbranch_scc1 k1v_3
  v_mov_b32 v104, s38
  v_mov_b32 v105, s38
  v_mov_b32 v106, s38
  v_mov_b32 v107, s38
  v_mov_b32 v108, s38
  v_mov_b32 v109, s38
  v_mov_b32 v110, s38
  v_mov_b32 v111, s38
  v_mov_b32 v112, s38
  v_mov_b32 v113, s38
  v_mov_b32 v114, s38
  v_mov_b32 v115, s38
  v_mov_b32 v116, s38
  v_mov_b32 v117, s38
  v_mov_b32 v118, s38
  v_mov_b32 v119, s38
k1v_3:
  v_cndmask_b32 v104, v232, v104, s[40:41]
  v_cndmask_b32 v105, v233, v105, s[42:43]
  v_cndmask_b32 v106, v234, v106, s[44:45]
  v_cndmask_b32 v107, v235, v107, s[46:47]
  v_cndmask_b32 v108, v236, v108, s[48:49]
  v_cndmask_b32 v109, v237, v109, s[50:51]
  v_cndmask_b32 v110, v238, v110, s[52:53]
  v_cndmask_b32 v111, v239, v111, s[54:55]
  v_cndmask_b32 v112, v240, v112, s[56:57]
  v_cndmask_b32 v113, v241, v113, s[58:59]
  v_cndmask_b32 v114, v242, v114, s[60:61]
  v_cndmask_b32 v115, v243, v115, s[62:63]
  v_cndmask_b32 v116, v244, v116, s[64:65]
  v_cndmask_b32 v117, v245, v117, s[66:67]
  v_cndmask_b32 v118, v246, v118, s[68:69]
  v_cndmask_b32 v119, v247, v119, s[70:71]
  v_max_f32 v9, v104, v105
  v_max3_f32 v9, v106, v107, v9
  v_max3_f32 v9, v108, v109, v9
  v_max3_f32 v9, v110, v111, v9
  v_max3_f32 v9, v112, v113, v9
  v_max3_f32 v9, v114, v115, v9
  v_max3_f32 v9, v116, v117, v9
  v_max3_f32 v9, v118, v119, v9
  v_mfma_f32_32x32x16_bf16 v[184:199], v[148:151], v[32:35], 0
  v_mfma_f32_32x32x8bf16_1k v[184:199], v[26:27], v[38:39], v[184:199]
  s_cmp_ge_u32 s33, 1
  s_cbranch_scc1 k1v_4
  v_mov_b32 v216, s38
  v_mov_b32 v217, s38
  v_mov_b32 v218, s38
  v_mov_b32 v219, s38
  v_mov_b32 v220, s38
  v_mov_b32 v221, s38
  v_mov_b32 v222, s38
  v_mov_b32 v223, s38
  v_mov_b32 v224, s38
  v_mov_b32 v225, s38
  v_mov_b32 v226, s38
  v_mov_b32 v227, s38
  v_mov_b32 v228, s38
  v_mov_b32 v229, s38
  v_mov_b32 v230, s38
  v_mov_b32 v231, s38
k1v_4:
  v_max3_f32 v9, v216, v217, v9
  v_max3_f32 v9, v218, v219, v9
  v_max3_f32 v9, v220, v221, v9
  v_max3_f32 v9, v222, v223, v9
  v_max3_f32 v9, v224, v225, v9
  v_max3_f32 v9, v226, v227, v9
  v_max3_f32 v9, v228, v229, v9
  v_max3_f32 v9, v230, v231, v9
  v_mfma_f32_32x32x16_bf16 v[168:183], v[144:147], v[32:35], 0
  v_mfma_f32_32x32x8bf16_1k v[168:183], v[26:27], v[36:37], v[168:183]
  s_cmp_ge_u32 s33, 2
  s_cbranch_scc1 k1v_5
  v_mov_b32 v200, s38
  v_mov_b32 v201, s38
  v_mov_b32 v202, s38
  v_mov_b32 v203, s38
  v_mov_b32 v204, s38
  v_mov_b32 v205, s38
  v_mov_b32 v206, s38
  v_mov_b32 v207, s38
  v_mov_b32 v208, s38
  v_mov_b32 v209, s38
  v_mov_b32 v210, s38
  v_mov_b32 v211, s38
  v_mov_b32 v212, s38
  v_mov_b32 v213, s38
  v_mov_b32 v214, s38
  v_mov_b32 v215, s38
k1v_5:
  s_setprio 3
  s_waitcnt vmcnt(35)
  s_barrier
  s_add_u32 m0, s39, 28672
  s_nop 0
  buffer_load_dwordx4 v248, s[76:79], s74 offen offset:0 lds
  buffer_load_dwordx4 v249, s[76:79], s74 offen offset:1024 lds
  buffer_load_dwordx4 v250, s[96:99], s75 offen offset:2048 lds
  buffer_load_dwordx4 v251, s[96:99], s75 offen offset:3072 lds
  s_add_u32 m0, s39, 32768
  s_nop 0
  buffer_load_dwordx4 v252, s[96:99], s75 offen offset:0 lds
  buffer_load_dwordx4 v253, s[96:99], s75 offen offset:1024 lds
  buffer_load_dwordx4 v254, s[96:99], s75 offen offset:2048 lds
  s_add_u32 s74, s74, s100
  s_add_u32 s75, s75, s101
  s_setprio 1
  v_max3_f32 v9, v200, v201, v9
  v_max3_f32 v9, v202, v203, v9
  v_max3_f32 v9, v204, v205, v9
  v_max3_f32 v9, v206, v207, v9
  v_max3_f32 v9, v208, v209, v9
  v_max3_f32 v9, v210, v211, v9
  v_max3_f32 v9, v212, v213, v9
  v_max3_f32 v9, v214, v215, v9
  v_mfma_f32_32x32x16_bf16 v[152:167], v[132:135], v[32:35], 0
  v_mfma_f32_32x32x8bf16_1k v[152:167], v[24:25], v[42:43], v[152:167]
  s_cmp_ge_u32 s33, 3
  s_cbranch_scc1 k1v_6
  v_mov_b32 v184, s38
  v_mov_b32 v185, s38
  v_mov_b32 v186, s38
  v_mov_b32 v187, s38
  v_mov_b32 v188, s38
  v_mov_b32 v189, s38
  v_mov_b32 v190, s38
  v_mov_b32 v191, s38
  v_mov_b32 v192, s38
  v_mov_b32 v193, s38
  v_mov_b32 v194, s38
  v_mov_b32 v195, s38
  v_mov_b32 v196, s38
  v_mov_b32 v197, s38
  v_mov_b32 v198, s38
  v_mov_b32 v199, s38
k1v_6:
  v_max3_f32 v9, v184, v185, v9
  v_max3_f32 v9, v186, v187, v9
  v_max3_f32 v9, v188, v189, v9
  v_max3_f32 v9, v190, v191, v9
  v_max3_f32 v9, v192, v193, v9
  v_max3_f32 v9, v194, v195, v9
  v_max3_f32 v9, v196, v197, v9
  v_max3_f32 v9, v198, v199, v9
  v_mfma_f32_32x32x16_bf16 v[136:151], v[128:131], v[32:35], 0
  v_mfma_f32_32x32x8bf16_1k v[136:151], v[24:25], v[40:41], v[136:151]
  s_cmp_ge_u32 s33, 4
  s_cbranch_scc1 k1v_7
  v_mov_b32 v168, s38
  v_mov_b32 v169, s38
  v_mov_b32 v170, s38
  v_mov_b32 v171, s38
  v_mov_b32 v172, s38
  v_mov_b32 v173, s38
  v_mov_b32 v174, s38
  v_mov_b32 v175, s38
  v_mov_b32 v176, s38
  v_mov_b32 v177, s38
  v_mov_b32 v178, s38
  v_mov_b32 v179, s38
  v_mov_b32 v180, s38
  v_mov_b32 v181, s38
  v_mov_b32 v182, s38
  v_mov_b32 v183, s38
k1v_7:
  v_max3_f32 v9, v168, v169, v9
  v_max3_f32 v9, v170, v171, v9
  v_max3_f32 v9, v172, v173, v9
  v_max3_f32 v9, v174, v175, v9
  v_max3_f32 v9, v176, v177, v9
  v_max3_f32 v9, v178, v179, v9
  v_max3_f32 v9, v180, v181, v9
  v_max3_f32 v9, v182, v183, v9
  v_mfma_f32_32x32x16_bf16 v[120:135], v[44:47], v[32:35], 0
  v_mfma_f32_32x32x8bf16_1k v[120:135], v[24:25], v[38:39], v[120:135]
  s_cmp_ge_u32 s33, 5
  s_cbranch_scc1 k1v_8
  v_mov_b32 v152, s38
  v_mov_b32 v153, s38
  v_mov_b32 v154, s38
  v_mov_b32 v155, s38
  v_mov_b32 v156, s38
  v_mov_b32 v157, s38
  v_mov_b32 v158, s38
  v_mov_b32 v159, s38
  v_mov_b32 v160, s38
  v_mov_b32 v161, s38
  v_mov_b32 v162, s38
  v_mov_b32 v163, s38
  v_mov_b32 v164, s38
  v_mov_b32 v165, s38
  v_mov_b32 v166, s38
  v_mov_b32 v167, s38
k1v_8:
  s_setprio 3
  s_waitcnt vmcnt(21)
  s_barrier
  s_add_u32 m0, s39, 57344
  s_nop 0
  buffer_load_dwordx4 v248, s[76:79], s74 offen offset:0 lds
  buffer_load_dwordx4 v249, s[76:79], s74 offen offset:1024 lds
  buffer_load_dwordx4 v250, s[96:99], s75 offen offset:2048 lds
  buffer_load_dwordx4 v251, s[96:99], s75 offen offset:3072 lds
  s_add_u32 m0, s39, 61440
  s_nop 0
  buffer_load_dwordx4 v252, s[96:99], s75 offen offset:0 lds
  buffer_load_dwordx4 v253, s[96:99], s75 offen offset:1024 lds
  buffer_load_dwordx4 v254, s[96:99], s75 offen offset:2048 lds
  s_add_u32 s74, s74, s100
  s_add_u32 s75, s75, s101
  s_setprio 1
  v_max3_f32 v9, v152, v153, v9
  v_max3_f32 v9, v154, v155, v9
  v_max3_f32 v9, v156, v157, v9
  v_max3_f32 v9, v158, v159, v9
  v_max3_f32 v9, v160, v161, v9
  v_max3_f32 v9, v162, v163, v9
  v_max3_f32 v9, v164, v165, v9
  v_max3_f32 v9, v166, v167, v9
  buffer_load_dwordx4 v[32:35], v1, s[12:15], s27 offen
  v_and_b32 v10, 0xff, v2
  buffer_load_dword v8, v10, s[12:15], s29 offen
  buffer_load_dword v24, v2, s[12:15], s28 offen offset:0
  buffer_load_dword v25, v2, s[12:15], s28 offen offset:512
  buffer_load_dword v26, v2, s[12:15], s28 offen offset:1024
  buffer_load_dword v27, v2, s[12:15], s28 offen offset:1536
  buffer_load_dword v28, v2, s[12:15], s28 offen offset:2048
  buffer_load_dwordx4 v[44:47], v1, s[12:15], s24 offen offset:1024
  s_cmp_ge_u32 s33, 6
  s_cbranch_scc1 k1v_9
  v_mov_b32 v136, s38
  v_mov_b32 v137, s38
  v_mov_b32 v138, s38
  v_mov_b32 v139, s38
  v_mov_b32 v140, s38
  v_mov_b32 v141, s38
  v_mov_b32 v142, s38
  v_mov_b32 v143, s38
  v_mov_b32 v144, s38
  v_mov_b32 v145, s38
  v_mov_b32 v146, s38
  v_mov_b32 v147, s38
  v_mov_b32 v148, s38
  v_mov_b32 v149, s38
  v_mov_b32 v150, s38
  v_mov_b32 v151, s38
k1v_9:
  v_max3_f32 v9, v136, v137, v9
  v_max3_f32 v9, v138, v139, v9
  v_max3_f32 v9, v140, v141, v9
  v_max3_f32 v9, v142, v143, v9
  v_max3_f32 v9, v144, v145, v9
  v_max3_f32 v9, v146, v147, v9
  v_max3_f32 v9, v148, v149, v9
  v_max3_f32 v9, v150, v151, v9
  s_cmp_ge_u32 s33, 7
  s_cbranch_scc1 k1v_10
  v_mov_b32 v120, s38
  v_mov_b32 v121, s38
  v_mov_b32 v122, s38
  v_mov_b32 v123, s38
  v_mov_b32 v124, s38
  v_mov_b32 v125, s38
  v_mov_b32 v126, s38
  v_mov_b32 v127, s38
  v_mov_b32 v128, s38
  v_mov_b32 v129, s38
  v_mov_b32 v130, s38
  v_mov_b32 v131, s38
  v_mov_b32 v132, s38
  v_mov_b32 v133, s38
  v_mov_b32 v134, s38
  v_mov_b32 v135, s38
k1v_10:
  v_max3_f32 v9, v120, v121, v9
  v_max3_f32 v9, v122, v123, v9
  v_max3_f32 v9, v124, v125, v9
  v_max3_f32 v9, v126, v127, v9
  v_max3_f32 v9, v128, v129, v9
  v_max3_f32 v9, v130, v131, v9
  v_max3_f32 v9, v132, v133, v9
  v_max3_f32 v9, v134, v135, v9
  v_mov_b32 v10, v9
  s_nop 1
  v_permlane32_swap_b32 v9, v10
  v_max_f32 v9, v9, v10
  v_mul_f32 v12, 0xbeae1a93, v9
  v_pk_fma_f32 v[104:105], v[104:105], v[14:15], v[12:13] op_sel_hi:[1,0,0]
  v_pk_fma_f32 v[106:107], v[106:107], v[14:15], v[12:13] op_sel_hi:[1,0,0]
  v_pk_fma_f32 v[108:109], v[108:109], v[14:15], v[12:13] op_sel_hi:[1,0,0]
  v_pk_fma_f32 v[110:111], v[110:111], v[14:15], v[12:13] op_sel_hi:[1,0,0]
  v_pk_fma_f32 v[112:113], v[112:113], v[14:15], v[12:13] op_sel_hi:[1,0,0]
  v_pk_fma_f32 v[114:115], v[114:115], v[14:15], v[12:13] op_sel_hi:[1,0,0]
  v_pk_fma_f32 v[116:117], v[116:117], v[14:15], v[12:13] op_sel_hi:[1,0,0]
  v_pk_fma_f32 v[118:119], v[118:119], v[14:15], v[12:13] op_sel_hi:[1,0,0]
  v_exp_f32 v104, v104
  v_exp_f32 v105, v105
  v_exp_f32 v106, v106
  v_exp_f32 v107, v107
  v_exp_f32 v108, v108
  v_exp_f32 v109, v109
  s_setprio 3
  s_waitcnt vmcnt(29)
  s_barrier
  s_add_u32 m0, s39, 86016
  s_nop 0
  buffer_load_dwordx4 v248, s[76:79], s74 offen offset:0 lds
  buffer_load_dwordx4 v249, s[76:79], s74 offen offset:1024 lds
  buffer_load_dwordx4 v250, s[96:99], s75 offen offset:2048 lds
  buffer_load_dwordx4 v251, s[96:99], s75 offen offset:3072 lds
  s_add_u32 m0, s39, 90112
  s_nop 0
  buffer_load_dwordx4 v252, s[96:99], s75 offen offset:0 lds
  buffer_load_dwordx4 v253, s[96:99], s75 offen offset:1024 lds
  buffer_load_dwordx4 v254, s[96:99], s75 offen offset:2048 lds
  s_add_u32 s74, s74, s100
  s_add_u32 s75, s75, s101
  s_setprio 1
  v_exp_f32 v110, v110
  v_exp_f32 v111, v111
  v_exp_f32 v112, v112
  v_exp_f32 v113, v113
  v_exp_f32 v114, v114
  v_exp_f32 v115, v115
  v_exp_f32 v116, v116
  v_exp_f32 v117, v117
  v_exp_f32 v118, v118
  v_exp_f32 v119, v119
  v_cvt_pk_bf16_f32 v104, v104, v105
  v_cvt_pk_bf16_f32 v105, v106, v107
  v_cvt_pk_bf16_f32 v106, v108, v109
  v_cvt_pk_bf16_f32 v107, v110, v111
  v_cvt_pk_bf16_f32 v108, v112, v113
  v_cvt_pk_bf16_f32 v109, v114, v115
  v_cvt_pk_bf16_f32 v110, v116, v117
  v_cvt_pk_bf16_f32 v111, v118, v119
  v_and_b32 v112, v16, v104
  v_xor_b32 v104, v104, v112
  v_and_b32 v113, v17, v105
  v_xor_b32 v105, v105, v113
  v_and_b32 v114, v18, v106
  v_xor_b32 v106, v106, v114
  v_and_b32 v115, v19, v107
  v_xor_b32 v107, v107, v115
  v_and_b32 v116, v20, v108
  v_xor_b32 v108, v108, v116
  v_and_b32 v117, v21, v109
  v_xor_b32 v109, v109, v117
  v_and_b32 v118, v22, v110
  v_xor_b32 v110, v110, v118
  v_and_b32 v119, v23, v111
  v_xor_b32 v111, v111, v119
  v_pk_fma_f32 v[120:121], v[120:121], v[14:15], v[12:13] op_sel_hi:[1,0,0]
  v_pk_fma_f32 v[122:123], v[122:123], v[14:15], v[12:13] op_sel_hi:[1,0,0]
  v_pk_fma_f32 v[124:125], v[124:125], v[14:15], v[12:13] op_sel_hi:[1,0,0]
  v_pk_fma_f32 v[126:127], v[126:127], v[14:15], v[12:13] op_sel_hi:[1,0,0]
  v_pk_fma_f32 v[128:129], v[128:129], v[14:15], v[12:13] op_sel_hi:[1,0,0]
  v_pk_fma_f32 v[130:131], v[130:131], v[14:15], v[12:13] op_sel_hi:[1,0,0]
  v_pk_fma_f32 v[132:133], v[132:133], v[14:15], v[12:13] op_sel_hi:[1,0,0]
  v_pk_fma_f32 v[134:135], v[134:135], v[14:15], v[12:13] op_sel_hi:[1,0,0]
  v_exp_f32 v120, v120
  v_exp_f32 v121, v121
  v_exp_f32 v122, v122
  v_exp_f32 v123, v123
  s_waitcnt vmcnt(62)
  v_mfma_f32_32x32x16_bf16 v[232:247], v[48:51], v[112:115], 0
  s_setprio 3
  s_waitcnt vmcnt(29)
  s_barrier
  s_add_u32 m0, s39, 114688
  s_nop 0
  buffer_load_dwordx4 v248, s[76:79], s74 offen offset:0 lds
  buffer_load_dwordx4 v249, s[76:79], s74 offen offset:1024 lds
  buffer_load_dwordx4 v250, s[96:99], s75 offen offset:2048 lds
  buffer_load_dwordx4 v251, s[96:99], s75 offen offset:3072 lds
  s_add_u32 m0, s39, 118784
  s_nop 0
  buffer_load_dwordx4 v252, s[96:99], s75 offen offset:0 lds
  buffer_load_dwordx4 v253, s[96:99], s75 offen offset:1024 lds
  buffer_load_dwordx4 v254, s[96:99], s75 offen offset:2048 lds
  s_add_u32 s74, s74, s100
  s_add_u32 s75, s75, s101
  s_setprio 1
  v_mfma_f32_32x32x16_bf16 v[232:247], v[52:55], v[116:119], v[232:247]
  s_waitcnt vmcnt(63)
  v_mfma_f32_32x32x16_bf16 v[232:247], v[56:59], v[104:107], v[232:247]
  v_mfma_f32_32x32x16_bf16 v[232:247], v[60:63], v[108:111], v[232:247]
  s_add_i32 s36, s33, -2
  s_max_i32 s36, s36, 0
  s_mul_i32 s36, s36, 36928
  s_add_u32 s36, s36, 15597568
  s_add_u32 s37, s36, 18464
  s_mov_b32 exec_lo, 0x3ffff
  s_mov_b32 exec_hi, 0x3ffff
  buffer_load_dwordx4 v[48:51], v5, s[12:15], s36 offen
  buffer_load_dwordx4 v[52:55], v5, s[12:15], s37 offen
  s_mov_b64 exec, -1
  s_add_i32 s36, s33, -1
  s_max_i32 s36, s36, 0
  s_mul_i32 s36, s36, 36928
  s_add_u32 s36, s36, 15597568
  s_add_u32 s37, s36, 18464
  s_mov_b32 exec_lo, 0x3ffff
  s_mov_b32 exec_hi, 0x3ffff
  buffer_load_dwordx4 v[56:59], v5, s[12:15], s36 offen
  buffer_load_dwordx4 v[60:63], v5, s[12:15], s37 offen
  s_mov_b64 exec, -1
  v_exp_f32 v124, v124
  v_exp_f32 v125, v125
  v_exp_f32 v126, v126
  v_exp_f32 v127, v127
  v_exp_f32 v128, v128
  v_exp_f32 v129, v129
  v_exp_f32 v130, v130
  v_exp_f32 v131, v131
  v_exp_f32 v132, v132
  v_exp_f32 v133, v133
  v_exp_f32 v134, v134
  v_exp_f32 v135, v135
  v_cvt_pk_bf16_f32 v120, v120, v121
  v_cvt_pk_bf16_f32 v121, v122, v123
  v_cvt_pk_bf16_f32 v122, v124, v125
  v_cvt_pk_bf16_f32 v123, v126, v127
  v_cvt_pk_bf16_f32 v124, v128, v129
  v_cvt_pk_bf16_f32 v125, v130, v131
  v_cvt_pk_bf16_f32 v126, v132, v133
  s_setprio 3
  s_waitcnt vmcnt(33)
  s_barrier
  s_add_u32 m0, s39, 0
  s_nop 0
  buffer_load_dwordx4 v248, s[76:79], s74 offen offset:0 lds
  buffer_load_dwordx4 v249, s[76:79], s74 offen offset:1024 lds
  buffer_load_dwordx4 v250, s[96:99], s75 offen offset:2048 lds
  buffer_load_dwordx4 v251, s[96:99], s75 offen offset:3072 lds
  s_add_u32 m0, s39, 4096
  s_nop 0
  buffer_load_dwordx4 v252, s[96:99], s75 offen offset:0 lds
  buffer_load_dwordx4 v253, s[96:99], s75 offen offset:1024 lds
  buffer_load_dwordx4 v254, s[96:99], s75 offen offset:2048 lds
  s_add_u32 s74, s74, s100
  s_add_u32 s75, s75, s101
  s_setprio 1
  v_cvt_pk_bf16_f32 v127, v134, v135
  buffer_load_dwordx4 v[128:131], v1, s[12:15], s24 offen offset:2048
  buffer_load_dwordx4 v[132:135], v1, s[12:15], s24 offen offset:3072
  v_pk_fma_f32 v[136:137], v[136:137], v[14:15], v[12:13] op_sel_hi:[1,0,0]
  v_pk_fma_f32 v[138:139], v[138:139], v[14:15], v[12:13] op_sel_hi:[1,0,0]
  v_pk_fma_f32 v[140:141], v[140:141], v[14:15], v[12:13] op_sel_hi:[1,0,0]
  v_pk_fma_f32 v[142:143], v[142:143], v[14:15], v[12:13] op_sel_hi:[1,0,0]
  v_pk_fma_f32 v[144:145], v[144:145], v[14:15], v[12:13] op_sel_hi:[1,0,0]
  v_pk_fma_f32 v[146:147], v[146:147], v[14:15], v[12:13] op_sel_hi:[1,0,0]
  v_pk_fma_f32 v[148:149], v[148:149], v[14:15], v[12:13] op_sel_hi:[1,0,0]
  v_pk_fma_f32 v[150:151], v[150:151], v[14:15], v[12:13] op_sel_hi:[1,0,0]
  v_exp_f32 v136, v136
  v_exp_f32 v137, v137
  v_exp_f32 v138, v138
  v_exp_f32 v139, v139
  s_waitcnt vmcnt(63)
  v_mfma_f32_32x32x16_bf16 v[232:247], v[64:67], v[120:123], v[232:247]
  v_mfma_f32_32x32x16_bf16 v[232:247], v[68:71], v[124:127], v[232:247]
  v_exp_f32 v140, v140
  v_exp_f32 v141, v141
  v_exp_f32 v142, v142
  v_exp_f32 v143, v143
  v_exp_f32 v144, v144
  v_exp_f32 v145, v145
  v_exp_f32 v146, v146
  v_exp_f32 v147, v147
  v_exp_f32 v148, v148
  v_exp_f32 v149, v149
  v_exp_f32 v150, v150
  v_exp_f32 v151, v151
  v_cvt_pk_bf16_f32 v136, v136, v137
  v_cvt_pk_bf16_f32 v137, v138, v139
  v_cvt_pk_bf16_f32 v138, v140, v141
  s_setprio 3
  s_waitcnt vmcnt(35)
  s_barrier
  s_add_u32 m0, s39, 28672
  s_nop 0
  buffer_load_dwordx4 v248, s[76:79], s74 offen offset:0 lds
  buffer_load_dwordx4 v249, s[76:79], s74 offen offset:1024 lds
  buffer_load_dwordx4 v250, s[96:99], s75 offen offset:2048 lds
  buffer_load_dwordx4 v251, s[96:99], s75 offen offset:3072 lds
  s_add_u32 m0, s39, 32768
  s_nop 0
  buffer_load_dwordx4 v252, s[96:99], s75 offen offset:0 lds
  buffer_load_dwordx4 v253, s[96:99], s75 offen offset:1024 lds
  buffer_load_dwordx4 v254, s[96:99], s75 offen offset:2048 lds
  s_add_u32 s74, s74, s100
  s_add_u32 s75, s75, s101
  s_setprio 1
  v_cvt_pk_bf16_f32 v139, v142, v143
  v_cvt_pk_bf16_f32 v140, v144, v145
  v_cvt_pk_bf16_f32 v141, v146, v147
  v_cvt_pk_bf16_f32 v142, v148, v149
  v_cvt_pk_bf16_f32 v143, v150, v151
  buffer_load_dwordx4 v[144:147], v1, s[12:15], s25 offen offset:0
  buffer_load_dwordx4 v[148:151], v1, s[12:15], s25 offen offset:1024
  v_pk_fma_f32 v[152:153], v[152:153], v[14:15], v[12:13] op_sel_hi:[1,0,0]
  v_pk_fma_f32 v[154:155], v[154:155], v[14:15], v[12:13] op_sel_hi:[1,0,0]
  v_pk_fma_f32 v[156:157], v[156:157], v[14:15], v[12:13] op_sel_hi:[1,0,0]
  v_pk_fma_f32 v[158:159], v[158:159], v[14:15], v[12:13] op_sel_hi:[1,0,0]
  v_pk_fma_f32 v[160:161], v[160:161], v[14:15], v[12:13] op_sel_hi:[1,0,0]
  v_pk_fma_f32 v[162:163], v[162:163], v[14:15], v[12:13] op_sel_hi:[1,0,0]
  v_pk_fma_f32 v[164:165], v[164:165], v[14:15], v[12:13] op_sel_hi:[1,0,0]
  v_pk_fma_f32 v[166:167], v[166:167], v[14:15], v[12:13] op_sel_hi:[1,0,0]
  v_exp_f32 v152, v152
  v_exp_f32 v153, v153
  v_exp_f32 v154, v154
  v_exp_f32 v155, v155
  s_waitcnt vmcnt(63)
  v_mfma_f32_32x32x16_bf16 v[232:247], v[72:75], v[136:139], v[232:247]
  v_mfma_f32_32x32x16_bf16 v[232:247], v[76:79], v[140:143], v[232:247]
  v_exp_f32 v156, v156
  v_exp_f32 v157, v157
  v_exp_f32 v158, v158
  v_exp_f32 v159, v159
  v_exp_f32 v160, v160
  v_exp_f32 v161, v161
  v_exp_f32 v162, v162
  v_exp_f32 v163, v163
  v_exp_f32 v164, v164
  v_exp_f32 v165, v165
  v_exp_f32 v166, v166
  v_exp_f32 v167, v167
  s_setprio 3
  s_waitcnt vmcnt(29)
  s_barrier
  s_add_u32 m0, s39, 57344
  s_nop 0
  buffer_load_dwordx4 v248, s[76:79], s74 offen offset:0 lds
  buffer_load_dwordx4 v249, s[76:79], s74 offen offset:1024 lds
  buffer_load_dwordx4 v250, s[96:99], s75 offen offset:2048 lds
  buffer_load_dwordx4 v251, s[96:99], s75 offen offset:3072 lds
  s_add_u32 m0, s39, 61440
  s_nop 0
  buffer_load_dwordx4 v252, s[96:99], s75 offen offset:0 lds
  buffer_load_dwordx4 v253, s[96:99], s75 offen offset:1024 lds
  buffer_load_dwordx4 v254, s[96:99], s75 offen offset:2048 lds
  s_add_u32 s74, s74, s100
  s_add_u32 s75, s75, s101
  s_setprio 1
  v_cvt_pk_bf16_f32 v152, v152, v153
  v_cvt_pk_bf16_f32 v153, v154, v155
  v_cvt_pk_bf16_f32 v154, v156, v157
  v_cvt_pk_bf16_f32 v155, v158, v159
  v_cvt_pk_bf16_f32 v156, v160, v161
  v_cvt_pk_bf16_f32 v157, v162, v163
  v_cvt_pk_bf16_f32 v158, v164, v165
  v_cvt_pk_bf16_f32 v159, v166, v167
  buffer_load_dwordx4 v[160:163], v1, s[12:15], s25 offen offset:2048
  buffer_load_dwordx4 v[164:167], v1, s[12:15], s25 offen offset:3072
  v_pk_fma_f32 v[168:169], v[168:169], v[14:15], v[12:13] op_sel_hi:[1,0,0]
  v_pk_fma_f32 v[170:171], v[170:171], v[14:15], v[12:13] op_sel_hi:[1,0,0]
  v_pk_fma_f32 v[172:173], v[172:173], v[14:15], v[12:13] op_sel_hi:[1,0,0]
  v_pk_fma_f32 v[174:175], v[174:175], v[14:15], v[12:13] op_sel_hi:[1,0,0]
  v_pk_fma_f32 v[176:177], v[176:177], v[14:15], v[12:13] op_sel_hi:[1,0,0]
  v_pk_fma_f32 v[178:179], v[178:179], v[14:15], v[12:13] op_sel_hi:[1,0,0]
  v_pk_fma_f32 v[180:181], v[180:181], v[14:15], v[12:13] op_sel_hi:[1,0,0]
  v_pk_fma_f32 v[182:183], v[182:183], v[14:15], v[12:13] op_sel_hi:[1,0,0]
  v_exp_f32 v168, v168
  v_exp_f32 v169, v169
  v_exp_f32 v170, v170
  v_exp_f32 v171, v171
  s_waitcnt vmcnt(63)
  v_mfma_f32_32x32x16_bf16 v[232:247], v[80:83], v[152:155], v[232:247]
  v_mfma_f32_32x32x16_bf16 v[232:247], v[84:87], v[156:159], v[232:247]
  v_exp_f32 v172, v172
  v_exp_f32 v173, v173
  v_exp_f32 v174, v174
  v_exp_f32 v175, v175
  v_exp_f32 v176, v176
  v_exp_f32 v177, v177
  v_exp_f32 v178, v178
  v_exp_f32 v179, v179
  v_exp_f32 v180, v180
  v_exp_f32 v181, v181
  s_setprio 3
  s_waitcnt vmcnt(31)
  s_barrier
  s_add_u32 m0, s39, 86016
  s_nop 0
  buffer_load_dwordx4 v248, s[76:79], s74 offen offset:0 lds
  buffer_load_dwordx4 v249, s[76:79], s74 offen offset:1024 lds
  buffer_load_dwordx4 v250, s[96:99], s75 offen offset:2048 lds
  buffer_load_dwordx4 v251, s[96:99], s75 offen offset:3072 lds
  s_add_u32 m0, s39, 90112
  s_nop 0
  buffer_load_dwordx4 v252, s[96:99], s75 offen offset:0 lds
  buffer_load_dwordx4 v253, s[96:99], s75 offen offset:1024 lds
  buffer_load_dwordx4 v254, s[96:99], s75 offen offset:2048 lds
  s_add_u32 s74, s74, s100
  s_add_u32 s75, s75, s101
  s_setprio 1
  v_exp_f32 v182, v182
  v_exp_f32 v183, v183
  v_cvt_pk_bf16_f32 v168, v168, v169
  v_cvt_pk_bf16_f32 v169, v170, v171
  v_cvt_pk_bf16_f32 v170, v172, v173
  v_cvt_pk_bf16_f32 v171, v174, v175
  v_cvt_pk_bf16_f32 v172, v176, v177
  v_cvt_pk_bf16_f32 v173, v178, v179
  v_cvt_pk_bf16_f32 v174, v180, v181
  v_cvt_pk_bf16_f32 v175, v182, v183
  buffer_load_dwordx4 v[176:179], v1, s[12:15], s26 offen offset:0
  buffer_load_dwordx4 v[180:183], v1, s[12:15], s24 offen offset:0
  v_pk_fma_f32 v[184:185], v[184:185], v[14:15], v[12:13] op_sel_hi:[1,0,0]
  v_pk_fma_f32 v[186:187], v[186:187], v[14:15], v[12:13] op_sel_hi:[1,0,0]
  v_pk_fma_f32 v[188:189], v[188:189], v[14:15], v[12:13] op_sel_hi:[1,0,0]
  v_pk_fma_f32 v[190:191], v[190:191], v[14:15], v[12:13] op_sel_hi:[1,0,0]
  v_pk_fma_f32 v[192:193], v[192:193], v[14:15], v[12:13] op_sel_hi:[1,0,0]
  v_pk_fma_f32 v[194:195], v[194:195], v[14:15], v[12:13] op_sel_hi:[1,0,0]
  v_pk_fma_f32 v[196:197], v[196:197], v[14:15], v[12:13] op_sel_hi:[1,0,0]
  v_pk_fma_f32 v[198:199], v[198:199], v[14:15], v[12:13] op_sel_hi:[1,0,0]
  v_exp_f32 v184, v184
  v_exp_f32 v185, v185
  v_exp_f32 v186, v186
  v_exp_f32 v187, v187
  s_waitcnt vmcnt(63)
  v_mfma_f32_32x32x16_bf16 v[232:247], v[88:91], v[168:171], v[232:247]
  v_mfma_f32_32x32x16_bf16 v[232:247], v[92:95], v[172:175], v[232:247]
  v_exp_f32 v188, v188
  v_exp_f32 v189, v189
  v_exp_f32 v190, v190
  v_exp_f32 v191, v191
  v_exp_f32 v192, v192
  v_exp_f32 v193, v193
  v_exp_f32 v194, v194
  v_exp_f32 v195, v195
  s_setprio 3
  s_waitcnt vmcnt(29)
  s_barrier
  s_add_u32 m0, s39, 114688
  s_nop 0
  buffer_load_dwordx4 v248, s[76:79], s74 offen offset:0 lds
  buffer_load_dwordx4 v249, s[76:79], s74 offen offset:1024 lds
  buffer_load_dwordx4 v250, s[96:99], s75 offen offset:2048 lds
  buffer_load_dwordx4 v251, s[96:99], s75 offen offset:3072 lds
  s_add_u32 m0, s39, 118784
  s_nop 0
  buffer_load_dwordx4 v252, s[96:99], s75 offen offset:0 lds
  buffer_load_dwordx4 v253, s[96:99], s75 offen offset:1024 lds
  buffer_load_dwordx4 v254, s[96:99], s75 offen offset:2048 lds
  s_add_u32 s74, s74, s100
  s_add_u32 s75, s75, s101
  s_setprio 1
  v_exp_f32 v196, v196
  v_exp_f32 v197, v197
  v_exp_f32 v198, v198
  v_exp_f32 v199, v199
  v_cvt_pk_bf16_f32 v184, v184, v185
  v_cvt_pk_bf16_f32 v185, v186, v187
  v_cvt_pk_bf16_f32 v186, v188, v189
  v_cvt_pk_bf16_f32 v187, v190, v191
  v_cvt_pk_bf16_f32 v188, v192, v193
  v_cvt_pk_bf16_f32 v189, v194, v195
  v_cvt_pk_bf16_f32 v190, v196, v197
  v_cvt_pk_bf16_f32 v191, v198, v199
  v_pk_fma_f32 v[200:201], v[200:201], v[14:15], v[12:13] op_sel_hi:[1,0,0]
  v_pk_fma_f32 v[202:203], v[202:203], v[14:15], v[12:13] op_sel_hi:[1,0,0]
  v_pk_fma_f32 v[204:205], v[204:205], v[14:15], v[12:13] op_sel_hi:[1,0,0]
  v_pk_fma_f32 v[206:207], v[206:207], v[14:15], v[12:13] op_sel_hi:[1,0,0]
  v_pk_fma_f32 v[208:209], v[208:209], v[14:15], v[12:13] op_sel_hi:[1,0,0]
  v_pk_fma_f32 v[210:211], v[210:211], v[14:15], v[12:13] op_sel_hi:[1,0,0]
  v_pk_fma_f32 v[212:213], v[212:213], v[14:15], v[12:13] op_sel_hi:[1,0,0]
  v_pk_fma_f32 v[214:215], v[214:215], v[14:15], v[12:13] op_sel_hi:[1,0,0]
  v_exp_f32 v200, v200
  v_exp_f32 v201, v201
  v_exp_f32 v202, v202
  v_exp_f32 v203, v203
  s_waitcnt vmcnt(63)
  v_mfma_f32_32x32x16_bf16 v[232:247], v[96:99], v[184:187], v[232:247]
  v_mfma_f32_32x32x16_bf16 v[232:247], v[100:103], v[188:191], v[232:247]
  v_exp_f32 v204, v204
  v_exp_f32 v205, v205
  v_exp_f32 v206, v206
  v_exp_f32 v207, v207
  v_exp_f32 v208, v208
  v_exp_f32 v209, v209
  v_exp_f32 v210, v210
  v_exp_f32 v211, v211
  s_setprio 3
  s_waitcnt vmcnt(27)
  s_barrier
  s_add_u32 m0, s39, 0
  s_nop 0
  buffer_load_dwordx4 v248, s[76:79], s74 offen offset:0 lds
  buffer_load_dwordx4 v249, s[76:79], s74 offen offset:1024 lds
  buffer_load_dwordx4 v250, s[96:99], s75 offen offset:2048 lds
  buffer_load_dwordx4 v251, s[96:99], s75 offen offset:3072 lds
  s_add_u32 m0, s39, 4096
  s_nop 0
  buffer_load_dwordx4 v252, s[96:99], s75 offen offset:0 lds
  buffer_load_dwordx4 v253, s[96:99], s75 offen offset:1024 lds
  buffer_load_dwordx4 v254, s[96:99], s75 offen offset:2048 lds
  s_add_u32 s74, s74, s100
  s_add_u32 s75, s75, s101
  s_setprio 1
  v_exp_f32 v212, v212
  v_exp_f32 v213, v213
  v_exp_f32 v214, v214
  v_exp_f32 v215, v215
  v_cvt_pk_bf16_f32 v200, v200, v201
  v_cvt_pk_bf16_f32 v201, v202, v203
  v_cvt_pk_bf16_f32 v202, v204, v205
  v_cvt_pk_bf16_f32 v203, v206, v207
  v_cvt_pk_bf16_f32 v204, v208, v209
  v_cvt_pk_bf16_f32 v205, v210, v211
  v_cvt_pk_bf16_f32 v206, v212, v213
  v_cvt_pk_bf16_f32 v207, v214, v215
  v_pk_fma_f32 v[216:217], v[216:217], v[14:15], v[12:13] op_sel_hi:[1,0,0]
  v_pk_fma_f32 v[218:219], v[218:219], v[14:15], v[12:13] op_sel_hi:[1,0,0]
  v_pk_fma_f32 v[220:221], v[220:221], v[14:15], v[12:13] op_sel_hi:[1,0,0]
  v_pk_fma_f32 v[222:223], v[222:223], v[14:15], v[12:13] op_sel_hi:[1,0,0]
  v_pk_fma_f32 v[224:225], v[224:225], v[14:15], v[12:13] op_sel_hi:[1,0,0]
  v_pk_fma_f32 v[226:227], v[226:227], v[14:15], v[12:13] op_sel_hi:[1,0,0]
  v_pk_fma_f32 v[228:229], v[228:229], v[14:15], v[12:13] op_sel_hi:[1,0,0]
  v_pk_fma_f32 v[230:231], v[230:231], v[14:15], v[12:13] op_sel_hi:[1,0,0]
  v_exp_f32 v216, v216
  v_exp_f32 v217, v217
  v_exp_f32 v218, v218
  v_exp_f32 v219, v219
  s_waitcnt vmcnt(52)
  v_mfma_f32_32x32x16_bf16 v[232:247], v[48:51], v[200:203], v[232:247]
  v_mfma_f32_32x32x16_bf16 v[232:247], v[52:55], v[204:207], v[232:247]
  v_exp_f32 v220, v220
  v_exp_f32 v221, v221
  v_exp_f32 v222, v222
  v_exp_f32 v223, v223
  v_exp_f32 v224, v224
  v_exp_f32 v225, v225
  v_exp_f32 v226, v226
  v_exp_f32 v227, v227
  s_setprio 3
  s_waitcnt vmcnt(25)
  s_barrier
  s_add_u32 m0, s39, 28672
  s_nop 0
  buffer_load_dwordx4 v248, s[76:79], s74 offen offset:0 lds
  buffer_load_dwordx4 v249, s[76:79], s74 offen offset:1024 lds
  buffer_load_dwordx4 v250, s[96:99], s75 offen offset:2048 lds
  buffer_load_dwordx4 v251, s[96:99], s75 offen offset:3072 lds
  s_add_u32 m0, s39, 32768
  s_nop 0
  buffer_load_dwordx4 v252, s[96:99], s75 offen offset:0 lds
  buffer_load_dwordx4 v253, s[96:99], s75 offen offset:1024 lds
  buffer_load_dwordx4 v254, s[96:99], s75 offen offset:2048 lds
  s_add_u32 s74, s74, s100
  s_add_u32 s75, s75, s101
  s_setprio 1
  v_exp_f32 v228, v228
  v_exp_f32 v229, v229
  v_exp_f32 v230, v230
  v_exp_f32 v231, v231
  v_cvt_pk_bf16_f32 v216, v216, v217
  v_cvt_pk_bf16_f32 v217, v218, v219
  v_cvt_pk_bf16_f32 v218, v220, v221
  v_cvt_pk_bf16_f32 v219, v222, v223
  v_cvt_pk_bf16_f32 v220, v224, v225
  v_cvt_pk_bf16_f32 v221, v226, v227
  v_cvt_pk_bf16_f32 v222, v228, v229
  v_cvt_pk_bf16_f32 v223, v230, v231
  s_waitcnt vmcnt(57)
  v_mfma_f32_32x32x16_bf16 v[232:247], v[56:59], v[216:219], v[232:247]
  v_mfma_f32_32x32x16_bf16 v[232:247], v[60:63], v[220:223], v[232:247]
  s_mul_i32 s36, s32, 73728
  s_lshl_b32 s37, s33, 6
  s_add_u32 s36, s36, s37
  s_add_u32 s36, s36, 8519680
  s_nop 7
  v_rcp_f32 v12, v242
  s_nop 0
  v_pk_mul_f32 v[232:233], v[232:233], v[12:13] op_sel_hi:[1,0]
  v_pk_mul_f32 v[234:235], v[234:235], v[12:13] op_sel_hi:[1,0]
  v_pk_mul_f32 v[236:237], v[236:237], v[12:13] op_sel_hi:[1,0]
  v_pk_mul_f32 v[238:239], v[238:239], v[12:13] op_sel_hi:[1,0]
  v_pk_mul_f32 v[240:241], v[240:241], v[12:13] op_sel_hi:[1,0]
  v_cvt_pk_bf16_f32 v232, v232, v233
  v_cvt_pk_bf16_f32 v234, v234, v235
  v_cvt_pk_bf16_f32 v236, v236, v237
  v_cvt_pk_bf16_f32 v238, v238, v239
  v_cvt_pk_bf16_f32 v240, v240, v241
  s_add_u32 s37, s36, 0
  buffer_store_short v232, v6, s[12:15], s37 offen
  s_add_u32 s37, s36, 4096
  buffer_store_short_d16_hi v232, v6, s[12:15], s37 offen
  s_add_u32 s37, s36, 8192
  buffer_store_short v234, v6, s[12:15], s37 offen
  s_add_u32 s37, s36, 12288
  buffer_store_short_d16_hi v234, v6, s[12:15], s37 offen
  s_add_u32 s37, s36, 32768
  buffer_store_short v236, v6, s[12:15], s37 offen
  s_add_u32 s37, s36, 36864
  buffer_store_short_d16_hi v236, v6, s[12:15], s37 offen
  s_add_u32 s37, s36, 40960
  buffer_store_short v238, v6, s[12:15], s37 offen
  s_add_u32 s37, s36, 45056
  buffer_store_short_d16_hi v238, v6, s[12:15], s37 offen
  s_add_u32 s37, s36, 65536
  buffer_store_short v240, v7, s[12:15], s37 offen
  s_add_u32 s37, s36, 69632
  buffer_store_short_d16_hi v240, v7, s[12:15], s37 offen
  s_mov_b32 s32, s30
  s_mov_b32 s33, s31
  s_setprio 3
  s_waitcnt vmcnt(33)
  s_barrier
  s_add_u32 m0, s39, 57344
  s_nop 0
  buffer_load_dwordx4 v248, s[76:79], s74 offen offset:0 lds
  buffer_load_dwordx4 v249, s[76:79], s74 offen offset:1024 lds
  buffer_load_dwordx4 v250, s[96:99], s75 offen offset:2048 lds
  buffer_load_dwordx4 v251, s[96:99], s75 offen offset:3072 lds
  s_add_u32 m0, s39, 61440
  s_nop 0
  buffer_load_dwordx4 v252, s[96:99], s75 offen offset:0 lds
  buffer_load_dwordx4 v253, s[96:99], s75 offen offset:1024 lds
  buffer_load_dwordx4 v254, s[96:99], s75 offen offset:2048 lds
  s_add_u32 s74, s74, s100
  s_add_u32 s75, s75, s101
  s_setprio 1
  v_mad_u32_u24 v5, v4, s32, v3
  s_add_i32 s36, s33, -8
  s_max_i32 s36, s36, 0
  s_mul_i32 s36, s36, 36928
  s_add_u32 s36, s36, 15597568
  s_add_u32 s37, s36, 18464
  s_mov_b32 exec_lo, 0x3ffff
  s_mov_b32 exec_hi, 0x3ffff
  buffer_load_dwordx4 v[48:51], v5, s[12:15], s36 offen
  buffer_load_dwordx4 v[52:55], v5, s[12:15], s37 offen
  s_mov_b64 exec, -1
  s_add_i32 s36, s33, 0
  s_max_i32 s36, s36, 0
  s_mul_i32 s36, s36, 36928
  s_add_u32 s36, s36, 15597568
  s_add_u32 s37, s36, 18464
  s_mov_b32 exec_lo, 0x3ffff
  s_mov_b32 exec_hi, 0x3ffff
  buffer_load_dwordx4 v[56:59], v5, s[12:15], s36 offen
  buffer_load_dwordx4 v[60:63], v5, s[12:15], s37 offen
  s_mov_b64 exec, -1
  s_add_i32 s36, s33, -7
  s_max_i32 s36, s36, 0
  s_mul_i32 s36, s36, 36928
  s_add_u32 s36, s36, 15597568
  s_add_u32 s37, s36, 18464
  s_mov_b32 exec_lo, 0x3ffff
  s_mov_b32 exec_hi, 0x3ffff
  buffer_load_dwordx4 v[64:67], v5, s[12:15], s36 offen
  buffer_load_dwordx4 v[68:71], v5, s[12:15], s37 offen
  s_mov_b64 exec, -1
  s_add_i32 s36, s33, -6
  s_max_i32 s36, s36, 0
  s_mul_i32 s36, s36, 36928
  s_add_u32 s36, s36, 15597568
  s_add_u32 s37, s36, 18464
  s_mov_b32 exec_lo, 0x3ffff
  s_mov_b32 exec_hi, 0x3ffff
  buffer_load_dwordx4 v[72:75], v5, s[12:15], s36 offen
  buffer_load_dwordx4 v[76:79], v5, s[12:15], s37 offen
  s_mov_b64 exec, -1
  s_add_i32 s36, s33, -5
  s_max_i32 s36, s36, 0
  s_mul_i32 s36, s36, 36928
  s_add_u32 s36, s36, 15597568
  s_add_u32 s37, s36, 18464
  s_mov_b32 exec_lo, 0x3ffff
  s_mov_b32 exec_hi, 0x3ffff
  buffer_load_dwordx4 v[80:83], v5, s[12:15], s36 offen
  buffer_load_dwordx4 v[84:87], v5, s[12:15], s37 offen
  s_mov_b64 exec, -1
  s_add_i32 s36, s33, -4
  s_max_i32 s36, s36, 0
  s_mul_i32 s36, s36, 36928
  s_add_u32 s36, s36, 15597568
  s_add_u32 s37, s36, 18464
  s_mov_b32 exec_lo, 0x3ffff
  s_mov_b32 exec_hi, 0x3ffff
  buffer_load_dwordx4 v[88:91], v5, s[12:15], s36 offen
  buffer_load_dwordx4 v[92:95], v5, s[12:15], s37 offen
  s_mov_b64 exec, -1
  s_add_i32 s36, s33, -3
  s_max_i32 s36, s36, 0
  s_mul_i32 s36, s36, 36928
  s_add_u32 s36, s36, 15597568
  s_add_u32 s37, s36, 18464
  s_mov_b32 exec_lo, 0x3ffff
  s_mov_b32 exec_hi, 0x3ffff
  buffer_load_dwordx4 v[96:99], v5, s[12:15], s36 offen
  buffer_load_dwordx4 v[100:103], v5, s[12:15], s37 offen
  s_mov_b64 exec, -1
  s_waitcnt vmcnt(52)
  v_cndmask_b32 v36, 0, v8, s[72:73]
  v_cndmask_b32 v41, 0, v8, s[72:73]
  v_cndmask_b32 v38, v8, 0, s[72:73]
  v_cndmask_b32 v43, v8, 0, s[72:73]
  v_mfma_f32_32x32x16_bf16 v[232:247], v[176:179], v[32:35], 0
  v_mfma_f32_32x32x8bf16_1k v[232:247], v[28:29], v[36:37], v[232:247]
  s_setprio 3
  s_waitcnt vmcnt(45)
  s_barrier
  s_add_u32 m0, s39, 86016
  s_nop 0
  buffer_load_dwordx4 v248, s[76:79], s74 offen offset:0 lds
  buffer_load_dwordx4 v249, s[76:79], s74 offen offset:1024 lds
  buffer_load_dwordx4 v250, s[96:99], s75 offen offset:2048 lds
  buffer_load_dwordx4 v251, s[96:99], s75 offen offset:3072 lds
  s_add_u32 m0, s39, 90112
  s_nop 0
  buffer_load_dwordx4 v252, s[96:99], s75 offen offset:0 lds
  buffer_load_dwordx4 v253, s[96:99], s75 offen offset:1024 lds
  buffer_load_dwordx4 v254, s[96:99], s75 offen offset:2048 lds
  s_add_u32 s74, s74, s100
  s_add_u32 s75, s75, s101
  s_setprio 1
  v_mfma_f32_32x32x16_bf16 v[104:119], v[180:183], v[32:35], 0
  v_mfma_f32_32x32x8bf16_1k v[104:119], v[24:25], v[36:37], v[104:119]
  v_mfma_f32_32x32x16_bf16 v[216:231], v[164:167], v[32:35], 0
  v_mfma_f32_32x32x8bf16_1k v[216:231], v[26:27], v[42:43], v[216:231]
  v_mfma_f32_32x32x16_bf16 v[200:215], v[160:163], v[32:35], 0
  v_mfma_f32_32x32x8bf16_1k v[200:215], v[26:27], v[40:41], v[200:215]
  s_cmp_ge_u32 s33, 8
  s_cbranch_scc1 k1v_11
  s_nop 5
  v_mov_b32 v104, s38
  v_mov_b32 v105, s38
  v_mov_b32 v106, s38
  v_mov_b32 v107, s38
  v_mov_b32 v108, s38
  v_mov_b32 v109, s38
  v_mov_b32 v110, s38
  v_mov_b32 v111, s38
  v_mov_b32 v112, s38
  v_mov_b32 v113, s38
  v_mov_b32 v114, s38
  v_mov_b32 v115, s38
  v_mov_b32 v116, s38
  v_mov_b32 v117, s38
  v_mov_b32 v118, s38
  v_mov_b32 v119, s38
k1v_11:
  s_nop 4
  v_cndmask_b32 v104, v232, v104, s[40:41]
  v_cndmask_b32 v105, v233, v105, s[42:43]
  v_cndmask_b32 v106, v234, v106, s[44:45]
  v_cndmask_b32 v107, v235, v107, s[46:47]
  v_cndmask_b32 v108, v236, v108, s[48:49]
  v_cndmask_b32 v109, v237, v109, s[50:51]
  v_cndmask_b32 v110, v238, v110, s[52:53]
  v_cndmask_b32 v111, v239, v111, s[54:55]
  v_cndmask_b32 v112, v240, v112, s[56:57]
  v_cndmask_b32 v113, v241, v113, s[58:59]
  v_cndmask_b32 v114, v242, v114, s[60:61]
  v_cndmask_b32 v115, v243, v115, s[62:63]
  v_cndmask_b32 v116, v244, v116, s[64:65]
  v_cndmask_b32 v117, v245, v117, s[66:67]
  v_cndmask_b32 v118, v246, v118, s[68:69]
  v_cndmask_b32 v119, v247, v119, s[70:71]
  v_max_f32 v9, v104, v105
  v_max3_f32 v9, v106, v107, v9
  v_max3_f32 v9, v108, v109, v9
  s_setprio 3
  s_waitcnt vmcnt(45)
  s_barrier
  s_add_u32 m0, s39, 114688
  s_nop 0
  buffer_load_dwordx4 v248, s[76:79], s74 offen offset:0 lds
  buffer_load_dwordx4 v249, s[76:79], s74 offen offset:1024 lds
  buffer_load_dwordx4 v250, s[96:99], s75 offen offset:2048 lds
  buffer_load_dwordx4 v251, s[96:99], s75 offen offset:3072 lds
  s_add_u32 m0, s39, 118784
  s_nop 0
  buffer_load_dwordx4 v252, s[96:99], s75 offen offset:0 lds
  buffer_load_dwordx4 v253, s[96:99], s75 offen offset:1024 lds
  buffer_load_dwordx4 v254, s[96:99], s75 offen offset:2048 lds
  s_add_u32 s74, s74, s100
  s_add_u32 s75, s75, s101
  s_setprio 1
  v_max3_f32 v9, v110, v111, v9
  v_max3_f32 v9, v112, v113, v9
  v_max3_f32 v9, v114, v115, v9
  v_max3_f32 v9, v116, v117, v9
  v_max3_f32 v9, v118, v119, v9
  v_mfma_f32_32x32x16_bf16 v[184:199], v[148:151], v[32:35], 0
  v_mfma_f32_32x32x8bf16_1k v[184:199], v[26:27], v[38:39], v[184:199]
  s_cmp_ge_u32 s33, 1
  s_cbranch_scc1 k1v_12
  v_mov_b32 v216, s38
  v_mov_b32 v217, s38
  v_mov_b32 v218, s38
  v_mov_b32 v219, s38
  v_mov_b32 v220, s38
  v_mov_b32 v221, s38
  v_mov_b32 v222, s38
  v_mov_b32 v223, s38
  v_mov_b32 v224, s38
  v_mov_b32 v225, s38
  v_mov_b32 v226, s38
  v_mov_b32 v227, s38
  v_mov_b32 v228, s38
  v_mov_b32 v229, s38
  v_mov_b32 v230, s38
  v_mov_b32 v231, s38
k1v_12:
  v_max3_f32 v9, v216, v217, v9
  v_max3_f32 v9, v218, v219, v9
  v_max3_f32 v9, v220, v221, v9
  v_max3_f32 v9, v222, v223, v9
  v_max3_f32 v9, v224, v225, v9
  v_max3_f32 v9, v226, v227, v9
  v_max3_f32 v9, v228, v229, v9
  v_max3_f32 v9, v230, v231, v9
  v_mfma_f32_32x32x16_bf16 v[168:183], v[144:147], v[32:35], 0
  v_mfma_f32_32x32x8bf16_1k v[168:183], v[26:27], v[36:37], v[168:183]
  s_cmp_ge_u32 s33, 2
  s_cbranch_scc1 k1v_13
  v_mov_b32 v200, s38
  v_mov_b32 v201, s38
  v_mov_b32 v202, s38
  v_mov_b32 v203, s38
  v_mov_b32 v204, s38
  v_mov_b32 v205, s38
  v_mov_b32 v206, s38
  v_mov_b32 v207, s38
  v_mov_b32 v208, s38
  v_mov_b32 v209, s38
  v_mov_b32 v210, s38
  v_mov_b32 v211, s38
  v_mov_b32 v212, s38
  v_mov_b32 v213, s38
  v_mov_b32 v214, s38
  v_mov_b32 v215, s38
k1v_13:
  v_max3_f32 v9, v200, v201, v9
  v_max3_f32 v9, v202, v203, v9
  v_max3_f32 v9, v204, v205, v9
  v_max3_f32 v9, v206, v207, v9
  v_max3_f32 v9, v208, v209, v9
  v_max3_f32 v9, v210, v211, v9
  v_max3_f32 v9, v212, v213, v9
  v_max3_f32 v9, v214, v215, v9
  v_mfma_f32_32x32x16_bf16 v[152:167], v[132:135], v[32:35], 0
  v_mfma_f32_32x32x8bf16_1k v[152:167], v[24:25], v[42:43], v[152:167]
  s_cmp_ge_u32 s33, 3
  s_cbranch_scc1 k1v_14
  v_mov_b32 v184, s38
  v_mov_b32 v185, s38
  v_mov_b32 v186, s38
  v_mov_b32 v187, s38
  v_mov_b32 v188, s38
  v_mov_b32 v189, s38
  v_mov_b32 v190, s38
  v_mov_b32 v191, s38
  v_mov_b32 v192, s38
  v_mov_b32 v193, s38
  v_mov_b32 v194, s38
  v_mov_b32 v195, s38
  v_mov_b32 v196, s38
  v_mov_b32 v197, s38
  v_mov_b32 v198, s38
  v_mov_b32 v199, s38
k1v_14:
  s_setprio 3
  s_waitcnt vmcnt(45)
  s_barrier
  s_add_u32 m0, s39, 0
  s_nop 0
  buffer_load_dwordx4 v248, s[76:79], s74 offen offset:0 lds
  buffer_load_dwordx4 v249, s[76:79], s74 offen offset:1024 lds
  buffer_load_dwordx4 v250, s[96:99], s75 offen offset:2048 lds
  buffer_load_dwordx4 v251, s[96:99], s75 offen offset:3072 lds
  s_add_u32 m0, s39, 4096
  s_nop 0
  buffer_load_dwordx4 v252, s[96:99], s75 offen offset:0 lds
  buffer_load_dwordx4 v253, s[96:99], s75 offen offset:1024 lds
  buffer_load_dwordx4 v254, s[96:99], s75 offen offset:2048 lds
  s_add_u32 s74, s74, s100
  s_add_u32 s75, s75, s101
  s_setprio 1
  v_max3_f32 v9, v184, v185, v9
  v_max3_f32 v9, v186, v187, v9
  v_max3_f32 v9, v188, v189, v9
  v_max3_f32 v9, v190, v191, v9
  v_max3_f32 v9, v192, v193, v9
  v_max3_f32 v9, v194, v195, v9
  v_max3_f32 v9, v196, v197, v9
  v_max3_f32 v9, v198, v199, v9
  v_mfma_f32_32x32x16_bf16 v[136:151], v[128:131], v[32:35], 0
  v_mfma_f32_32x32x8bf16_1k v[136:151], v[24:25], v[40:41], v[136:151]
  s_cmp_ge_u32 s33, 4
  s_cbranch_scc1 k1v_15
  v_mov_b32 v168, s38
  v_mov_b32 v169, s38
  v_mov_b32 v170, s38
  v_mov_b32 v171, s38
  v_mov_b32 v172, s38
  v_mov_b32 v173, s38
  v_mov_b32 v174, s38
  v_mov_b32 v175, s38
  v_mov_b32 v176, s38
  v_mov_b32 v177, s38
  v_mov_b32 v178, s38
  v_mov_b32 v179, s38
  v_mov_b32 v180, s38
  v_mov_b32 v181, s38
  v_mov_b32 v182, s38
  v_mov_b32 v183, s38
k1v_15:
  v_max3_f32 v9, v168, v169, v9
  v_max3_f32 v9, v170, v171, v9
  v_max3_f32 v9, v172, v173, v9
  v_max3_f32 v9, v174, v175, v9
  v_max3_f32 v9, v176, v177, v9
  v_max3_f32 v9, v178, v179, v9
  v_max3_f32 v9, v180, v181, v9
  v_max3_f32 v9, v182, v183, v9
  v_mfma_f32_32x32x16_bf16 v[120:135], v[44:47], v[32:35], 0
  v_mfma_f32_32x32x8bf16_1k v[120:135], v[24:25], v[38:39], v[120:135]
  s_cmp_ge_u32 s33, 5
  s_cbranch_scc1 k1v_16
  v_mov_b32 v152, s38
  v_mov_b32 v153, s38
  v_mov_b32 v154, s38
  v_mov_b32 v155, s38
  v_mov_b32 v156, s38
  v_mov_b32 v157, s38
  v_mov_b32 v158, s38
  v_mov_b32 v159, s38
  v_mov_b32 v160, s38
  v_mov_b32 v161, s38
  v_mov_b32 v162, s38
  v_mov_b32 v163, s38
  v_mov_b32 v164, s38
  v_mov_b32 v165, s38
  v_mov_b32 v166, s38
  v_mov_b32 v167, s38
k1v_16:
  v_max3_f32 v9, v152, v153, v9
  v_max3_f32 v9, v154, v155, v9
  v_max3_f32 v9, v156, v157, v9
  v_max3_f32 v9, v158, v159, v9
  v_max3_f32 v9, v160, v161, v9
  v_max3_f32 v9, v162, v163, v9
  v_max3_f32 v9, v164, v165, v9
  v_max3_f32 v9, v166, v167, v9
  s_cmp_ge_u32 s33, 6
  s_cbranch_scc1 k1v_17
  v_mov_b32 v136, s38
  v_mov_b32 v137, s38
  v_mov_b32 v138, s38
  v_mov_b32 v139, s38
  v_mov_b32 v140, s38
  v_mov_b32 v141, s38
  v_mov_b32 v142, s38
  v_mov_b32 v143, s38
  v_mov_b32 v144, s38
  v_mov_b32 v145, s38
  v_mov_b32 v146, s38
  v_mov_b32 v147, s38
  v_mov_b32 v148, s38
  v_mov_b32 v149, s38
  v_mov_b32 v150, s38
  v_mov_b32 v151, s38
k1v_17:
  v_max3_f32 v9, v136, v137, v9
  v_max3_f32 v9, v138, v139, v9
  v_max3_f32 v9, v140, v141, v9
  v_max3_f32 v9, v142, v143, v9
  v_max3_f32 v9, v144, v145, v9
  v_max3_f32 v9, v146, v147, v9
  v_max3_f32 v9, v148, v149, v9
  v_max3_f32 v9, v150, v151, v9
  s_cmp_ge_u32 s33, 7
  s_cbranch_scc1 k1v_18
  v_mov_b32 v120, s38
  v_mov_b32 v121, s38
  v_mov_b32 v122, s38
  v_mov_b32 v123, s38
  v_mov_b32 v124, s38
  v_mov_b32 v125, s38
  v_mov_b32 v126, s38
  v_mov_b32 v127, s38
  v_mov_b32 v128, s38
  v_mov_b32 v129, s38
  v_mov_b32 v130, s38
  v_mov_b32 v131, s38
  v_mov_b32 v132, s38
  v_mov_b32 v133, s38
  v_mov_b32 v134, s38
  v_mov_b32 v135, s38
k1v_18:
  v_max3_f32 v9, v120, v121, v9
  v_max3_f32 v9, v122, v123, v9
  s_setprio 3
  s_waitcnt vmcnt(35)
  s_barrier
  s_add_u32 m0, s39, 28672
  s_nop 0
  buffer_load_dwordx4 v248, s[76:79], s74 offen offset:0 lds
  buffer_load_dwordx4 v249, s[76:79], s74 offen offset:1024 lds
  buffer_load_dwordx4 v250, s[96:99], s75 offen offset:2048 lds
  buffer_load_dwordx4 v251, s[96:99], s75 offen offset:3072 lds
  s_add_u32 m0, s39, 32768
  s_nop 0
  buffer_load_dwordx4 v252, s[96:99], s75 offen offset:0 lds
  buffer_load_dwordx4 v253, s[96:99], s75 offen offset:1024 lds
  buffer_load_dwordx4 v254, s[96:99], s75 offen offset:2048 lds
  s_add_u32 s74, s74, s100
  s_add_u32 s75, s75, s101
  s_setprio 1
  v_max3_f32 v9, v124, v125, v9
  v_max3_f32 v9, v126, v127, v9
  v_max3_f32 v9, v128, v129, v9
  v_max3_f32 v9, v130, v131, v9
  v_max3_f32 v9, v132, v133, v9
  v_max3_f32 v9, v134, v135, v9
  v_mov_b32 v10, v9
  s_nop 1
  v_permlane32_swap_b32 v9, v10
  v_max_f32 v9, v9, v10
  v_mul_f32 v12, 0xbeae1a93, v9
  v_pk_fma_f32 v[104:105], v[104:105], v[14:15], v[12:13] op_sel_hi:[1,0,0]
  v_pk_fma_f32 v[106:107], v[106:107], v[14:15], v[12:13] op_sel_hi:[1,0,0]
  v_pk_fma_f32 v[108:109], v[108:109], v[14:15], v[12:13] op_sel_hi:[1,0,0]
  v_pk_fma_f32 v[110:111], v[110:111], v[14:15], v[12:13] op_sel_hi:[1,0,0]
  v_pk_fma_f32 v[112:113], v[112:113], v[14:15], v[12:13] op_sel_hi:[1,0,0]
  v_pk_fma_f32 v[114:115], v[114:115], v[14:15], v[12:13] op_sel_hi:[1,0,0]
  v_pk_fma_f32 v[116:117], v[116:117], v[14:15], v[12:13] op_sel_hi:[1,0,0]
  v_pk_fma_f32 v[118:119], v[118:119], v[14:15], v[12:13] op_sel_hi:[1,0,0]
  v_exp_f32 v104, v104
  v_exp_f32 v105, v105
  v_exp_f32 v106, v106
  v_exp_f32 v107, v107
  v_exp_f32 v108, v108
  v_exp_f32 v109, v109
  v_exp_f32 v110, v110
  v_exp_f32 v111, v111
  v_exp_f32 v112, v112
  v_exp_f32 v113, v113
  v_exp_f32 v114, v114
  v_exp_f32 v115, v115
  v_exp_f32 v116, v116
  v_exp_f32 v117, v117
  v_exp_f32 v118, v118
  v_exp_f32 v119, v119
  v_cvt_pk_bf16_f32 v104, v104, v105
  v_cvt_pk_bf16_f32 v105, v106, v107
  v_cvt_pk_bf16_f32 v106, v108, v109
  v_cvt_pk_bf16_f32 v107, v110, v111
  v_cvt_pk_bf16_f32 v108, v112, v113
  v_cvt_pk_bf16_f32 v109, v114, v115
  v_cvt_pk_bf16_f32 v110, v116, v117
  v_cvt_pk_bf16_f32 v111, v118, v119
  v_and_b32 v112, v16, v104
  v_xor_b32 v104, v104, v112
  v_and_b32 v113, v17, v105
  v_xor_b32 v105, v105, v113
  v_and_b32 v114, v18, v106
  v_xor_b32 v106, v106, v114
  v_and_b32 v115, v19, v107
  v_xor_b32 v107, v107, v115
  s_setprio 3
  s_waitcnt vmcnt(21)
  s_barrier
  s_add_u32 m0, s39, 57344
  s_nop 0
  buffer_load_dwordx4 v248, s[76:79], s74 offen offset:0 lds
  buffer_load_dwordx4 v249, s[76:79], s74 offen offset:1024 lds
  buffer_load_dwordx4 v250, s[96:99], s75 offen offset:2048 lds
  buffer_load_dwordx4 v251, s[96:99], s75 offen offset:3072 lds
  s_add_u32 m0, s39, 61440
  s_nop 0
  buffer_load_dwordx4 v252, s[96:99], s75 offen offset:0 lds
  buffer_load_dwordx4 v253, s[96:99], s75 offen offset:1024 lds
  buffer_load_dwordx4 v254, s[96:99], s75 offen offset:2048 lds
  s_add_u32 s74, s74, s100
  s_add_u32 s75, s75, s101
  s_setprio 1
  v_and_b32 v116, v20, v108
  v_xor_b32 v108, v108, v116
  v_and_b32 v117, v21, v109
  v_xor_b32 v109, v109, v117
  v_and_b32 v118, v22, v110
  v_xor_b32 v110, v110, v118
  v_and_b32 v119, v23, v111
  v_xor_b32 v111, v111, v119
  v_pk_fma_f32 v[120:121], v[120:121], v[14:15], v[12:13] op_sel_hi:[1,0,0]
  v_pk_fma_f32 v[122:123], v[122:123], v[14:15], v[12:13] op_sel_hi:[1,0,0]
  v_pk_fma_f32 v[124:125], v[124:125], v[14:15], v[12:13] op_sel_hi:[1,0,0]
  v_pk_fma_f32 v[126:127], v[126:127], v[14:15], v[12:13] op_sel_hi:[1,0,0]
  v_pk_fma_f32 v[128:129], v[128:129], v[14:15], v[12:13] op_sel_hi:[1,0,0]
  v_pk_fma_f32 v[130:131], v[130:131], v[14:15], v[12:13] op_sel_hi:[1,0,0]
  v_pk_fma_f32 v[132:133], v[132:133], v[14:15], v[12:13] op_sel_hi:[1,0,0]
  v_pk_fma_f32 v[134:135], v[134:135], v[14:15], v[12:13] op_sel_hi:[1,0,0]
  v_exp_f32 v120, v120
  v_exp_f32 v121, v121
  v_exp_f32 v122, v122
  v_exp_f32 v123, v123
  s_waitcnt vmcnt(47)
  v_mfma_f32_32x32x16_bf16 v[232:247], v[48:51], v[112:115], 0
  v_mfma_f32_32x32x16_bf16 v[232:247], v[52:55], v[116:119], v[232:247]
  s_waitcnt vmcnt(45)
  v_mfma_f32_32x32x16_bf16 v[232:247], v[56:59], v[104:107], v[232:247]
  v_mfma_f32_32x32x16_bf16 v[232:247], v[60:63], v[108:111], v[232:247]
  s_add_i32 s36, s33, -2
  s_max_i32 s36, s36, 0
  s_mul_i32 s36, s36, 36928
  s_add_u32 s36, s36, 15597568
  s_add_u32 s37, s36, 18464
  s_mov_b32 exec_lo, 0x3ffff
  s_mov_b32 exec_hi, 0x3ffff
  buffer_load_dwordx4 v[48:51], v5, s[12:15], s36 offen
  buffer_load_dwordx4 v[52:55], v5, s[12:15], s37 offen
  s_mov_b64 exec, -1
  s_add_i32 s36, s33, -1
  s_max_i32 s36, s36, 0
  s_mul_i32 s36, s36, 36928
  s_add_u32 s36, s36, 15597568
  s_add_u32 s37, s36, 18464
  s_mov_b32 exec_lo, 0x3ffff
  s_mov_b32 exec_hi, 0x3ffff
  buffer_load_dwordx4 v[56:59], v5, s[12:15], s36 offen
  buffer_load_dwordx4 v[60:63], v5, s[12:15], s37 offen
  s_mov_b64 exec, -1
  s_setprio 3
  s_waitcnt vmcnt(25)
  s_barrier
  s_add_u32 m0, s39, 86016
  s_nop 0
  buffer_load_dwordx4 v248, s[76:79], s74 offen offset:0 lds
  buffer_load_dwordx4 v249, s[76:79], s74 offen offset:1024 lds
  buffer_load_dwordx4 v250, s[96:99], s75 offen offset:2048 lds
  buffer_load_dwordx4 v251, s[96:99], s75 offen offset:3072 lds
  s_add_u32 m0, s39, 90112
  s_nop 0
  buffer_load_dwordx4 v252, s[96:99], s75 offen offset:0 lds
  buffer_load_dwordx4 v253, s[96:99], s75 offen offset:1024 lds
  buffer_load_dwordx4 v254, s[96:99], s75 offen offset:2048 lds
  s_add_u32 s74, s74, s100
  s_add_u32 s75, s75, s101
  s_setprio 1
  v_exp_f32 v124, v124
  v_exp_f32 v125, v125
  v_exp_f32 v126, v126
  v_exp_f32 v127, v127
  v_exp_f32 v128, v128
  v_exp_f32 v129, v129
  v_exp_f32 v130, v130
  v_exp_f32 v131, v131
  v_exp_f32 v132, v132
  v_exp_f32 v133, v133
  v_exp_f32 v134, v134
  v_exp_f32 v135, v135
  v_cvt_pk_bf16_f32 v120, v120, v121
  v_cvt_pk_bf16_f32 v121, v122, v123
  v_cvt_pk_bf16_f32 v122, v124, v125
  v_cvt_pk_bf16_f32 v123, v126, v127
  v_cvt_pk_bf16_f32 v124, v128, v129
  v_cvt_pk_bf16_f32 v125, v130, v131
  v_cvt_pk_bf16_f32 v126, v132, v133
  v_cvt_pk_bf16_f32 v127, v134, v135
  v_pk_fma_f32 v[136:137], v[136:137], v[14:15], v[12:13] op_sel_hi:[1,0,0]
  v_pk_fma_f32 v[138:139], v[138:139], v[14:15], v[12:13] op_sel_hi:[1,0,0]
  v_pk_fma_f32 v[140:141], v[140:141], v[14:15], v[12:13] op_sel_hi:[1,0,0]
  v_pk_fma_f32 v[142:143], v[142:143], v[14:15], v[12:13] op_sel_hi:[1,0,0]
  v_pk_fma_f32 v[144:145], v[144:145], v[14:15], v[12:13] op_sel_hi:[1,0,0]
  v_pk_fma_f32 v[146:147], v[146:147], v[14:15], v[12:13] op_sel_hi:[1,0,0]
  v_pk_fma_f32 v[148:149], v[148:149], v[14:15], v[12:13] op_sel_hi:[1,0,0]
  v_pk_fma_f32 v[150:151], v[150:151], v[14:15], v[12:13] op_sel_hi:[1,0,0]
  v_exp_f32 v136, v136
  v_exp_f32 v137, v137
  v_exp_f32 v138, v138
  v_exp_f32 v139, v139
  s_waitcnt vmcnt(54)
  v_mfma_f32_32x32x16_bf16 v[232:247], v[64:67], v[120:123], v[232:247]
  v_mfma_f32_32x32x16_bf16 v[232:247], v[68:71], v[124:127], v[232:247]
  s_setprio 3
  s_waitcnt vmcnt(25)
  s_barrier
  s_add_u32 m0, s39, 114688
  s_nop 0
  buffer_load_dwordx4 v248, s[76:79], s74 offen offset:0 lds
  buffer_load_dwordx4 v249, s[76:79], s74 offen offset:1024 lds
  buffer_load_dwordx4 v250, s[96:99], s75 offen offset:2048 lds
  buffer_load_dwordx4 v251, s[96:99], s75 offen offset:3072 lds
  s_add_u32 m0, s39, 118784
  s_nop 0
  buffer_load_dwordx4 v252, s[96:99], s75 offen offset:0 lds
  buffer_load_dwordx4 v253, s[96:99], s75 offen offset:1024 lds
  buffer_load_dwordx4 v254, s[96:99], s75 offen offset:2048 lds
  s_add_u32 s74, s74, s100
  s_add_u32 s75, s75, s101
  s_setprio 1
  v_exp_f32 v140, v140
  v_exp_f32 v141, v141
  v_exp_f32 v142, v142
  v_exp_f32 v143, v143
  v_exp_f32 v144, v144
  v_exp_f32 v145, v145
  v_exp_f32 v146, v146
  v_exp_f32 v147, v147
  v_exp_f32 v148, v148
  v_exp_f32 v149, v149
  v_exp_f32 v150, v150
  v_exp_f32 v151, v151
  v_cvt_pk_bf16_f32 v136, v136, v137
  v_cvt_pk_bf16_f32 v137, v138, v139
  v_cvt_pk_bf16_f32 v138, v140, v141
  v_cvt_pk_bf16_f32 v139, v142, v143
  v_cvt_pk_bf16_f32 v140, v144, v145
  v_cvt_pk_bf16_f32 v141, v146, v147
  v_cvt_pk_bf16_f32 v142, v148, v149
  v_cvt_pk_bf16_f32 v143, v150, v151
  v_pk_fma_f32 v[152:153], v[152:153], v[14:15], v[12:13] op_sel_hi:[1,0,0]
  v_pk_fma_f32 v[154:155], v[154:155], v[14:15], v[12:13] op_sel_hi:[1,0,0]
  v_pk_fma_f32 v[156:157], v[156:157], v[14:15], v[12:13] op_sel_hi:[1,0,0]
  v_pk_fma_f32 v[158:159], v[158:159], v[14:15], v[12:13] op_sel_hi:[1,0,0]
  v_pk_fma_f32 v[160:161], v[160:161], v[14:15], v[12:13] op_sel_hi:[1,0,0]
  v_pk_fma_f32 v[162:163], v[162:163], v[14:15], v[12:13] op_sel_hi:[1,0,0]
  v_pk_fma_f32 v[164:165], v[164:165], v[14:15], v[12:13] op_sel_hi:[1,0,0]
  v_pk_fma_f32 v[166:167], v[166:167], v[14:15], v[12:13] op_sel_hi:[1,0,0]
  v_exp_f32 v152, v152
  v_exp_f32 v153, v153
  v_exp_f32 v154, v154
  v_exp_f32 v155, v155
  s_waitcnt vmcnt(59)
  v_mfma_f32_32x32x16_bf16 v[232:247], v[72:75], v[136:139], v[232:247]
  v_mfma_f32_32x32x16_bf16 v[232:247], v[76:79], v[140:143], v[232:247]
  s_setprio 3
  s_waitcnt vmcnt(25)
  s_barrier
  s_add_u32 m0, s39, 0
  s_nop 0
  buffer_load_dwordx4 v248, s[76:79], s74 offen offset:0 lds
  buffer_load_dwordx4 v249, s[76:79], s74 offen offset:1024 lds
  buffer_load_dwordx4 v250, s[96:99], s75 offen offset:2048 lds
  buffer_load_dwordx4 v251, s[96:99], s75 offen offset:3072 lds
  s_add_u32 m0, s39, 4096
  s_nop 0
  buffer_load_dwordx4 v252, s[96:99], s75 offen offset:0 lds
  buffer_load_dwordx4 v253, s[96:99], s75 offen offset:1024 lds
  buffer_load_dwordx4 v254, s[96:99], s75 offen offset:2048 lds
  s_add_u32 s74, s74, s100
  s_add_u32 s75, s75, s101
  s_setprio 1
  v_exp_f32 v156, v156
  v_exp_f32 v157, v157
  v_exp_f32 v158, v158
  v_exp_f32 v159, v159
  v_exp_f32 v160, v160
  v_exp_f32 v161, v161
  v_exp_f32 v162, v162
  v_exp_f32 v163, v163
  v_exp_f32 v164, v164
  v_exp_f32 v165, v165
  v_exp_f32 v166, v166
  v_exp_f32 v167, v167
  v_cvt_pk_bf16_f32 v152, v152, v153
  v_cvt_pk_bf16_f32 v153, v154, v155
  v_cvt_pk_bf16_f32 v154, v156, v157
  v_cvt_pk_bf16_f32 v155, v158, v159
  v_cvt_pk_bf16_f32 v156, v160, v161
  v_cvt_pk_bf16_f32 v157, v162, v163
  v_cvt_pk_bf16_f32 v158, v164, v165
  v_cvt_pk_bf16_f32 v159, v166, v167
  v_pk_fma_f32 v[168:169], v[168:169], v[14:15], v[12:13] op_sel_hi:[1,0,0]
  v_pk_fma_f32 v[170:171], v[170:171], v[14:15], v[12:13] op_sel_hi:[1,0,0]
  v_pk_fma_f32 v[172:173], v[172:173], v[14:15], v[12:13] op_sel_hi:[1,0,0]
  v_pk_fma_f32 v[174:175], v[174:175], v[14:15], v[12:13] op_sel_hi:[1,0,0]
  v_pk_fma_f32 v[176:177], v[176:177], v[14:15], v[12:13] op_sel_hi:[1,0,0]
  v_pk_fma_f32 v[178:179], v[178:179], v[14:15], v[12:13] op_sel_hi:[1,0,0]
  v_pk_fma_f32 v[180:181], v[180:181], v[14:15], v[12:13] op_sel_hi:[1,0,0]
  v_pk_fma_f32 v[182:183], v[182:183], v[14:15], v[12:13] op_sel_hi:[1,0,0]
  v_exp_f32 v168, v168
  v_exp_f32 v169, v169
  v_exp_f32 v170, v170
  v_exp_f32 v171, v171
  s_waitcnt vmcnt(63)
  v_mfma_f32_32x32x16_bf16 v[232:247], v[80:83], v[152:155], v[232:247]
  v_mfma_f32_32x32x16_bf16 v[232:247], v[84:87], v[156:159], v[232:247]
  s_setprio 3
  s_waitcnt vmcnt(25)
  s_barrier
  s_add_u32 m0, s39, 28672
  s_nop 0
  buffer_load_dwordx4 v248, s[76:79], s74 offen offset:0 lds
  buffer_load_dwordx4 v249, s[76:79], s74 offen offset:1024 lds
  buffer_load_dwordx4 v250, s[96:99], s75 offen offset:2048 lds
  buffer_load_dwordx4 v251, s[96:99], s75 offen offset:3072 lds
  s_add_u32 m0, s39, 32768
  s_nop 0
  buffer_load_dwordx4 v252, s[96:99], s75 offen offset:0 lds
  buffer_load_dwordx4 v253, s[96:99], s75 offen offset:1024 lds
  buffer_load_dwordx4 v254, s[96:99], s75 offen offset:2048 lds
  s_add_u32 s74, s74, s100
  s_add_u32 s75, s75, s101
  s_setprio 1
  v_exp_f32 v172, v172
  v_exp_f32 v173, v173
  v_exp_f32 v174, v174
  v_exp_f32 v175, v175
  v_exp_f32 v176, v176
  v_exp_f32 v177, v177
  v_exp_f32 v178, v178
  v_exp_f32 v179, v179
  v_exp_f32 v180, v180
  v_exp_f32 v181, v181
  v_exp_f32 v182, v182
  v_exp_f32 v183, v183
  v_cvt_pk_bf16_f32 v168, v168, v169
  v_cvt_pk_bf16_f32 v169, v170, v171
  v_cvt_pk_bf16_f32 v170, v172, v173
  v_cvt_pk_bf16_f32 v171, v174, v175
  v_cvt_pk_bf16_f32 v172, v176, v177
  v_cvt_pk_bf16_f32 v173, v178, v179
  v_cvt_pk_bf16_f32 v174, v180, v181
  v_cvt_pk_bf16_f32 v175, v182, v183
  v_pk_fma_f32 v[184:185], v[184:185], v[14:15], v[12:13] op_sel_hi:[1,0,0]
  v_pk_fma_f32 v[186:187], v[186:187], v[14:15], v[12:13] op_sel_hi:[1,0,0]
  v_pk_fma_f32 v[188:189], v[188:189], v[14:15], v[12:13] op_sel_hi:[1,0,0]
  v_pk_fma_f32 v[190:191], v[190:191], v[14:15], v[12:13] op_sel_hi:[1,0,0]
  v_pk_fma_f32 v[192:193], v[192:193], v[14:15], v[12:13] op_sel_hi:[1,0,0]
  v_pk_fma_f32 v[194:195], v[194:195], v[14:15], v[12:13] op_sel_hi:[1,0,0]
  v_pk_fma_f32 v[196:197], v[196:197], v[14:15], v[12:13] op_sel_hi:[1,0,0]
  v_pk_fma_f32 v[198:199], v[198:199], v[14:15], v[12:13] op_sel_hi:[1,0,0]
  v_exp_f32 v184, v184
  v_exp_f32 v185, v185
  v_exp_f32 v186, v186
  v_exp_f32 v187, v187
  s_waitcnt vmcnt(63)
  v_mfma_f32_32x32x16_bf16 v[232:247], v[88:91], v[168:171], v[232:247]
  v_mfma_f32_32x32x16_bf16 v[232:247], v[92:95], v[172:175], v[232:247]
  s_setprio 3
  s_waitcnt vmcnt(21)
  s_barrier
  s_add_u32 m0, s39, 57344
  s_nop 0
  buffer_load_dwordx4 v248, s[76:79], s74 offen offset:0 lds
  buffer_load_dwordx4 v249, s[76:79], s74 offen offset:1024 lds
  buffer_load_dwordx4 v250, s[96:99], s75 offen offset:2048 lds
  buffer_load_dwordx4 v251, s[96:99], s75 offen offset:3072 lds
  s_add_u32 m0, s39, 61440
  s_nop 0
  buffer_load_dwordx4 v252, s[96:99], s75 offen offset:0 lds
  buffer_load_dwordx4 v253, s[96:99], s75 offen offset:1024 lds
  buffer_load_dwordx4 v254, s[96:99], s75 offen offset:2048 lds
  s_add_u32 s74, s74, s100
  s_add_u32 s75, s75, s101
  s_setprio 1
  v_exp_f32 v188, v188
  v_exp_f32 v189, v189
  v_exp_f32 v190, v190
  v_exp_f32 v191, v191
  v_exp_f32 v192, v192
  v_exp_f32 v193, v193
  v_exp_f32 v194, v194
  v_exp_f32 v195, v195
  v_exp_f32 v196, v196
  v_exp_f32 v197, v197
  v_exp_f32 v198, v198
  v_exp_f32 v199, v199
  v_cvt_pk_bf16_f32 v184, v184, v185
  v_cvt_pk_bf16_f32 v185, v186, v187
  v_cvt_pk_bf16_f32 v186, v188, v189
  v_cvt_pk_bf16_f32 v187, v190, v191
  v_cvt_pk_bf16_f32 v188, v192, v193
  v_cvt_pk_bf16_f32 v189, v194, v195
  v_cvt_pk_bf16_f32 v190, v196, v197
  v_cvt_pk_bf16_f32 v191, v198, v199
  v_pk_fma_f32 v[200:201], v[200:201], v[14:15], v[12:13] op_sel_hi:[1,0,0]
  v_pk_fma_f32 v[202:203], v[202:203], v[14:15], v[12:13] op_sel_hi:[1,0,0]
  v_pk_fma_f32 v[204:205], v[204:205], v[14:15], v[12:13] op_sel_hi:[1,0,0]
  v_pk_fma_f32 v[206:207], v[206:207], v[14:15], v[12:13] op_sel_hi:[1,0,0]
  v_pk_fma_f32 v[208:209], v[208:209], v[14:15], v[12:13] op_sel_hi:[1,0,0]
  v_pk_fma_f32 v[210:211], v[210:211], v[14:15], v[12:13] op_sel_hi:[1,0,0]
  v_pk_fma_f32 v[212:213], v[212:213], v[14:15], v[12:13] op_sel_hi:[1,0,0]
  v_pk_fma_f32 v[214:215], v[214:215], v[14:15], v[12:13] op_sel_hi:[1,0,0]
  v_exp_f32 v200, v200
  v_exp_f32 v201, v201
  v_exp_f32 v202, v202
  v_exp_f32 v203, v203
  s_waitcnt vmcnt(63)
  v_mfma_f32_32x32x16_bf16 v[232:247], v[96:99], v[184:187], v[232:247]
  v_mfma_f32_32x32x16_bf16 v[232:247], v[100:103], v[188:191], v[232:247]
  s_setprio 3
  s_waitcnt vmcnt(21)
  s_barrier
  s_add_u32 m0, s39, 86016
  s_nop 0
  buffer_load_dwordx4 v248, s[76:79], s74 offen offset:0 lds
  buffer_load_dwordx4 v249, s[76:79], s74 offen offset:1024 lds
  buffer_load_dwordx4 v250, s[96:99], s75 offen offset:2048 lds
  buffer_load_dwordx4 v251, s[96:99], s75 offen offset:3072 lds
  s_add_u32 m0, s39, 90112
  s_nop 0
  buffer_load_dwordx4 v252, s[96:99], s75 offen offset:0 lds
  buffer_load_dwordx4 v253, s[96:99], s75 offen offset:1024 lds
  buffer_load_dwordx4 v254, s[96:99], s75 offen offset:2048 lds
  s_add_u32 s74, s74, s100
  s_add_u32 s75, s75, s101
  s_setprio 1
  v_exp_f32 v204, v204
  v_exp_f32 v205, v205
  v_exp_f32 v206, v206
  v_exp_f32 v207, v207
  v_exp_f32 v208, v208
  v_exp_f32 v209, v209
  v_exp_f32 v210, v210
  v_exp_f32 v211, v211
  v_exp_f32 v212, v212
  v_exp_f32 v213, v213
  v_exp_f32 v214, v214
  v_exp_f32 v215, v215
  v_cvt_pk_bf16_f32 v200, v200, v201
  v_cvt_pk_bf16_f32 v201, v202, v203
  v_cvt_pk_bf16_f32 v202, v204, v205
  v_cvt_pk_bf16_f32 v203, v206, v207
  v_cvt_pk_bf16_f32 v204, v208, v209
  v_cvt_pk_bf16_f32 v205, v210, v211
  v_cvt_pk_bf16_f32 v206, v212, v213
  v_cvt_pk_bf16_f32 v207, v214, v215
  v_pk_fma_f32 v[216:217], v[216:217], v[14:15], v[12:13] op_sel_hi:[1,0,0]
  v_pk_fma_f32 v[218:219], v[218:219], v[14:15], v[12:13] op_sel_hi:[1,0,0]
  v_pk_fma_f32 v[220:221], v[220:221], v[14:15], v[12:13] op_sel_hi:[1,0,0]
  v_pk_fma_f32 v[222:223], v[222:223], v[14:15], v[12:13] op_sel_hi:[1,0,0]
  v_pk_fma_f32 v[224:225], v[224:225], v[14:15], v[12:13] op_sel_hi:[1,0,0]
  v_pk_fma_f32 v[226:227], v[226:227], v[14:15], v[12:13] op_sel_hi:[1,0,0]
  v_pk_fma_f32 v[228:229], v[228:229], v[14:15], v[12:13] op_sel_hi:[1,0,0]
  v_pk_fma_f32 v[230:231], v[230:231], v[14:15], v[12:13] op_sel_hi:[1,0,0]
  v_exp_f32 v216, v216
  v_exp_f32 v217, v217
  v_exp_f32 v218, v218
  v_exp_f32 v219, v219
  s_waitcnt vmcnt(44)
  v_mfma_f32_32x32x16_bf16 v[232:247], v[48:51], v[200:203], v[232:247]
  v_mfma_f32_32x32x16_bf16 v[232:247], v[52:55], v[204:207], v[232:247]
  s_setprio 3
  s_waitcnt vmcnt(21)
  s_barrier
  s_add_u32 m0, s39, 114688
  s_nop 0
  buffer_load_dwordx4 v248, s[76:79], s74 offen offset:0 lds
  buffer_load_dwordx4 v249, s[76:79], s74 offen offset:1024 lds
  buffer_load_dwordx4 v250, s[96:99], s75 offen offset:2048 lds
  buffer_load_dwordx4 v251, s[96:99], s75 offen offset:3072 lds
  s_add_u32 m0, s39, 118784
  s_nop 0
  buffer_load_dwordx4 v252, s[96:99], s75 offen offset:0 lds
  buffer_load_dwordx4 v253, s[96:99], s75 offen offset:1024 lds
  buffer_load_dwordx4 v254, s[96:99], s75 offen offset:2048 lds
  s_add_u32 s74, s74, s100
  s_add_u32 s75, s75, s101
  s_setprio 1
  v_exp_f32 v220, v220
  v_exp_f32 v221, v221
  v_exp_f32 v222, v222
  v_exp_f32 v223, v223
  v_exp_f32 v224, v224
  v_exp_f32 v225, v225
  v_exp_f32 v226, v226
  v_exp_f32 v227, v227
  v_exp_f32 v228, v228
  v_exp_f32 v229, v229
  v_exp_f32 v230, v230
  v_exp_f32 v231, v231
  v_cvt_pk_bf16_f32 v216, v216, v217
  v_cvt_pk_bf16_f32 v217, v218, v219
  v_cvt_pk_bf16_f32 v218, v220, v221
  v_cvt_pk_bf16_f32 v219, v222, v223
  v_cvt_pk_bf16_f32 v220, v224, v225
  v_cvt_pk_bf16_f32 v221, v226, v227
  v_cvt_pk_bf16_f32 v222, v228, v229
  v_cvt_pk_bf16_f32 v223, v230, v231
  s_waitcnt vmcnt(49)
  v_mfma_f32_32x32x16_bf16 v[232:247], v[56:59], v[216:219], v[232:247]
  v_mfma_f32_32x32x16_bf16 v[232:247], v[60:63], v[220:223], v[232:247]
  s_mul_i32 s36, s32, 73728
  s_lshl_b32 s37, s33, 6
  s_add_u32 s36, s36, s37
  s_add_u32 s36, s36, 8519680
  s_nop 7
  v_rcp_f32 v12, v242
  s_nop 0
  v_pk_mul_f32 v[232:233], v[232:233], v[12:13] op_sel_hi:[1,0]
  v_pk_mul_f32 v[234:235], v[234:235], v[12:13] op_sel_hi:[1,0]
  v_pk_mul_f32 v[236:237], v[236:237], v[12:13] op_sel_hi:[1,0]
  v_pk_mul_f32 v[238:239], v[238:239], v[12:13] op_sel_hi:[1,0]
  v_pk_mul_f32 v[240:241], v[240:241], v[12:13] op_sel_hi:[1,0]
  v_cvt_pk_bf16_f32 v232, v232, v233
  v_cvt_pk_bf16_f32 v234, v234, v235
  v_cvt_pk_bf16_f32 v236, v236, v237
  v_cvt_pk_bf16_f32 v238, v238, v239
  v_cvt_pk_bf16_f32 v240, v240, v241
  s_add_u32 s37, s36, 0
  buffer_store_short v232, v6, s[12:15], s37 offen
  s_add_u32 s37, s36, 4096
  buffer_store_short_d16_hi v232, v6, s[12:15], s37 offen
  s_add_u32 s37, s36, 8192
  buffer_store_short v234, v6, s[12:15], s37 offen
  s_add_u32 s37, s36, 12288
  buffer_store_short_d16_hi v234, v6, s[12:15], s37 offen
  s_add_u32 s37, s36, 32768
  buffer_store_short v236, v6, s[12:15], s37 offen
  s_add_u32 s37, s36, 36864
  buffer_store_short_d16_hi v236, v6, s[12:15], s37 offen
  s_add_u32 s37, s36, 40960
  buffer_store_short v238, v6, s[12:15], s37 offen
  s_add_u32 s37, s36, 45056
  buffer_store_short_d16_hi v238, v6, s[12:15], s37 offen
  s_add_u32 s37, s36, 65536
  buffer_store_short v240, v7, s[12:15], s37 offen
  s_add_u32 s37, s36, 69632
  buffer_store_short_d16_hi v240, v7, s[12:15], s37 offen
  s_setprio 3
  s_waitcnt vmcnt(31)
  s_barrier
  s_add_u32 m0, s39, 0
  s_nop 0
  buffer_load_dwordx4 v248, s[76:79], s74 offen offset:0 lds
  buffer_load_dwordx4 v249, s[76:79], s74 offen offset:1024 lds
  buffer_load_dwordx4 v250, s[96:99], s75 offen offset:2048 lds
  buffer_load_dwordx4 v251, s[96:99], s75 offen offset:3072 lds
  s_add_u32 m0, s39, 4096
  s_nop 0
  buffer_load_dwordx4 v252, s[96:99], s75 offen offset:0 lds
  buffer_load_dwordx4 v253, s[96:99], s75 offen offset:1024 lds
  buffer_load_dwordx4 v254, s[96:99], s75 offen offset:2048 lds
  s_add_u32 s74, s74, s100
  s_add_u32 s75, s75, s101
  s_setprio 1
  s_setprio 3
  s_waitcnt vmcnt(31)
  s_barrier
  s_add_u32 m0, s39, 28672
  s_nop 0
  buffer_load_dwordx4 v248, s[76:79], s74 offen offset:0 lds
  buffer_load_dwordx4 v249, s[76:79], s74 offen offset:1024 lds
  buffer_load_dwordx4 v250, s[96:99], s75 offen offset:2048 lds
  buffer_load_dwordx4 v251, s[96:99], s75 offen offset:3072 lds
  s_add_u32 m0, s39, 32768
  s_nop 0
  buffer_load_dwordx4 v252, s[96:99], s75 offen offset:0 lds
  buffer_load_dwordx4 v253, s[96:99], s75 offen offset:1024 lds
  buffer_load_dwordx4 v254, s[96:99], s75 offen offset:2048 lds
  s_add_u32 s74, s74, s100
  s_add_u32 s75, s75, s101
  s_mov_b32 m0, 143360
  s_nop 0
  buffer_load_dword v255, s[16:19], s35 offen lds
  s_setprio 1
  s_setprio 3
  s_waitcnt vmcnt(32)
  s_barrier
  s_setprio 1
  s_setprio 3
  s_waitcnt vmcnt(25)
  s_barrier
  s_setprio 1
  s_setprio 3
  s_waitcnt vmcnt(8)
  s_barrier
  s_setprio 1
  s_setprio 3
  s_waitcnt vmcnt(1)
  s_barrier
  s_setprio 1
  s_waitcnt vmcnt(0) lgkmcnt(0)
  s_endpgm
k1_free:
  s_sub_u32 s20, s5, 27
  s_lshl_b32 s20, s20, 3
  s_add_u32 s20, s20, s3
  s_add_u32 s20, s20, 216
  s_mov_b32 s16, s28
  s_and_b32 s17, s29, 0xffff
  s_mov_b32 s18, 18874368
  s_mov_b32 s19, 0x20000
  s_cmp_lt_u32 s5, 30
  s_cbranch_scc1 k1fw_19
  s_lshl_b32 s34, s4, 1
  s_add_u32 s34, s34, s5
  s_sub_u32 s34, s34, 30
  s_lshl_b32 s34, s34, 3
  s_add_u32 s34, s34, s3
  s_add_u32 s34, s34, 1920
  s_lshl_b32 s34, s34, 13
  v_lshlrev_b32 v255, 7, v0
  buffer_load_dword v254, v255, s[8:11], s34 offen
  s_add_u32 s34, s34, 1048576
  buffer_load_dword v254, v255, s[8:11], s34 offen
  s_add_u32 s34, s34, 1048576
  buffer_load_dword v254, v255, s[8:11], s34 offen
  s_add_u32 s34, s34, 1048576
  s_branch k1_fpf
k1fw_19:
  s_mov_b32 s21, 16
  s_mov_b32 s22, 248
  s_cmp_eq_u32 s5, 29
  s_cselect_b32 s22, 256, s22
  s_cselect_b32 s23, 16, 0
  s_add_u32 s20, s20, s23
  v_and_b32 v10, 31, v0
  v_lshrrev_b32 v9, 5, v0
  v_lshlrev_b32 v1, 5, v10
  v_lshl_add_u32 v1, v9, 4, v1
  v_lshlrev_b32 v2, 3, v10
  v_lshl_add_u32 v2, v9, 8, v2
  v_cmp_gt_u32 vcc, 18, v10
  v_lshlrev_b32 v3, 4, v9
  v_add_u32 v3, 18432, v3
  v_cndmask_b32 v3, v3, v1, vcc
  v_mov_b32 v5, 576
  v_cndmask_b32 v4, 0, v5, vcc
  v_lshlrev_b32 v6, 1, v10
  v_lshl_add_u32 v6, v9, 14, v6
  v_lshl_add_u32 v7, v9, 30, v6
  v_lshlrev_b32 v12, 2, v9
  v_sub_u32 v12, v10, v12
  v_cmp_gt_i32 s[40:41], 0, v12
  v_cmp_gt_i32 s[42:43], 1, v12
  v_cmp_gt_i32 s[44:45], 2, v12
  v_cmp_gt_i32 s[46:47], 3, v12
  v_cmp_gt_i32 s[48:49], 8, v12
  v_cmp_gt_i32 s[50:51], 9, v12
  v_cmp_gt_i32 s[52:53], 10, v12
  v_cmp_gt_i32 s[54:55], 11, v12
  v_cmp_gt_i32 s[56:57], 16, v12
  v_cmp_gt_i32 s[58:59], 17, v12
  v_cmp_gt_i32 s[60:61], 18, v12
  v_cmp_gt_i32 s[62:63], 19, v12
  v_cmp_gt_i32 s[64:65], 24, v12
  v_cmp_gt_i32 s[66:67], 25, v12
  v_cmp_gt_i32 s[68:69], 26, v12
  v_cmp_gt_i32 s[70:71], 27, v12
  v_mov_b32 v12, 0xffff
  v_mov_b32 v13, 0xffff0000
  v_cndmask_b32 v16, 0, v12, s[40:41]
  v_cndmask_b32 v10, 0, v13, s[42:43]
  v_or_b32 v16, v16, v10
  v_cndmask_b32 v17, 0, v12, s[44:45]
  v_cndmask_b32 v10, 0, v13, s[46:47]
  v_or_b32 v17, v17, v10
  v_cndmask_b32 v18, 0, v12, s[48:49]
  v_cndmask_b32 v10, 0, v13, s[50:51]
  v_or_b32 v18, v18, v10
  v_cndmask_b32 v19, 0, v12, s[52:53]
  v_cndmask_b32 v10, 0, v13, s[54:55]
  v_or_b32 v19, v19, v10
  v_cndmask_b32 v20, 0, v12, s[56:57]
  v_cndmask_b32 v10, 0, v13, s[58:59]
  v_or_b32 v20, v20, v10
  v_cndmask_b32 v21, 0, v12, s[60:61]
  v_cndmask_b32 v10, 0, v13, s[62:63]
  v_or_b32 v21, v21, v10
  v_cndmask_b32 v22, 0, v12, s[64:65]
  v_cndmask_b32 v10, 0, v13, s[66:67]
  v_or_b32 v22, v22, v10
  v_cndmask_b32 v23, 0, v12, s[68:69]
  v_cndmask_b32 v10, 0, v13, s[70:71]
  v_or_b32 v23, v23, v10
  v_mov_b32 v37, 0
  v_mov_b32 v39, 0
  v_mov_b32 v40, 0
  v_mov_b32 v42, 0
  v_mov_b32 v29, 0
  v_mov_b32 v48, 0x3f803f80
  v_mov_b32 v49, 0x3f803f80
  v_mov_b32 v50, 0x3f803f80
  v_mov_b32 v51, 0x3f803f80
  v_mov_b32 v52, 0x3f803f80
  v_mov_b32 v53, 0x3f803f80
  v_mov_b32 v54, 0x3f803f80
  v_mov_b32 v55, 0x3f803f80
  v_mov_b32 v56, 0x3f803f80
  v_mov_b32 v57, 0x3f803f80
  v_mov_b32 v58, 0x3f803f80
  v_mov_b32 v59, 0x3f803f80
  v_mov_b32 v60, 0x3f803f80
  v_mov_b32 v61, 0x3f803f80
  v_mov_b32 v62, 0x3f803f80
  v_mov_b32 v63, 0x3f803f80
  v_mov_b32 v64, 0x3f803f80
  v_mov_b32 v65, 0x3f803f80
  v_mov_b32 v66, 0x3f803f80
  v_mov_b32 v67, 0x3f803f80
  v_mov_b32 v68, 0x3f803f80
  v_mov_b32 v69, 0x3f803f80
  v_mov_b32 v70, 0x3f803f80
  v_mov_b32 v71, 0x3f803f80
  v_mov_b32 v72, 0x3f803f80
  v_mov_b32 v73, 0x3f803f80
  v_mov_b32 v74, 0x3f803f80
  v_mov_b32 v75, 0x3f803f80
  v_mov_b32 v76, 0x3f803f80
  v_mov_b32 v77, 0x3f803f80
  v_mov_b32 v78, 0x3f803f80
  v_mov_b32 v79, 0x3f803f80
  v_mov_b32 v80, 0x3f803f80
  v_mov_b32 v81, 0x3f803f80
  v_mov_b32 v82, 0x3f803f80
  v_mov_b32 v83, 0x3f803f80
  v_mov_b32 v84, 0x3f803f80
  v_mov_b32 v85, 0x3f803f80
  v_mov_b32 v86, 0x3f803f80
  v_mov_b32 v87, 0x3f803f80
  v_mov_b32 v88, 0x3f803f80
  v_mov_b32 v89, 0x3f803f80
  v_mov_b32 v90, 0x3f803f80
  v_mov_b32 v91, 0x3f803f80
  v_mov_b32 v92, 0x3f803f80
  v_mov_b32 v93, 0x3f803f80
  v_mov_b32 v94, 0x3f803f80
  v_mov_b32 v95, 0x3f803f80
  v_mov_b32 v96, 0x3f803f80
  v_mov_b32 v97, 0x3f803f80
  v_mov_b32 v98, 0x3f803f80
  v_mov_b32 v99, 0x3f803f80
  v_mov_b32 v100, 0x3f803f80
  v_mov_b32 v101, 0x3f803f80
  v_mov_b32 v102, 0x3f803f80
  v_mov_b32 v103, 0x3f803f80
  v_cmp_gt_u32 s[72:73], 32, v0
  v_mov_b32 v14, 0x3eae1a93
  s_mov_b32 s38, 0xff800000
  s_cmp_ge_u32 s20, s22
  s_cbranch_scc1 k1_f_done
  s_lshr_b32 s30, s20, 6
  s_lshl_b32 s31, s4, 2
  s_add_u32 s30, s30, s31
  s_and_b32 s31, s20, 63
  s_lshl_b32 s24, s30, 16
  s_lshl_b32 s25, s31, 10
  s_add_u32 s24, s24, s25
  s_add_u32 s27, s24, 10878976
  s_add_u32 s24, s24, 13230080
  s_add_u32 s25, s24, 4096
  s_add_u32 s26, s24, 8192
  s_lshr_b32 s28, s30, 1
  s_lshl_b32 s28, s28, 14
  s_and_b32 s29, s30, 1
  s_lshl_b32 s29, s29, 2
  s_add_u32 s28, s28, s29
  s_lshl_b32 s29, s31, 8
  s_add_u32 s28, s28, s29
  s_add_u32 s29, s28, 12976128
  s_add_u32 s28, s28, 15333376
  buffer_load_dwordx4 v[32:35], v1, s[12:15], s27 offen
  v_and_b32 v10, 0xff, v2
  buffer_load_dword v8, v10, s[12:15], s29 offen
  buffer_load_dword v24, v2, s[12:15], s28 offen offset:0
  buffer_load_dword v25, v2, s[12:15], s28 offen offset:512
  buffer_load_dword v26, v2, s[12:15], s28 offen offset:1024
  buffer_load_dword v27, v2, s[12:15], s28 offen offset:1536
  buffer_load_dword v28, v2, s[12:15], s28 offen offset:2048
  buffer_load_dwordx4 v[44:47], v1, s[12:15], s24 offen offset:1024
  buffer_load_dwordx4 v[176:179], v1, s[12:15], s26 offen offset:0
  buffer_load_dwordx4 v[180:183], v1, s[12:15], s24 offen offset:0
  buffer_load_dwordx4 v[164:167], v1, s[12:15], s25 offen offset:3072
  buffer_load_dwordx4 v[160:163], v1, s[12:15], s25 offen offset:2048
  buffer_load_dwordx4 v[148:151], v1, s[12:15], s25 offen offset:1024
  buffer_load_dwordx4 v[144:147], v1, s[12:15], s25 offen offset:0
  buffer_load_dwordx4 v[132:135], v1, s[12:15], s24 offen offset:3072
  buffer_load_dwordx4 v[128:131], v1, s[12:15], s24 offen offset:2048
  s_mov_b32 s23, 1
k1_f_loop:
  s_mov_b32 s32, s30
  s_mov_b32 s33, s31
  v_mad_u32_u24 v5, v4, s32, v3
  s_add_i32 s36, s33, -8
  s_max_i32 s36, s36, 0
  s_mul_i32 s36, s36, 36928
  s_add_u32 s36, s36, 15597568
  s_add_u32 s37, s36, 18464
  s_mov_b32 exec_lo, 0x3ffff
  s_mov_b32 exec_hi, 0x3ffff
  buffer_load_dwordx4 v[48:51], v5, s[12:15], s36 offen
  buffer_load_dwordx4 v[52:55], v5, s[12:15], s37 offen
  s_mov_b64 exec, -1
  s_add_i32 s36, s33, 0
  s_max_i32 s36, s36, 0
  s_mul_i32 s36, s36, 36928
  s_add_u32 s36, s36, 15597568
  s_add_u32 s37, s36, 18464
  s_mov_b32 exec_lo, 0x3ffff
  s_mov_b32 exec_hi, 0x3ffff
  buffer_load_dwordx4 v[56:59], v5, s[12:15], s36 offen
  buffer_load_dwordx4 v[60:63], v5, s[12:15], s37 offen
  s_mov_b64 exec, -1
  s_add_i32 s36, s33, -7
  s_max_i32 s36, s36, 0
  s_mul_i32 s36, s36, 36928
  s_add_u32 s36, s36, 15597568
  s_add_u32 s37, s36, 18464
  s_mov_b32 exec_lo, 0x3ffff
  s_mov_b32 exec_hi, 0x3ffff
  buffer_load_dwordx4 v[64:67], v5, s[12:15], s36 offen
  buffer_load_dwordx4 v[68:71], v5, s[12:15], s37 offen
  s_mov_b64 exec, -1
  s_add_i32 s36, s33, -6
  s_max_i32 s36, s36, 0
  s_mul_i32 s36, s36, 36928
  s_add_u32 s36, s36, 15597568
  s_add_u32 s37, s36, 18464
  s_mov_b32 exec_lo, 0x3ffff
  s_mov_b32 exec_hi, 0x3ffff
  buffer_load_dwordx4 v[72:75], v5, s[12:15], s36 offen
  buffer_load_dwordx4 v[76:79], v5, s[12:15], s37 offen
  s_mov_b64 exec, -1
  s_add_i32 s36, s33, -5
  s_max_i32 s36, s36, 0
  s_mul_i32 s36, s36, 36928
  s_add_u32 s36, s36, 15597568
  s_add_u32 s37, s36, 18464
  s_mov_b32 exec_lo, 0x3ffff
  s_mov_b32 exec_hi, 0x3ffff
  buffer_load_dwordx4 v[80:83], v5, s[12:15], s36 offen
  buffer_load_dwordx4 v[84:87], v5, s[12:15], s37 offen
  s_mov_b64 exec, -1
  s_add_i32 s36, s33, -4
  s_max_i32 s36, s36, 0
  s_mul_i32 s36, s36, 36928
  s_add_u32 s36, s36, 15597568
  s_add_u32 s37, s36, 18464
  s_mov_b32 exec_lo, 0x3ffff
  s_mov_b32 exec_hi, 0x3ffff
  buffer_load_dwordx4 v[88:91], v5, s[12:15], s36 offen
  buffer_load_dwordx4 v[92:95], v5, s[12:15], s37 offen
  s_mov_b64 exec, -1
  s_add_i32 s36, s33, -3
  s_max_i32 s36, s36, 0
  s_mul_i32 s36, s36, 36928
  s_add_u32 s36, s36, 15597568
  s_add_u32 s37, s36, 18464
  s_mov_b32 exec_lo, 0x3ffff
  s_mov_b32 exec_hi, 0x3ffff
  buffer_load_dwordx4 v[96:99], v5, s[12:15], s36 offen
  buffer_load_dwordx4 v[100:103], v5, s[12:15], s37 offen
  s_mov_b64 exec, -1
  s_add_u32 s20, s20, s21
  s_sub_u32 s34, s22, 1
  s_min_u32 s34, s34, s20
  s_lshr_b32 s30, s34, 6
  s_lshl_b32 s31, s4, 2
  s_add_u32 s30, s30, s31
  s_and_b32 s31, s34, 63
  s_lshl_b32 s24, s30, 16
  s_lshl_b32 s25, s31, 10
  s_add_u32 s24, s24, s25
  s_add_u32 s27, s24, 10878976
  s_add_u32 s24, s24, 13230080
  s_add_u32 s25, s24, 4096
  s_add_u32 s26, s24, 8192
  s_lshr_b32 s28, s30, 1
  s_lshl_b32 s28, s28, 14
  s_and_b32 s29, s30, 1
  s_lshl_b32 s29, s29, 2
  s_add_u32 s28, s28, s29
  s_lshl_b32 s29, s31, 8
  s_add_u32 s28, s28, s29
  s_add_u32 s29, s28, 12976128
  s_add_u32 s28, s28, 15333376
  s_cmp_eq_u32 s23, 0
  s_cbranch_scc1 k1a_20
  s_waitcnt vmcnt(14)
  s_mov_b32 s23, 0
k1a_20:
  s_waitcnt vmcnt(24)
  v_cndmask_b32 v36, 0, v8, s[72:73]
  v_cndmask_b32 v41, 0, v8, s[72:73]
  v_cndmask_b32 v38, v8, 0, s[72:73]
  v_cndmask_b32 v43, v8, 0, s[72:73]
  v_mfma_f32_32x32x16_bf16 v[232:247], v[176:179], v[32:35], 0
  v_mfma_f32_32x32x8bf16_1k v[232:247], v[28:29], v[36:37], v[232:247]
  v_mfma_f32_32x32x16_bf16 v[104:119], v[180:183], v[32:35], 0
  v_mfma_f32_32x32x8bf16_1k v[104:119], v[24:25], v[36:37], v[104:119]
  v_mfma_f32_32x32x16_bf16 v[216:231], v[164:167], v[32:35], 0
  v_mfma_f32_32x32x8bf16_1k v[216:231], v[26:27], v[42:43], v[216:231]
  v_mfma_f32_32x32x16_bf16 v[200:215], v[160:163], v[32:35], 0
  v_mfma_f32_32x32x8bf16_1k v[200:215], v[26:27], v[40:41], v[200:215]
  s_cmp_ge_u32 s33, 8
  s_cbranch_scc1 k1v_21
  s_nop 5
  v_mov_b32 v104, s38
  v_mov_b32 v105, s38
  v_mov_b32 v106, s38
  v_mov_b32 v107, s38
  v_mov_b32 v108, s38
  v_mov_b32 v109, s38
  v_mov_b32 v110, s38
  v_mov_b32 v111, s38
  v_mov_b32 v112, s38
  v_mov_b32 v113, s38
  v_mov_b32 v114, s38
  v_mov_b32 v115, s38
  v_mov_b32 v116, s38
  v_mov_b32 v117, s38
  v_mov_b32 v118, s38
  v_mov_b32 v119, s38
k1v_21:
  s_nop 4
  v_cndmask_b32 v104, v232, v104, s[40:41]
  v_cndmask_b32 v105, v233, v105, s[42:43]
  v_cndmask_b32 v106, v234, v106, s[44:45]
  v_cndmask_b32 v107, v235, v107, s[46:47]
  v_cndmask_b32 v108, v236, v108, s[48:49]
  v_cndmask_b32 v109, v237, v109, s[50:51]
  v_cndmask_b32 v110, v238, v110, s[52:53]
  v_cndmask_b32 v111, v239, v111, s[54:55]
  v_cndmask_b32 v112, v240, v112, s[56:57]
  v_cndmask_b32 v113, v241, v113, s[58:59]
  v_cndmask_b32 v114, v242, v114, s[60:61]
  v_cndmask_b32 v115, v243, v115, s[62:63]
  v_cndmask_b32 v116, v244, v116, s[64:65]
  v_cndmask_b32 v117, v245, v117, s[66:67]
  v_cndmask_b32 v118, v246, v118, s[68:69]
  v_cndmask_b32 v119, v247, v119, s[70:71]
  v_max_f32 v9, v104, v105
  v_max3_f32 v9, v106, v107, v9
  v_max3_f32 v9, v108, v109, v9
  v_max3_f32 v9, v110, v111, v9
  v_max3_f32 v9, v112, v113, v9
  v_max3_f32 v9, v114, v115, v9
  v_max3_f32 v9, v116, v117, v9
  v_max3_f32 v9, v118, v119, v9
  v_mfma_f32_32x32x16_bf16 v[184:199], v[148:151], v[32:35], 0
  v_mfma_f32_32x32x8bf16_1k v[184:199], v[26:27], v[38:39], v[184:199]
  s_cmp_ge_u32 s33, 1
  s_cbranch_scc1 k1v_22
  v_mov_b32 v216, s38
  v_mov_b32 v217, s38
  v_mov_b32 v218, s38
  v_mov_b32 v219, s38
  v_mov_b32 v220, s38
  v_mov_b32 v221, s38
  v_mov_b32 v222, s38
  v_mov_b32 v223, s38
  v_mov_b32 v224, s38
  v_mov_b32 v225, s38
  v_mov_b32 v226, s38
  v_mov_b32 v227, s38
  v_mov_b32 v228, s38
  v_mov_b32 v229, s38
  v_mov_b32 v230, s38
  v_mov_b32 v231, s38
k1v_22:
  v_max3_f32 v9, v216, v217, v9
  v_max3_f32 v9, v218, v219, v9
  v_max3_f32 v9, v220, v221, v9
  v_max3_f32 v9, v222, v223, v9
  v_max3_f32 v9, v224, v225, v9
  v_max3_f32 v9, v226, v227, v9
  v_max3_f32 v9, v228, v229, v9
  v_max3_f32 v9, v230, v231, v9
  v_mfma_f32_32x32x16_bf16 v[168:183], v[144:147], v[32:35], 0
  v_mfma_f32_32x32x8bf16_1k v[168:183], v[26:27], v[36:37], v[168:183]
  s_cmp_ge_u32 s33, 2
  s_cbranch_scc1 k1v_23
  v_mov_b32 v200, s38
  v_mov_b32 v201, s38
  v_mov_b32 v202, s38
  v_mov_b32 v203, s38
  v_mov_b32 v204, s38
  v_mov_b32 v205, s38
  v_mov_b32 v206, s38
  v_mov_b32 v207, s38
  v_mov_b32 v208, s38
  v_mov_b32 v209, s38
  v_mov_b32 v210, s38
  v_mov_b32 v211, s38
  v_mov_b32 v212, s38
  v_mov_b32 v213, s38
  v_mov_b32 v214, s38
  v_mov_b32 v215, s38
k1v_23:
  v_max3_f32 v9, v200, v201, v9
  v_max3_f32 v9, v202, v203, v9
  v_max3_f32 v9, v204, v205, v9
  v_max3_f32 v9, v206, v207, v9
  v_max3_f32 v9, v208, v209, v9
  v_max3_f32 v9, v210, v211, v9
  v_max3_f32 v9, v212, v213, v9
  v_max3_f32 v9, v214, v215, v9
  v_mfma_f32_32x32x16_bf16 v[152:167], v[132:135], v[32:35], 0
  v_mfma_f32_32x32x8bf16_1k v[152:167], v[24:25], v[42:43], v[152:167]
  s_cmp_ge_u32 s33, 3
  s_cbranch_scc1 k1v_24
  v_mov_b32 v184, s38
  v_mov_b32 v185, s38
  v_mov_b32 v186, s38
  v_mov_b32 v187, s38
  v_mov_b32 v188, s38
  v_mov_b32 v189, s38
  v_mov_b32 v190, s38
  v_mov_b32 v191, s38
  v_mov_b32 v192, s38
  v_mov_b32 v193, s38
  v_mov_b32 v194, s38
  v_mov_b32 v195, s38
  v_mov_b32 v196, s38
  v_mov_b32 v197, s38
  v_mov_b32 v198, s38
  v_mov_b32 v199, s38
k1v_24:
  v_max3_f32 v9, v184, v185, v9
  v_max3_f32 v9, v186, v187, v9
  v_max3_f32 v9, v188, v189, v9
  v_max3_f32 v9, v190, v191, v9
  v_max3_f32 v9, v192, v193, v9
  v_max3_f32 v9, v194, v195, v9
  v_max3_f32 v9, v196, v197, v9
  v_max3_f32 v9, v198, v199, v9
  v_mfma_f32_32x32x16_bf16 v[136:151], v[128:131], v[32:35], 0
  v_mfma_f32_32x32x8bf16_1k v[136:151], v[24:25], v[40:41], v[136:151]
  s_cmp_ge_u32 s33, 4
  s_cbranch_scc1 k1v_25
  v_mov_b32 v168, s38
  v_mov_b32 v169, s38
  v_mov_b32 v170, s38
  v_mov_b32 v171, s38
  v_mov_b32 v172, s38
  v_mov_b32 v173, s38
  v_mov_b32 v174, s38
  v_mov_b32 v175, s38
  v_mov_b32 v176, s38
  v_mov_b32 v177, s38
  v_mov_b32 v178, s38
  v_mov_b32 v179, s38
  v_mov_b32 v180, s38
  v_mov_b32 v181, s38
  v_mov_b32 v182, s38
  v_mov_b32 v183, s38
k1v_25:
  v_max3_f32 v9, v168, v169, v9
  v_max3_f32 v9, v170, v171, v9
  v_max3_f32 v9, v172, v173, v9
  v_max3_f32 v9, v174, v175, v9
  v_max3_f32 v9, v176, v177, v9
  v_max3_f32 v9, v178, v179, v9
  v_max3_f32 v9, v180, v181, v9
  v_max3_f32 v9, v182, v183, v9
  v_mfma_f32_32x32x16_bf16 v[120:135], v[44:47], v[32:35], 0
  v_mfma_f32_32x32x8bf16_1k v[120:135], v[24:25], v[38:39], v[120:135]
  s_cmp_ge_u32 s33, 5
  s_cbranch_scc1 k1v_26
  v_mov_b32 v152, s38
  v_mov_b32 v153, s38
  v_mov_b32 v154, s38
  v_mov_b32 v155, s38
  v_mov_b32 v156, s38
  v_mov_b32 v157, s38
  v_mov_b32 v158, s38
  v_mov_b32 v159, s38
  v_mov_b32 v160, s38
  v_mov_b32 v161, s38
  v_mov_b32 v162, s38
  v_mov_b32 v163, s38
  v_mov_b32 v164, s38
  v_mov_b32 v165, s38
  v_mov_b32 v166, s38
  v_mov_b32 v167, s38
k1v_26:
  v_max3_f32 v9, v152, v153, v9
  v_max3_f32 v9, v154, v155, v9
  v_max3_f32 v9, v156, v157, v9
  v_max3_f32 v9, v158, v159, v9
  v_max3_f32 v9, v160, v161, v9
  v_max3_f32 v9, v162, v163, v9
  v_max3_f32 v9, v164, v165, v9
  v_max3_f32 v9, v166, v167, v9
  buffer_load_dwordx4 v[32:35], v1, s[12:15], s27 offen
  v_and_b32 v10, 0xff, v2
  buffer_load_dword v8, v10, s[12:15], s29 offen
  buffer_load_dword v24, v2, s[12:15], s28 offen offset:0
  buffer_load_dword v25, v2, s[12:15], s28 offen offset:512
  buffer_load_dword v26, v2, s[12:15], s28 offen offset:1024
  buffer_load_dword v27, v2, s[12:15], s28 offen offset:1536
  buffer_load_dword v28, v2, s[12:15], s28 offen offset:2048
  buffer_load_dwordx4 v[44:47], v1, s[12:15], s24 offen offset:1024
  s_cmp_ge_u32 s33, 6
  s_cbranch_scc1 k1v_27
  v_mov_b32 v136, s38
  v_mov_b32 v137, s38
  v_mov_b32 v138, s38
  v_mov_b32 v139, s38
  v_mov_b32 v140, s38
  v_mov_b32 v141, s38
  v_mov_b32 v142, s38
  v_mov_b32 v143, s38
  v_mov_b32 v144, s38
  v_mov_b32 v145, s38
  v_mov_b32 v146, s38
  v_mov_b32 v147, s38
  v_mov_b32 v148, s38
  v_mov_b32 v149, s38
  v_mov_b32 v150, s38
  v_mov_b32 v151, s38
k1v_27:
  v_max3_f32 v9, v136, v137, v9
  v_max3_f32 v9, v138, v139, v9
  v_max3_f32 v9, v140, v141, v9
  v_max3_f32 v9, v142, v143, v9
  v_max3_f32 v9, v144, v145, v9
  v_max3_f32 v9, v146, v147, v9
  v_max3_f32 v9, v148, v149, v9
  v_max3_f32 v9, v150, v151, v9
  s_cmp_ge_u32 s33, 7
  s_cbranch_scc1 k1v_28
  v_mov_b32 v120, s38
  v_mov_b32 v121, s38
  v_mov_b32 v122, s38
  v_mov_b32 v123, s38
  v_mov_b32 v124, s38
  v_mov_b32 v125, s38
  v_mov_b32 v126, s38
  v_mov_b32 v127, s38
  v_mov_b32 v128, s38
  v_mov_b32 v129, s38
  v_mov_b32 v130, s38
  v_mov_b32 v131, s38
  v_mov_b32 v132, s38
  v_mov_b32 v133, s38
  v_mov_b32 v134, s38
  v_mov_b32 v135, s38
k1v_28:
  v_max3_f32 v9, v120, v121, v9
  v_max3_f32 v9, v122, v123, v9
  v_max3_f32 v9, v124, v125, v9
  v_max3_f32 v9, v126, v127, v9
  v_max3_f32 v9, v128, v129, v9
  v_max3_f32 v9, v130, v131, v9
  v_max3_f32 v9, v132, v133, v9
  v_max3_f32 v9, v134, v135, v9
  v_mov_b32 v10, v9
  s_nop 1
  v_permlane32_swap_b32 v9, v10
  v_max_f32 v9, v9, v10
  v_mul_f32 v12, 0xbeae1a93, v9
  v_pk_fma_f32 v[104:105], v[104:105], v[14:15], v[12:13] op_sel_hi:[1,0,0]
  v_pk_fma_f32 v[106:107], v[106:107], v[14:15], v[12:13] op_sel_hi:[1,0,0]
  v_pk_fma_f32 v[108:109], v[108:109], v[14:15], v[12:13] op_sel_hi:[1,0,0]
  v_pk_fma_f32 v[110:111], v[110:111], v[14:15], v[12:13] op_sel_hi:[1,0,0]
  v_pk_fma_f32 v[112:113], v[112:113], v[14:15], v[12:13] op_sel_hi:[1,0,0]
  v_pk_fma_f32 v[114:115], v[114:115], v[14:15], v[12:13] op_sel_hi:[1,0,0]
  v_pk_fma_f32 v[116:117], v[116:117], v[14:15], v[12:13] op_sel_hi:[1,0,0]
  v_pk_fma_f32 v[118:119], v[118:119], v[14:15], v[12:13] op_sel_hi:[1,0,0]
  v_exp_f32 v104, v104
  v_exp_f32 v105, v105
  v_exp_f32 v106, v106
  v_exp_f32 v107, v107
  v_exp_f32 v108, v108
  v_exp_f32 v109, v109
  v_exp_f32 v110, v110
  v_exp_f32 v111, v111
  v_exp_f32 v112, v112
  v_exp_f32 v113, v113
  v_exp_f32 v114, v114
  v_exp_f32 v115, v115
  v_exp_f32 v116, v116
  v_exp_f32 v117, v117
  v_exp_f32 v118, v118
  v_exp_f32 v119, v119
  v_cvt_pk_bf16_f32 v104, v104, v105
  v_cvt_pk_bf16_f32 v105, v106, v107
  v_cvt_pk_bf16_f32 v106, v108, v109
  v_cvt_pk_bf16_f32 v107, v110, v111
  v_cvt_pk_bf16_f32 v108, v112, v113
  v_cvt_pk_bf16_f32 v109, v114, v115
  v_cvt_pk_bf16_f32 v110, v116, v117
  v_cvt_pk_bf16_f32 v111, v118, v119
  v_and_b32 v112, v16, v104
  v_xor_b32 v104, v104, v112
  v_and_b32 v113, v17, v105
  v_xor_b32 v105, v105, v113
  v_and_b32 v114, v18, v106
  v_xor_b32 v106, v106, v114
  v_and_b32 v115, v19, v107
  v_xor_b32 v107, v107, v115
  v_and_b32 v116, v20, v108
  v_xor_b32 v108, v108, v116
  v_and_b32 v117, v21, v109
  v_xor_b32 v109, v109, v117
  v_and_b32 v118, v22, v110
  v_xor_b32 v110, v110, v118
  v_and_b32 v119, v23, v111
  v_xor_b32 v111, v111, v119
  v_pk_fma_f32 v[120:121], v[120:121], v[14:15], v[12:13] op_sel_hi:[1,0,0]
  v_pk_fma_f32 v[122:123], v[122:123], v[14:15], v[12:13] op_sel_hi:[1,0,0]
  v_pk_fma_f32 v[124:125], v[124:125], v[14:15], v[12:13] op_sel_hi:[1,0,0]
  v_pk_fma_f32 v[126:127], v[126:127], v[14:15], v[12:13] op_sel_hi:[1,0,0]
  v_pk_fma_f32 v[128:129], v[128:129], v[14:15], v[12:13] op_sel_hi:[1,0,0]
  v_pk_fma_f32 v[130:131], v[130:131], v[14:15], v[12:13] op_sel_hi:[1,0,0]
  v_pk_fma_f32 v[132:133], v[132:133], v[14:15], v[12:13] op_sel_hi:[1,0,0]
  v_pk_fma_f32 v[134:135], v[134:135], v[14:15], v[12:13] op_sel_hi:[1,0,0]
  v_exp_f32 v120, v120
  v_exp_f32 v121, v121
  v_exp_f32 v122, v122
  v_exp_f32 v123, v123
  s_waitcnt vmcnt(20)
  v_mfma_f32_32x32x16_bf16 v[232:247], v[48:51], v[112:115], 0
  v_mfma_f32_32x32x16_bf16 v[232:247], v[52:55], v[116:119], v[232:247]
  s_waitcnt vmcnt(18)
  v_mfma_f32_32x32x16_bf16 v[232:247], v[56:59], v[104:107], v[232:247]
  v_mfma_f32_32x32x16_bf16 v[232:247], v[60:63], v[108:111], v[232:247]
  s_add_i32 s36, s33, -2
  s_max_i32 s36, s36, 0
  s_mul_i32 s36, s36, 36928
  s_add_u32 s36, s36, 15597568
  s_add_u32 s37, s36, 18464
  s_mov_b32 exec_lo, 0x3ffff
  s_mov_b32 exec_hi, 0x3ffff
  buffer_load_dwordx4 v[48:51], v5, s[12:15], s36 offen
  buffer_load_dwordx4 v[52:55], v5, s[12:15], s37 offen
  s_mov_b64 exec, -1
  s_add_i32 s36, s33, -1
  s_max_i32 s36, s36, 0
  s_mul_i32 s36, s36, 36928
  s_add_u32 s36, s36, 15597568
  s_add_u32 s37, s36, 18464
  s_mov_b32 exec_lo, 0x3ffff
  s_mov_b32 exec_hi, 0x3ffff
  buffer_load_dwordx4 v[56:59], v5, s[12:15], s36 offen
  buffer_load_dwordx4 v[60:63], v5, s[12:15], s37 offen
  s_mov_b64 exec, -1
  v_exp_f32 v124, v124
  v_exp_f32 v125, v125
  v_exp_f32 v126, v126
  v_exp_f32 v127, v127
  v_exp_f32 v128, v128
  v_exp_f32 v129, v129
  v_exp_f32 v130, v130
  v_exp_f32 v131, v131
  v_exp_f32 v132, v132
  v_exp_f32 v133, v133
  v_exp_f32 v134, v134
  v_exp_f32 v135, v135
  v_cvt_pk_bf16_f32 v120, v120, v121
  v_cvt_pk_bf16_f32 v121, v122, v123
  v_cvt_pk_bf16_f32 v122, v124, v125
  v_cvt_pk_bf16_f32 v123, v126, v127
  v_cvt_pk_bf16_f32 v124, v128, v129
  v_cvt_pk_bf16_f32 v125, v130, v131
  v_cvt_pk_bf16_f32 v126, v132, v133
  v_cvt_pk_bf16_f32 v127, v134, v135
  buffer_load_dwordx4 v[128:131], v1, s[12:15], s24 offen offset:2048
  buffer_load_dwordx4 v[132:135], v1, s[12:15], s24 offen offset:3072
  v_pk_fma_f32 v[136:137], v[136:137], v[14:15], v[12:13] op_sel_hi:[1,0,0]
  v_pk_fma_f32 v[138:139], v[138:139], v[14:15], v[12:13] op_sel_hi:[1,0,0]
  v_pk_fma_f32 v[140:141], v[140:141], v[14:15], v[12:13] op_sel_hi:[1,0,0]
  v_pk_fma_f32 v[142:143], v[142:143], v[14:15], v[12:13] op_sel_hi:[1,0,0]
  v_pk_fma_f32 v[144:145], v[144:145], v[14:15], v[12:13] op_sel_hi:[1,0,0]
  v_pk_fma_f32 v[146:147], v[146:147], v[14:15], v[12:13] op_sel_hi:[1,0,0]
  v_pk_fma_f32 v[148:149], v[148:149], v[14:15], v[12:13] op_sel_hi:[1,0,0]
  v_pk_fma_f32 v[150:151], v[150:151], v[14:15], v[12:13] op_sel_hi:[1,0,0]
  v_exp_f32 v136, v136
  v_exp_f32 v137, v137
  v_exp_f32 v138, v138
  v_exp_f32 v139, v139
  s_waitcnt vmcnt(22)
  v_mfma_f32_32x32x16_bf16 v[232:247], v[64:67], v[120:123], v[232:247]
  v_mfma_f32_32x32x16_bf16 v[232:247], v[68:71], v[124:127], v[232:247]
  v_exp_f32 v140, v140
  v_exp_f32 v141, v141
  v_exp_f32 v142, v142
  v_exp_f32 v143, v143
  v_exp_f32 v144, v144
  v_exp_f32 v145, v145
  v_exp_f32 v146, v146
  v_exp_f32 v147, v147
  v_exp_f32 v148, v148
  v_exp_f32 v149, v149
  v_exp_f32 v150, v150
  v_exp_f32 v151, v151
  v_cvt_pk_bf16_f32 v136, v136, v137
  v_cvt_pk_bf16_f32 v137, v138, v139
  v_cvt_pk_bf16_f32 v138, v140, v141
  v_cvt_pk_bf16_f32 v139, v142, v143
  v_cvt_pk_bf16_f32 v140, v144, v145
  v_cvt_pk_bf16_f32 v141, v146, v147
  v_cvt_pk_bf16_f32 v142, v148, v149
  v_cvt_pk_bf16_f32 v143, v150, v151
  buffer_load_dwordx4 v[144:147], v1, s[12:15], s25 offen offset:0
  buffer_load_dwordx4 v[148:151], v1, s[12:15], s25 offen offset:1024
  v_pk_fma_f32 v[152:153], v[152:153], v[14:15], v[12:13] op_sel_hi:[1,0,0]
  v_pk_fma_f32 v[154:155], v[154:155], v[14:15], v[12:13] op_sel_hi:[1,0,0]
  v_pk_fma_f32 v[156:157], v[156:157], v[14:15], v[12:13] op_sel_hi:[1,0,0]
  v_pk_fma_f32 v[158:159], v[158:159], v[14:15], v[12:13] op_sel_hi:[1,0,0]
  v_pk_fma_f32 v[160:161], v[160:161], v[14:15], v[12:13] op_sel_hi:[1,0,0]
  v_pk_fma_f32 v[162:163], v[162:163], v[14:15], v[12:13] op_sel_hi:[1,0,0]
  v_pk_fma_f32 v[164:165], v[164:165], v[14:15], v[12:13] op_sel_hi:[1,0,0]
  v_pk_fma_f32 v[166:167], v[166:167], v[14:15], v[12:13] op_sel_hi:[1,0,0]
  v_exp_f32 v152, v152
  v_exp_f32 v153, v153
  v_exp_f32 v154, v154
  v_exp_f32 v155, v155
  s_waitcnt vmcnt(22)
  v_mfma_f32_32x32x16_bf16 v[232:247], v[72:75], v[136:139], v[232:247]
  v_mfma_f32_32x32x16_bf16 v[232:247], v[76:79], v[140:143], v[232:247]
  v_exp_f32 v156, v156
  v_exp_f32 v157, v157
  v_exp_f32 v158, v158
  v_exp_f32 v159, v159
  v_exp_f32 v160, v160
  v_exp_f32 v161, v161
  v_exp_f32 v162, v162
  v_exp_f32 v163, v163
  v_exp_f32 v164, v164
  v_exp_f32 v165, v165
  v_exp_f32 v166, v166
  v_exp_f32 v167, v167
  v_cvt_pk_bf16_f32 v152, v152, v153
  v_cvt_pk_bf16_f32 v153, v154, v155
  v_cvt_pk_bf16_f32 v154, v156, v157
  v_cvt_pk_bf16_f32 v155, v158, v159
  v_cvt_pk_bf16_f32 v156, v160, v161
  v_cvt_pk_bf16_f32 v157, v162, v163
  v_cvt_pk_bf16_f32 v158, v164, v165
  v_cvt_pk_bf16_f32 v159, v166, v167
  buffer_load_dwordx4 v[160:163], v1, s[12:15], s25 offen offset:2048
  buffer_load_dwordx4 v[164:167], v1, s[12:15], s25 offen offset:3072
  v_pk_fma_f32 v[168:169], v[168:169], v[14:15], v[12:13] op_sel_hi:[1,0,0]
  v_pk_fma_f32 v[170:171], v[170:171], v[14:15], v[12:13] op_sel_hi:[1,0,0]
  v_pk_fma_f32 v[172:173], v[172:173], v[14:15], v[12:13] op_sel_hi:[1,0,0]
  v_pk_fma_f32 v[174:175], v[174:175], v[14:15], v[12:13] op_sel_hi:[1,0,0]
  v_pk_fma_f32 v[176:177], v[176:177], v[14:15], v[12:13] op_sel_hi:[1,0,0]
  v_pk_fma_f32 v[178:179], v[178:179], v[14:15], v[12:13] op_sel_hi:[1,0,0]
  v_pk_fma_f32 v[180:181], v[180:181], v[14:15], v[12:13] op_sel_hi:[1,0,0]
  v_pk_fma_f32 v[182:183], v[182:183], v[14:15], v[12:13] op_sel_hi:[1,0,0]
  v_exp_f32 v168, v168
  v_exp_f32 v169, v169
  v_exp_f32 v170, v170
  v_exp_f32 v171, v171
  s_waitcnt vmcnt(22)
  v_mfma_f32_32x32x16_bf16 v[232:247], v[80:83], v[152:155], v[232:247]
  v_mfma_f32_32x32x16_bf16 v[232:247], v[84:87], v[156:159], v[232:247]
  v_exp_f32 v172, v172
  v_exp_f32 v173, v173
  v_exp_f32 v174, v174
  v_exp_f32 v175, v175
  v_exp_f32 v176, v176
  v_exp_f32 v177, v177
  v_exp_f32 v178, v178
  v_exp_f32 v179, v179
  v_exp_f32 v180, v180
  v_exp_f32 v181, v181
  v_exp_f32 v182, v182
  v_exp_f32 v183, v183
  v_cvt_pk_bf16_f32 v168, v168, v169
  v_cvt_pk_bf16_f32 v169, v170, v171
  v_cvt_pk_bf16_f32 v170, v172, v173
  v_cvt_pk_bf16_f32 v171, v174, v175
  v_cvt_pk_bf16_f32 v172, v176, v177
  v_cvt_pk_bf16_f32 v173, v178, v179
  v_cvt_pk_bf16_f32 v174, v180, v181
  v_cvt_pk_bf16_f32 v175, v182, v183
  buffer_load_dwordx4 v[176:179], v1, s[12:15], s26 offen offset:0
  buffer_load_dwordx4 v[180:183], v1, s[12:15], s24 offen offset:0
  v_pk_fma_f32 v[184:185], v[184:185], v[14:15], v[12:13] op_sel_hi:[1,0,0]
  v_pk_fma_f32 v[186:187], v[186:187], v[14:15], v[12:13] op_sel_hi:[1,0,0]
  v_pk_fma_f32 v[188:189], v[188:189], v[14:15], v[12:13] op_sel_hi:[1,0,0]
  v_pk_fma_f32 v[190:191], v[190:191], v[14:15], v[12:13] op_sel_hi:[1,0,0]
  v_pk_fma_f32 v[192:193], v[192:193], v[14:15], v[12:13] op_sel_hi:[1,0,0]
  v_pk_fma_f32 v[194:195], v[194:195], v[14:15], v[12:13] op_sel_hi:[1,0,0]
  v_pk_fma_f32 v[196:197], v[196:197], v[14:15], v[12:13] op_sel_hi:[1,0,0]
  v_pk_fma_f32 v[198:199], v[198:199], v[14:15], v[12:13] op_sel_hi:[1,0,0]
  v_exp_f32 v184, v184
  v_exp_f32 v185, v185
  v_exp_f32 v186, v186
  v_exp_f32 v187, v187
  s_waitcnt vmcnt(22)
  v_mfma_f32_32x32x16_bf16 v[232:247], v[88:91], v[168:171], v[232:247]
  v_mfma_f32_32x32x16_bf16 v[232:247], v[92:95], v[172:175], v[232:247]
  v_exp_f32 v188, v188
  v_exp_f32 v189, v189
  v_exp_f32 v190, v190
  v_exp_f32 v191, v191
  v_exp_f32 v192, v192
  v_exp_f32 v193, v193
  v_exp_f32 v194, v194
  v_exp_f32 v195, v195
  v_exp_f32 v196, v196
  v_exp_f32 v197, v197
  v_exp_f32 v198, v198
  v_exp_f32 v199, v199
  v_cvt_pk_bf16_f32 v184, v184, v185
  v_cvt_pk_bf16_f32 v185, v186, v187
  v_cvt_pk_bf16_f32 v186, v188, v189
  v_cvt_pk_bf16_f32 v187, v190, v191
  v_cvt_pk_bf16_f32 v188, v192, v193
  v_cvt_pk_bf16_f32 v189, v194, v195
  v_cvt_pk_bf16_f32 v190, v196, v197
  v_cvt_pk_bf16_f32 v191, v198, v199
  v_pk_fma_f32 v[200:201], v[200:201], v[14:15], v[12:13] op_sel_hi:[1,0,0]
  v_pk_fma_f32 v[202:203], v[202:203], v[14:15], v[12:13] op_sel_hi:[1,0,0]
  v_pk_fma_f32 v[204:205], v[204:205], v[14:15], v[12:13] op_sel_hi:[1,0,0]
  v_pk_fma_f32 v[206:207], v[206:207], v[14:15], v[12:13] op_sel_hi:[1,0,0]
  v_pk_fma_f32 v[208:209], v[208:209], v[14:15], v[12:13] op_sel_hi:[1,0,0]
  v_pk_fma_f32 v[210:211], v[210:211], v[14:15], v[12:13] op_sel_hi:[1,0,0]
  v_pk_fma_f32 v[212:213], v[212:213], v[14:15], v[12:13] op_sel_hi:[1,0,0]
  v_pk_fma_f32 v[214:215], v[214:215], v[14:15], v[12:13] op_sel_hi:[1,0,0]
  v_exp_f32 v200, v200
  v_exp_f32 v201, v201
  v_exp_f32 v202, v202
  v_exp_f32 v203, v203
  s_waitcnt vmcnt(20)
  v_mfma_f32_32x32x16_bf16 v[232:247], v[96:99], v[184:187], v[232:247]
  v_mfma_f32_32x32x16_bf16 v[232:247], v[100:103], v[188:191], v[232:247]
  v_exp_f32 v204, v204
  v_exp_f32 v205, v205
  v_exp_f32 v206, v206
  v_exp_f32 v207, v207
  v_exp_f32 v208, v208
  v_exp_f32 v209, v209
  v_exp_f32 v210, v210
  v_exp_f32 v211, v211
  v_exp_f32 v212, v212
  v_exp_f32 v213, v213
  v_exp_f32 v214, v214
  v_exp_f32 v215, v215
  v_cvt_pk_bf16_f32 v200, v200, v201
  v_cvt_pk_bf16_f32 v201, v202, v203
  v_cvt_pk_bf16_f32 v202, v204, v205
  v_cvt_pk_bf16_f32 v203, v206, v207
  v_cvt_pk_bf16_f32 v204, v208, v209
  v_cvt_pk_bf16_f32 v205, v210, v211
  v_cvt_pk_bf16_f32 v206, v212, v213
  v_cvt_pk_bf16_f32 v207, v214, v215
  v_pk_fma_f32 v[216:217], v[216:217], v[14:15], v[12:13] op_sel_hi:[1,0,0]
  v_pk_fma_f32 v[218:219], v[218:219], v[14:15], v[12:13] op_sel_hi:[1,0,0]
  v_pk_fma_f32 v[220:221], v[220:221], v[14:15], v[12:13] op_sel_hi:[1,0,0]
  v_pk_fma_f32 v[222:223], v[222:223], v[14:15], v[12:13] op_sel_hi:[1,0,0]
  v_pk_fma_f32 v[224:225], v[224:225], v[14:15], v[12:13] op_sel_hi:[1,0,0]
  v_pk_fma_f32 v[226:227], v[226:227], v[14:15], v[12:13] op_sel_hi:[1,0,0]
  v_pk_fma_f32 v[228:229], v[228:229], v[14:15], v[12:13] op_sel_hi:[1,0,0]
  v_pk_fma_f32 v[230:231], v[230:231], v[14:15], v[12:13] op_sel_hi:[1,0,0]
  v_exp_f32 v216, v216
  v_exp_f32 v217, v217
  v_exp_f32 v218, v218
  v_exp_f32 v219, v219
  s_waitcnt vmcnt(10)
  v_mfma_f32_32x32x16_bf16 v[232:247], v[48:51], v[200:203], v[232:247]
  v_mfma_f32_32x32x16_bf16 v[232:247], v[52:55], v[204:207], v[232:247]
  v_exp_f32 v220, v220
  v_exp_f32 v221, v221
  v_exp_f32 v222, v222
  v_exp_f32 v223, v223
  v_exp_f32 v224, v224
  v_exp_f32 v225, v225
  v_exp_f32 v226, v226
  v_exp_f32 v227, v227
  v_exp_f32 v228, v228
  v_exp_f32 v229, v229
  v_exp_f32 v230, v230
  v_exp_f32 v231, v231
  v_cvt_pk_bf16_f32 v216, v216, v217
  v_cvt_pk_bf16_f32 v217, v218, v219
  v_cvt_pk_bf16_f32 v218, v220, v221
  v_cvt_pk_bf16_f32 v219, v222, v223
  v_cvt_pk_bf16_f32 v220, v224, v225
  v_cvt_pk_bf16_f32 v221, v226, v227
  v_cvt_pk_bf16_f32 v222, v228, v229
  v_cvt_pk_bf16_f32 v223, v230, v231
  s_waitcnt vmcnt(8)
  v_mfma_f32_32x32x16_bf16 v[232:247], v[56:59], v[216:219], v[232:247]
  v_mfma_f32_32x32x16_bf16 v[232:247], v[60:63], v[220:223], v[232:247]
  s_mul_i32 s36, s32, 73728
  s_lshl_b32 s37, s33, 6
  s_add_u32 s36, s36, s37
  s_add_u32 s36, s36, 8519680
  s_nop 7
  v_rcp_f32 v12, v242
  s_nop 0
  v_pk_mul_f32 v[232:233], v[232:233], v[12:13] op_sel_hi:[1,0]
  v_pk_mul_f32 v[234:235], v[234:235], v[12:13] op_sel_hi:[1,0]
  v_pk_mul_f32 v[236:237], v[236:237], v[12:13] op_sel_hi:[1,0]
  v_pk_mul_f32 v[238:239], v[238:239], v[12:13] op_sel_hi:[1,0]
  v_pk_mul_f32 v[240:241], v[240:241], v[12:13] op_sel_hi:[1,0]
  v_cvt_pk_bf16_f32 v232, v232, v233
  v_cvt_pk_bf16_f32 v234, v234, v235
  v_cvt_pk_bf16_f32 v236, v236, v237
  v_cvt_pk_bf16_f32 v238, v238, v239
  v_cvt_pk_bf16_f32 v240, v240, v241
  s_add_u32 s37, s36, 0
  buffer_store_short v232, v6, s[12:15], s37 offen
  s_add_u32 s37, s36, 4096
  buffer_store_short_d16_hi v232, v6, s[12:15], s37 offen
  s_add_u32 s37, s36, 8192
  buffer_store_short v234, v6, s[12:15], s37 offen
  s_add_u32 s37, s36, 12288
  buffer_store_short_d16_hi v234, v6, s[12:15], s37 offen
  s_add_u32 s37, s36, 32768
  buffer_store_short v236, v6, s[12:15], s37 offen
  s_add_u32 s37, s36, 36864
  buffer_store_short_d16_hi v236, v6, s[12:15], s37 offen
  s_add_u32 s37, s36, 40960
  buffer_store_short v238, v6, s[12:15], s37 offen
  s_add_u32 s37, s36, 45056
  buffer_store_short_d16_hi v238, v6, s[12:15], s37 offen
  s_add_u32 s37, s36, 65536
  buffer_store_short v240, v7, s[12:15], s37 offen
  s_add_u32 s37, s36, 69632
  buffer_store_short_d16_hi v240, v7, s[12:15], s37 offen
  s_cmp_lt_u32 s20, s22
  s_cbranch_scc1 k1_f_loop
k1_f_done:
k1_fpf:
  s_lshr_b32 s34, s4, 1
  s_mul_i32 s35, s34, 20
  s_cmp_lg_u32 s34, 0
  s_addc_u32 s35, s35, 0
  s_lshl_b32 s35, s35, 18
  s_and_b32 s34, s4, 1
  s_lshl_b32 s34, s34, 11
  s_add_u32 s35, s35, s34
  s_and_b32 s35, s35, 0xfffc0000
  s_and_b32 s34, s4, 1
  s_mul_i32 s34, s34, 192
  s_add_u32 s34, s34, s3
  s_mov_b32 s36, 3
  s_mov_b32 s37, 144
  s_cmp_eq_u32 s5, 28
  s_cselect_b32 s37, 168, s37
  s_cmp_eq_u32 s5, 29
  s_cselect_b32 s37, 96, s37
  s_cselect_b32 s36, 6, s36
  s_cmp_eq_u32 s5, 30
  s_cselect_b32 s37, 0, s37
  s_cselect_b32 s36, 6, s36
  s_cmp_eq_u32 s5, 31
  s_cselect_b32 s37, 48, s37
  s_cselect_b32 s36, 6, s36
  s_add_u32 s34, s34, s37
  s_lshl_b32 s34, s34, 13
  s_add_u32 s35, s35, s34
  v_lshlrev_b32 v255, 7, v0
k1_fpl:
  buffer_load_dword v254, v255, s[16:19], s35 offen
  s_add_u32 s35, s35, 65536
  s_sub_u32 s36, s36, 1
  s_cmp_lg_u32 s36, 0
  s_cbranch_scc1 k1_fpl
  s_waitcnt vmcnt(0)
  s_endpgm
k1_exit:
  s_endpgm
.p2align 8
.globl k2_gemm2_kernel
.type k2_gemm2_kernel,@function
k2_gemm2_kernel:
  s_cmp_ge_u32 s2, 256
  s_cbranch_scc1 k2_exit
  s_load_dwordx2 s[28:29], s[0:1], 0
  s_load_dwordx4 s[32:35], s[0:1], 48
  s_load_dwordx2 s[36:37], s[0:1], 64
  s_load_dwordx2 s[30:31], s[0:1], 80
  v_lshrrev_b32 v1, 6, v0
  v_and_b32 v0, 63, v0
  v_readfirstlane_b32 s3, v1
  s_and_b32 s4, s2, 7
  s_lshr_b32 s5, s2, 3
  s_lshr_b32 s6, s4, 1
  s_and_b32 s7, s4, 1
  s_lshl_b32 s7, s7, 3
  s_lshr_b32 s38, s5, 2
  s_add_u32 s7, s7, s38
  s_and_b32 s5, s5, 3
  s_mul_i32 s39, s6, 20
  s_cmp_lg_u32 s6, 0
  s_addc_u32 s39, s39, 0
  s_cmp_eq_u32 s6, 0
  s_cselect_b32 s40, 21, 20
  s_waitcnt lgkmcnt(0)
  s_mov_b32 s8, s32
  s_and_b32 s9, s33, 0xffff
  s_mov_b32 s10, 18874368
  s_mov_b32 s11, 0x20000
  s_mov_b32 s12, s30
  s_and_b32 s13, s31, 0xffff
  s_mov_b32 s14, 37355520
  s_mov_b32 s15, 0x20000
  s_mov_b32 s16, s28
  s_and_b32 s17, s29, 0xffff
  s_mov_b32 s18, 2359296
  s_mov_b32 s19, 0x20000
  s_mov_b32 s20, s34
  s_and_b32 s21, s35, 0xffff
  s_mov_b32 s22, 4096
  s_mov_b32 s23, 0x20000
  s_mov_b32 s24, s36
  s_and_b32 s25, s37, 0xffff
  s_mov_b32 s26, 2359296
  s_mov_b32 s27, 0x20000
  s_cmp_ge_u32 s3, 4
  s_cbranch_scc1 k2_loader
  s_setprio 2
  v_and_b32 v9, 15, v0
  v_lshrrev_b32 v10, 4, v0
  s_lshl_b32 s41, s7, 7
  s_lshl_b32 s42, s3, 5
  s_add_u32 s41, s41, s42
  s_lshr_b32 s42, s6, 1
  s_lshl_b32 s42, s42, 4
  s_add_u32 s41, s41, s42
  v_add_u32 v11, s41, v9
  v_mul_u32_u24 v15, 1152, v11
  v_lshl_add_u32 v15, v10, 3, v15
  v_lshlrev_b32 v11, 1, v11
  s_mul_i32 s43, s5, 288
  s_and_b32 s42, s6, 1
  s_mul_i32 s42, s42, 160
  s_add_u32 s43, s43, s42
  buffer_load_ushort v18, v11, s[20:23], 0 offen
  buffer_load_dwordx2 v[20:21], v15, s[16:19], s43 offen offset:0
  buffer_load_dwordx2 v[22:23], v15, s[16:19], s43 offen offset:32
  buffer_load_dwordx2 v[24:25], v15, s[16:19], s43 offen offset:64
  buffer_load_dwordx2 v[26:27], v15, s[16:19], s43 offen offset:96
  buffer_load_dwordx2 v[28:29], v15, s[16:19], s43 offen offset:128
  v_bfe_u32 v12, v0, 2, 2
  v_lshl_add_u32 v13, v10, 3, v12
  v_lshlrev_b32 v1, 8, v13
  v_and_b32 v13, 3, v0
  v_lshl_add_u32 v1, v13, 3, v1
  v_and_b32 v13, 1, v10
  v_lshl_add_u32 v12, v13, 2, v12
  s_lshl_b32 s42, s3, 1
  v_xor_b32 v12, s42, v12
  v_xor_b32 v13, 1, v12
  v_lshl_add_u32 v2, v13, 5, v1
  v_lshl_add_u32 v1, v12, 5, v1
  v_lshrrev_b32 v12, 1, v9
  v_xor_b32 v12, v12, v10
  v_lshlrev_b32 v13, 7, v9
  v_lshl_add_u32 v3, v12, 4, v13
  v_xor_b32 v12, 4, v12
  v_lshl_add_u32 v4, v12, 4, v13
  v_mov_b32 v5, v1
  v_mov_b32 v7, v3
  v_mov_b32 v6, v2
  v_mov_b32 v8, v4
  v_mov_b32 v32, 0
  v_mov_b32 v33, 0
  v_mov_b32 v34, 0
  v_mov_b32 v35, 0
  v_mov_b32 v36, 0
  v_mov_b32 v37, 0
  v_mov_b32 v38, 0
  v_mov_b32 v39, 0
  v_mov_b32 v40, 0
  v_mov_b32 v41, 0
  v_mov_b32 v42, 0
  v_mov_b32 v43, 0
  v_mov_b32 v44, 0
  v_mov_b32 v45, 0
  v_mov_b32 v46, 0
  v_mov_b32 v47, 0
  v_mov_b32 v48, 0
  v_mov_b32 v49, 0
  v_mov_b32 v50, 0
  v_mov_b32 v51, 0
  v_mov_b32 v52, 0
  v_mov_b32 v53, 0
  v_mov_b32 v54, 0
  v_mov_b32 v55, 0
  v_mov_b32 v56, 0
  v_mov_b32 v57, 0
  v_mov_b32 v58, 0
  v_mov_b32 v59, 0
  v_mov_b32 v60, 0
  v_mov_b32 v61, 0
  v_mov_b32 v62, 0
  v_mov_b32 v63, 0
  v_mov_b32 v64, 0
  v_mov_b32 v65, 0
  v_mov_b32 v66, 0
  v_mov_b32 v67, 0
  v_mov_b32 v68, 0
  v_mov_b32 v69, 0
  v_mov_b32 v70, 0
  v_mov_b32 v71, 0
  v_mov_b32 v72, 0
  v_mov_b32 v73, 0
  v_mov_b32 v74, 0
  v_mov_b32 v75, 0
  v_mov_b32 v76, 0
  v_mov_b32 v77, 0
  v_mov_b32 v78, 0
  v_mov_b32 v79, 0
  v_mov_b32 v80, 0
  v_mov_b32 v81, 0
  v_mov_b32 v82, 0
  v_mov_b32 v83, 0
  v_mov_b32 v84, 0
  v_mov_b32 v85, 0
  v_mov_b32 v86, 0
  v_mov_b32 v87, 0
  v_mov_b32 v88, 0
  v_mov_b32 v89, 0
  v_mov_b32 v90, 0
  v_mov_b32 v91, 0
  v_mov_b32 v92, 0
  v_mov_b32 v93, 0
  v_mov_b32 v94, 0
  v_mov_b32 v95, 0
  v_mov_b32 v96, 0
  v_mov_b32 v97, 0
  v_mov_b32 v98, 0
  v_mov_b32 v99, 0
  v_mov_b32 v100, 0
  v_mov_b32 v101, 0
  v_mov_b32 v102, 0
  v_mov_b32 v103, 0
  v_lshlrev_b32 v16, 4, v0
  s_mov_b32 s44, 0
  s_barrier
  ds_read_b64_tr_b16 v[128:129], v5 offset:0
  ds_read_b64_tr_b16 v[130:131], v5 offset:1024
  ds_read_b64_tr_b16 v[132:133], v6 offset:0
  ds_read_b64_tr_b16 v[134:135], v6 offset:1024
  ds_read_b128 v[104:107], v7 offset:16384
  ds_read_b128 v[108:111], v7 offset:18432
  ds_read_b128 v[112:115], v7 offset:20480
  ds_read_b128 v[116:119], v7 offset:22528
  s_sub_u32 s45, s40, 1
k2_cloop:
  s_waitcnt lgkmcnt(3)
  v_mfma_f32_16x16x32_bf16 v[32:35], v[104:107], v[128:131], v[32:35]
  ds_read_b128 v[120:123], v7 offset:24576
  v_mfma_f32_16x16x32_bf16 v[68:71], v[104:107], v[132:135], v[68:71]
  s_waitcnt lgkmcnt(3)
  v_mfma_f32_16x16x32_bf16 v[36:39], v[108:111], v[128:131], v[36:39]
  ds_read_b128 v[124:127], v7 offset:26624
  v_mfma_f32_16x16x32_bf16 v[72:75], v[108:111], v[132:135], v[72:75]
  s_waitcnt lgkmcnt(3)
  v_mfma_f32_16x16x32_bf16 v[40:43], v[112:115], v[128:131], v[40:43]
  ds_read_b128 v[104:107], v7 offset:28672
  v_mfma_f32_16x16x32_bf16 v[76:79], v[112:115], v[132:135], v[76:79]
  s_waitcnt lgkmcnt(3)
  v_mfma_f32_16x16x32_bf16 v[44:47], v[116:119], v[128:131], v[44:47]
  ds_read_b128 v[108:111], v7 offset:30720
  v_mfma_f32_16x16x32_bf16 v[80:83], v[116:119], v[132:135], v[80:83]
  s_waitcnt lgkmcnt(3)
  v_mfma_f32_16x16x32_bf16 v[48:51], v[120:123], v[128:131], v[48:51]
  ds_read_b128 v[112:115], v7 offset:32768
  v_mfma_f32_16x16x32_bf16 v[84:87], v[120:123], v[132:135], v[84:87]
  s_waitcnt lgkmcnt(3)
  v_mfma_f32_16x16x32_bf16 v[52:55], v[124:127], v[128:131], v[52:55]
  ds_read_b64_tr_b16 v[136:137], v5 offset:8192
  ds_read_b64_tr_b16 v[138:139], v5 offset:9216
  ds_read_b64_tr_b16 v[140:141], v6 offset:8192
  ds_read_b64_tr_b16 v[142:143], v6 offset:9216
  ds_read_b128 v[116:119], v8 offset:16384
  v_mfma_f32_16x16x32_bf16 v[88:91], v[124:127], v[132:135], v[88:91]
  s_waitcnt lgkmcnt(7)
  v_mfma_f32_16x16x32_bf16 v[56:59], v[104:107], v[128:131], v[56:59]
  ds_read_b128 v[120:123], v8 offset:18432
  v_mfma_f32_16x16x32_bf16 v[92:95], v[104:107], v[132:135], v[92:95]
  s_waitcnt lgkmcnt(7)
  v_mfma_f32_16x16x32_bf16 v[60:63], v[108:111], v[128:131], v[60:63]
  ds_read_b128 v[124:127], v8 offset:20480
  v_mfma_f32_16x16x32_bf16 v[96:99], v[108:111], v[132:135], v[96:99]
  s_waitcnt lgkmcnt(7)
  v_mfma_f32_16x16x32_bf16 v[64:67], v[112:115], v[128:131], v[64:67]
  ds_read_b128 v[104:107], v8 offset:22528
  v_mfma_f32_16x16x32_bf16 v[100:103], v[112:115], v[132:135], v[100:103]
  s_waitcnt lgkmcnt(3)
  v_mfma_f32_16x16x32_bf16 v[32:35], v[116:119], v[136:139], v[32:35]
  ds_read_b128 v[108:111], v8 offset:24576
  v_mfma_f32_16x16x32_bf16 v[68:71], v[116:119], v[140:143], v[68:71]
  s_waitcnt lgkmcnt(3)
  v_mfma_f32_16x16x32_bf16 v[36:39], v[120:123], v[136:139], v[36:39]
  ds_read_b128 v[112:115], v8 offset:26624
  v_mfma_f32_16x16x32_bf16 v[72:75], v[120:123], v[140:143], v[72:75]
  s_waitcnt lgkmcnt(3)
  v_mfma_f32_16x16x32_bf16 v[40:43], v[124:127], v[136:139], v[40:43]
  ds_read_b128 v[116:119], v8 offset:28672
  v_mfma_f32_16x16x32_bf16 v[76:79], v[124:127], v[140:143], v[76:79]
  s_waitcnt lgkmcnt(3)
  v_mfma_f32_16x16x32_bf16 v[44:47], v[104:107], v[136:139], v[44:47]
  ds_read_b128 v[120:123], v8 offset:30720
  v_mfma_f32_16x16x32_bf16 v[80:83], v[104:107], v[140:143], v[80:83]
  ds_read_b128 v[124:127], v8 offset:32768
  s_waitcnt lgkmcnt(4)
  v_mfma_f32_16x16x32_bf16 v[48:51], v[108:111], v[136:139], v[48:51]
  v_mfma_f32_16x16x32_bf16 v[84:87], v[108:111], v[140:143], v[84:87]
  s_waitcnt lgkmcnt(0)
  v_mfma_f32_16x16x32_bf16 v[52:55], v[112:115], v[136:139], v[52:55]
  s_add_u32 s44, s44, 34816
  s_cmp_ge_u32 s44, 104448
  s_cselect_b32 s44, 0, s44
  s_barrier
  v_add_u32 v5, s44, v1
  v_add_u32 v7, s44, v3
  v_add_u32 v6, s44, v2
  v_add_u32 v8, s44, v4
  ds_read_b64_tr_b16 v[128:129], v5 offset:0
  ds_read_b64_tr_b16 v[130:131], v5 offset:1024
  ds_read_b64_tr_b16 v[132:133], v6 offset:0
  ds_read_b64_tr_b16 v[134:135], v6 offset:1024
  ds_read_b128 v[104:107], v7 offset:16384
  v_mfma_f32_16x16x32_bf16 v[88:91], v[112:115], v[140:143], v[88:91]
  v_mfma_f32_16x16x32_bf16 v[56:59], v[116:119], v[136:139], v[56:59]
  ds_read_b128 v[108:111], v7 offset:18432
  v_mfma_f32_16x16x32_bf16 v[92:95], v[116:119], v[140:143], v[92:95]
  v_mfma_f32_16x16x32_bf16 v[60:63], v[120:123], v[136:139], v[60:63]
  ds_read_b128 v[112:115], v7 offset:20480
  v_mfma_f32_16x16x32_bf16 v[96:99], v[120:123], v[140:143], v[96:99]
  v_mfma_f32_16x16x32_bf16 v[64:67], v[124:127], v[136:139], v[64:67]
  ds_read_b128 v[116:119], v7 offset:22528
  v_mfma_f32_16x16x32_bf16 v[100:103], v[124:127], v[140:143], v[100:103]
  s_sub_u32 s45, s45, 1
  s_cmp_lg_u32 s45, 0
  s_cbranch_scc1 k2_cloop
  s_waitcnt lgkmcnt(3)
  v_mfma_f32_16x16x32_bf16 v[32:35], v[104:107], v[128:131], v[32:35]
  ds_read_b128 v[120:123], v7 offset:24576
  v_mfma_f32_16x16x32_bf16 v[68:71], v[104:107], v[132:135], v[68:71]
  s_waitcnt lgkmcnt(3)
  v_mfma_f32_16x16x32_bf16 v[36:39], v[108:111], v[128:131], v[36:39]
  ds_read_b128 v[124:127], v7 offset:26624
  v_mfma_f32_16x16x32_bf16 v[72:75], v[108:111], v[132:135], v[72:75]
  s_waitcnt lgkmcnt(3)
  v_mfma_f32_16x16x32_bf16 v[40:43], v[112:115], v[128:131], v[40:43]
  ds_read_b128 v[104:107], v7 offset:28672
  v_mfma_f32_16x16x32_bf16 v[76:79], v[112:115], v[132:135], v[76:79]
  s_waitcnt lgkmcnt(3)
  v_mfma_f32_16x16x32_bf16 v[44:47], v[116:119], v[128:131], v[44:47]
  ds_read_b128 v[108:111], v7 offset:30720
  v_mfma_f32_16x16x32_bf16 v[80:83], v[116:119], v[132:135], v[80:83]
  s_waitcnt lgkmcnt(3)
  v_mfma_f32_16x16x32_bf16 v[48:51], v[120:123], v[128:131], v[48:51]
  ds_read_b128 v[112:115], v7 offset:32768
  v_mfma_f32_16x16x32_bf16 v[84:87], v[120:123], v[132:135], v[84:87]
  s_waitcnt lgkmcnt(3)
  v_mfma_f32_16x16x32_bf16 v[52:55], v[124:127], v[128:131], v[52:55]
  ds_read_b64_tr_b16 v[136:137], v5 offset:8192
  ds_read_b64_tr_b16 v[138:139], v5 offset:9216
  ds_read_b64_tr_b16 v[140:141], v6 offset:8192
  ds_read_b64_tr_b16 v[142:143], v6 offset:9216
  ds_read_b128 v[116:119], v8 offset:16384
  v_mfma_f32_16x16x32_bf16 v[88:91], v[124:127], v[132:135], v[88:91]
  s_waitcnt lgkmcnt(7)
  v_mfma_f32_16x16x32_bf16 v[56:59], v[104:107], v[128:131], v[56:59]
  ds_read_b128 v[120:123], v8 offset:18432
  v_mfma_f32_16x16x32_bf16 v[92:95], v[104:107], v[132:135], v[92:95]
  s_waitcnt lgkmcnt(7)
  v_mfma_f32_16x16x32_bf16 v[60:63], v[108:111], v[128:131], v[60:63]
  ds_read_b128 v[124:127], v8 offset:20480
  v_mfma_f32_16x16x32_bf16 v[96:99], v[108:111], v[132:135], v[96:99]
  s_waitcnt lgkmcnt(7)
  v_mfma_f32_16x16x32_bf16 v[64:67], v[112:115], v[128:131], v[64:67]
  ds_read_b128 v[104:107], v8 offset:22528
  v_mfma_f32_16x16x32_bf16 v[100:103], v[112:115], v[132:135], v[100:103]
  s_waitcnt lgkmcnt(3)
  v_mfma_f32_16x16x32_bf16 v[32:35], v[116:119], v[136:139], v[32:35]
  ds_read_b128 v[108:111], v8 offset:24576
  v_mfma_f32_16x16x32_bf16 v[68:71], v[116:119], v[140:143], v[68:71]
  s_waitcnt lgkmcnt(3)
  v_mfma_f32_16x16x32_bf16 v[36:39], v[120:123], v[136:139], v[36:39]
  ds_read_b128 v[112:115], v8 offset:26624
  v_mfma_f32_16x16x32_bf16 v[72:75], v[120:123], v[140:143], v[72:75]
  s_waitcnt lgkmcnt(3)
  v_mfma_f32_16x16x32_bf16 v[40:43], v[124:127], v[136:139], v[40:43]
  ds_read_b128 v[116:119], v8 offset:28672
  v_mfma_f32_16x16x32_bf16 v[76:79], v[124:127], v[140:143], v[76:79]
  s_waitcnt lgkmcnt(3)
  v_mfma_f32_16x16x32_bf16 v[44:47], v[104:107], v[136:139], v[44:47]
  ds_read_b128 v[120:123], v8 offset:30720
  v_mfma_f32_16x16x32_bf16 v[80:83], v[104:107], v[140:143], v[80:83]
  ds_read_b128 v[124:127], v8 offset:32768
  s_waitcnt lgkmcnt(4)
  v_mfma_f32_16x16x32_bf16 v[48:51], v[108:111], v[136:139], v[48:51]
  v_mfma_f32_16x16x32_bf16 v[84:87], v[108:111], v[140:143], v[84:87]
  s_waitcnt lgkmcnt(0)
  v_mfma_f32_16x16x32_bf16 v[52:55], v[112:115], v[136:139], v[52:55]
  v_mfma_f32_16x16x32_bf16 v[88:91], v[112:115], v[140:143], v[88:91]
  v_mfma_f32_16x16x32_bf16 v[56:59], v[116:119], v[136:139], v[56:59]
  v_mfma_f32_16x16x32_bf16 v[92:95], v[116:119], v[140:143], v[92:95]
  v_mfma_f32_16x16x32_bf16 v[60:63], v[120:123], v[136:139], v[60:63]
  v_mfma_f32_16x16x32_bf16 v[96:99], v[120:123], v[140:143], v[96:99]
  v_mfma_f32_16x16x32_bf16 v[64:67], v[124:127], v[136:139], v[64:67]
  v_mfma_f32_16x16x32_bf16 v[100:103], v[124:127], v[140:143], v[100:103]
  s_lshl_b32 s46, s7, 2
  s_add_u32 s46, s46, s5
  s_mul_i32 s47, s46, 135168
  s_mov_b32 s48, 18022400
  s_cmp_ge_u32 s46, 52
  s_mov_b32 s48, 10878976
  s_cselect_b32 s48, 4287942656, s48
  s_add_u32 s47, s47, s48
  s_mul_i32 s48, s3, 2560
  s_add_u32 s52, s47, s48
  s_mul_i32 s48, s3, 3072
  s_add_u32 s47, s47, s48
  v_lshlrev_b32 v13, 3, v0
  s_mov_b32 s49, 0xffff0000
  s_waitcnt vmcnt(0)
  s_cmp_eq_u32 s6, 1
  s_cbranch_scc1 k2_q1
  s_cmp_eq_u32 s6, 2
  s_cbranch_scc1 k2_q2
  s_cmp_eq_u32 s6, 3
  s_cbranch_scc1 k2_q3
  s_add_u32 s50, s52, 57344
  v_cvt_pk_bf16_f32 v52, v52, v53
  v_cvt_pk_bf16_f32 v53, v54, v55
  v_cvt_pk_bf16_f32 v54, v56, v57
  v_cvt_pk_bf16_f32 v55, v58, v58
  v_or_b32 v55, s49, v55
  buffer_store_dwordx4 v[52:55], v16, s[12:15], s50 offen offset:0 sc1
  v_cvt_pk_bf16_f32 v56, v59, v60
  v_cvt_pk_bf16_f32 v57, v61, v62
  v_cvt_pk_bf16_f32 v58, v63, v64
  v_cvt_pk_bf16_f32 v59, v65, v65
  v_or_b32 v59, s49, v59
  buffer_store_dwordx4 v[56:59], v16, s[12:15], s50 offen offset:1024 sc1
  s_add_u32 s50, s47, 79872
  v_cvt_pk_bf16_f32 v68, v68, v69
  v_cvt_pk_bf16_f32 v69, v70, v71
  v_cvt_pk_bf16_f32 v70, v72, v73
  v_cvt_pk_bf16_f32 v71, v74, v74
  v_or_b32 v71, s49, v71
  buffer_store_dwordx4 v[68:71], v16, s[12:15], s50 offen offset:0 sc1
  v_cvt_pk_bf16_f32 v72, v75, v76
  v_cvt_pk_bf16_f32 v73, v77, v78
  v_cvt_pk_bf16_f32 v74, v79, v80
  v_cvt_pk_bf16_f32 v75, v81, v81
  v_or_b32 v75, s49, v75
  buffer_store_dwordx4 v[72:75], v16, s[12:15], s50 offen offset:1024 sc1
  s_add_u32 s50, s52, 104448
  v_cvt_pk_bf16_f32 v88, v88, v89
  v_cvt_pk_bf16_f32 v89, v90, v91
  v_cvt_pk_bf16_f32 v90, v92, v93
  v_cvt_pk_bf16_f32 v91, v94, v94
  v_or_b32 v91, s49, v91
  buffer_store_dwordx4 v[88:91], v16, s[12:15], s50 offen offset:0 sc1
  v_cvt_pk_bf16_f32 v92, v95, v96
  v_cvt_pk_bf16_f32 v93, v97, v98
  v_cvt_pk_bf16_f32 v94, v99, v100
  v_cvt_pk_bf16_f32 v95, v101, v101
  v_or_b32 v95, s49, v95
  buffer_store_dwordx4 v[92:95], v16, s[12:15], s50 offen offset:1024 sc1
  s_add_u32 s50, s52, 57344
  v_cvt_pk_bf16_f32 v60, v66, v67
  v_mov_b32 v61, s49
  v_mov_b32 v63, s49
  buffer_store_dwordx2 v[60:61], v13, s[12:15], s50 offen offset:2048 sc1
  s_add_u32 s50, s47, 79872
  v_cvt_pk_bf16_f32 v76, v82, v83
  v_cvt_pk_bf16_f32 v77, v84, v85
  v_cvt_pk_bf16_f32 v78, v86, v87
  v_mov_b32 v79, s49
  buffer_store_dwordx4 v[76:79], v16, s[12:15], s50 offen offset:2048 sc1
  s_add_u32 s50, s52, 104448
  v_cvt_pk_bf16_f32 v96, v102, v103
  v_mov_b32 v97, s49
  v_mov_b32 v99, s49
  buffer_store_dwordx2 v[96:97], v13, s[12:15], s50 offen offset:2048 sc1
  s_add_u32 s53, s47, 0
  s_add_u32 s54, s47, 12288
  s_add_u32 s55, s47, 24576
  v_lshlrev_b32 v18, 16, v18
  v_lshlrev_b32 v184, 16, v20
  v_and_b32 v185, 0xffff0000, v20
  v_pk_add_f32 v[32:33], v[32:33], v[18:19] op_sel_hi:[1,0]
  s_nop 0
  v_pk_add_f32 v[32:33], v[32:33], v[184:185]
  v_lshlrev_b32 v186, 16, v21
  v_and_b32 v187, 0xffff0000, v21
  v_pk_add_f32 v[34:35], v[34:35], v[18:19] op_sel_hi:[1,0]
  s_nop 0
  v_pk_add_f32 v[34:35], v[34:35], v[186:187]
  v_lshlrev_b32 v188, 16, v22
  v_and_b32 v189, 0xffff0000, v22
  v_pk_add_f32 v[36:37], v[36:37], v[18:19] op_sel_hi:[1,0]
  s_nop 0
  v_pk_add_f32 v[36:37], v[36:37], v[188:189]
  v_lshlrev_b32 v190, 16, v23
  v_and_b32 v191, 0xffff0000, v23
  v_pk_add_f32 v[38:39], v[38:39], v[18:19] op_sel_hi:[1,0]
  s_nop 0
  v_pk_add_f32 v[38:39], v[38:39], v[190:191]
  v_lshlrev_b32 v184, 16, v24
  v_and_b32 v185, 0xffff0000, v24
  v_pk_add_f32 v[40:41], v[40:41], v[18:19] op_sel_hi:[1,0]
  s_nop 0
  v_pk_add_f32 v[40:41], v[40:41], v[184:185]
  v_lshlrev_b32 v186, 16, v25
  v_and_b32 v187, 0xffff0000, v25
  v_pk_add_f32 v[42:43], v[42:43], v[18:19] op_sel_hi:[1,0]
  s_nop 0
  v_pk_add_f32 v[42:43], v[42:43], v[186:187]
  v_lshlrev_b32 v188, 16, v26
  v_and_b32 v189, 0xffff0000, v26
  v_pk_add_f32 v[44:45], v[44:45], v[18:19] op_sel_hi:[1,0]
  s_nop 0
  v_pk_add_f32 v[44:45], v[44:45], v[188:189]
  v_lshlrev_b32 v190, 16, v27
  v_and_b32 v191, 0xffff0000, v27
  v_pk_add_f32 v[46:47], v[46:47], v[18:19] op_sel_hi:[1,0]
  s_nop 0
  v_pk_add_f32 v[46:47], v[46:47], v[190:191]
  v_lshlrev_b32 v184, 16, v28
  v_and_b32 v185, 0xffff0000, v28
  v_pk_add_f32 v[48:49], v[48:49], v[18:19] op_sel_hi:[1,0]
  s_nop 0
  v_pk_add_f32 v[48:49], v[48:49], v[184:185]
  v_lshlrev_b32 v186, 16, v29
  v_and_b32 v187, 0xffff0000, v29
  v_pk_add_f32 v[50:51], v[50:51], v[18:19] op_sel_hi:[1,0]
  s_nop 0
  v_pk_add_f32 v[50:51], v[50:51], v[186:187]
  s_mov_b32 s51, 0x100000
  s_waitcnt vmcnt(0)
  buffer_load_dwordx4 v[144:147], v16, s[12:15], s53 offen offset:0 sc1
  buffer_load_dwordx4 v[148:151], v16, s[12:15], s53 offen offset:1024 sc1
  buffer_load_dwordx4 v[156:159], v16, s[12:15], s54 offen offset:0 sc1
  buffer_load_dwordx4 v[160:163], v16, s[12:15], s54 offen offset:1024 sc1
  buffer_load_dwordx4 v[168:171], v16, s[12:15], s55 offen offset:0 sc1
  buffer_load_dwordx4 v[172:175], v16, s[12:15], s55 offen offset:1024 sc1
  buffer_load_dwordx4 v[152:155], v16, s[12:15], s53 offen offset:2048 sc1
  buffer_load_dwordx4 v[164:167], v16, s[12:15], s54 offen offset:2048 sc1
  buffer_load_dwordx4 v[176:179], v16, s[12:15], s55 offen offset:2048 sc1
  s_waitcnt vmcnt(0)
  v_min3_u32 v9, v147, v151, v159
  v_min3_u32 v10, v163, v171, v175
  v_min3_u32 v11, v155, v167, v179
  v_min3_u32 v9, v9, v10, v11
  v_cmp_gt_u32 vcc, s49, v9
  s_cbranch_vccz k2_ok0
k2_poll0:
  buffer_load_dwordx4 v[152:155], v16, s[12:15], s53 offen offset:2048 sc1
  buffer_load_dwordx4 v[164:167], v16, s[12:15], s54 offen offset:2048 sc1
  buffer_load_dwordx4 v[176:179], v16, s[12:15], s55 offen offset:2048 sc1
  s_sub_u32 s51, s51, 1
  s_cmp_eq_u32 s51, 0
  s_cbranch_scc1 k2_exit
  s_waitcnt vmcnt(0)
  v_min3_u32 v9, v155, v167, v179
  v_cmp_gt_u32 vcc, s49, v9
  s_cbranch_vccnz k2_poll0
  buffer_load_dwordx4 v[144:147], v16, s[12:15], s53 offen offset:0 sc1
  buffer_load_dwordx4 v[148:151], v16, s[12:15], s53 offen offset:1024 sc1
  buffer_load_dwordx4 v[156:159], v16, s[12:15], s54 offen offset:0 sc1
  buffer_load_dwordx4 v[160:163], v16, s[12:15], s54 offen offset:1024 sc1
  buffer_load_dwordx4 v[168:171], v16, s[12:15], s55 offen offset:0 sc1
  buffer_load_dwordx4 v[172:175], v16, s[12:15], s55 offen offset:1024 sc1
  s_waitcnt vmcnt(0)
  v_min3_u32 v9, v147, v151, v159
  v_min3_u32 v10, v163, v171, v175
  v_min_u32 v9, v9, v10
  v_cmp_gt_u32 vcc, s49, v9
  s_cbranch_vccnz k2_poll0
k2_ok0:
  v_lshlrev_b32 v184, 16, v144
  v_and_b32 v185, 0xffff0000, v144
  v_pk_add_f32 v[32:33], v[32:33], v[184:185]
  v_lshlrev_b32 v186, 16, v145
  v_and_b32 v187, 0xffff0000, v145
  v_pk_add_f32 v[34:35], v[34:35], v[186:187]
  v_lshlrev_b32 v188, 16, v156
  v_and_b32 v189, 0xffff0000, v156
  v_pk_add_f32 v[32:33], v[32:33], v[188:189]
  v_lshlrev_b32 v190, 16, v157
  v_and_b32 v191, 0xffff0000, v157
  v_pk_add_f32 v[34:35], v[34:35], v[190:191]
  v_lshlrev_b32 v184, 16, v168
  v_and_b32 v185, 0xffff0000, v168
  v_pk_add_f32 v[32:33], v[32:33], v[184:185]
  v_lshlrev_b32 v186, 16, v169
  v_and_b32 v187, 0xffff0000, v169
  v_pk_add_f32 v[34:35], v[34:35], v[186:187]
  v_cvt_pk_bf16_f32 v32, v32, v33
  v_cvt_pk_bf16_f32 v33, v34, v35
  buffer_store_dwordx2 v[32:33], v15, s[24:27], s43 offen offset:0
  v_lshlrev_b32 v184, 16, v146
  v_and_b32 v185, 0xffff0000, v146
  v_pk_add_f32 v[36:37], v[36:37], v[184:185]
  v_lshlrev_b32 v186, 16, v147
  v_lshlrev_b32 v187, 16, v148
  v_pk_add_f32 v[38:39], v[38:39], v[186:187]
  v_lshlrev_b32 v188, 16, v158
  v_and_b32 v189, 0xffff0000, v158
  v_pk_add_f32 v[36:37], v[36:37], v[188:189]
  v_lshlrev_b32 v190, 16, v159
  v_lshlrev_b32 v191, 16, v160
  v_pk_add_f32 v[38:39], v[38:39], v[190:191]
  v_lshlrev_b32 v184, 16, v170
  v_and_b32 v185, 0xffff0000, v170
  v_pk_add_f32 v[36:37], v[36:37], v[184:185]
  v_lshlrev_b32 v186, 16, v171
  v_lshlrev_b32 v187, 16, v172
  v_pk_add_f32 v[38:39], v[38:39], v[186:187]
  v_cvt_pk_bf16_f32 v36, v36, v37
  v_cvt_pk_bf16_f32 v37, v38, v39
  buffer_store_dwordx2 v[36:37], v15, s[24:27], s43 offen offset:32
  v_and_b32 v184, 0xffff0000, v148
  v_lshlrev_b32 v185, 16, v149
  v_pk_add_f32 v[40:41], v[40:41], v[184:185]
  v_and_b32 v186, 0xffff0000, v149
  v_lshlrev_b32 v187, 16, v150
  v_pk_add_f32 v[42:43], v[42:43], v[186:187]
  v_and_b32 v188, 0xffff0000, v160
  v_lshlrev_b32 v189, 16, v161
  v_pk_add_f32 v[40:41], v[40:41], v[188:189]
  v_and_b32 v190, 0xffff0000, v161
  v_lshlrev_b32 v191, 16, v162
  v_pk_add_f32 v[42:43], v[42:43], v[190:191]
  v_and_b32 v184, 0xffff0000, v172
  v_lshlrev_b32 v185, 16, v173
  v_pk_add_f32 v[40:41], v[40:41], v[184:185]
  v_and_b32 v186, 0xffff0000, v173
  v_lshlrev_b32 v187, 16, v174
  v_pk_add_f32 v[42:43], v[42:43], v[186:187]
  v_cvt_pk_bf16_f32 v40, v40, v41
  v_cvt_pk_bf16_f32 v41, v42, v43
  buffer_store_dwordx2 v[40:41], v15, s[24:27], s43 offen offset:64
  v_and_b32 v184, 0xffff0000, v150
  v_lshlrev_b32 v185, 16, v151
  v_pk_add_f32 v[44:45], v[44:45], v[184:185]
  v_lshlrev_b32 v186, 16, v152
  v_and_b32 v187, 0xffff0000, v152
  v_pk_add_f32 v[46:47], v[46:47], v[186:187]
  v_and_b32 v188, 0xffff0000, v162
  v_lshlrev_b32 v189, 16, v163
  v_pk_add_f32 v[44:45], v[44:45], v[188:189]
  v_lshlrev_b32 v190, 16, v164
  v_and_b32 v191, 0xffff0000, v164
  v_pk_add_f32 v[46:47], v[46:47], v[190:191]
  v_and_b32 v184, 0xffff0000, v174
  v_lshlrev_b32 v185, 16, v175
  v_pk_add_f32 v[44:45], v[44:45], v[184:185]
  v_lshlrev_b32 v186, 16, v176
  v_and_b32 v187, 0xffff0000, v176
  v_pk_add_f32 v[46:47], v[46:47], v[186:187]
  v_cvt_pk_bf16_f32 v44, v44, v45
  v_cvt_pk_bf16_f32 v45, v46, v47
  buffer_store_dwordx2 v[44:45], v15, s[24:27], s43 offen offset:96
  v_lshlrev_b32 v184, 16, v153
  v_and_b32 v185, 0xffff0000, v153
  v_pk_add_f32 v[48:49], v[48:49], v[184:185]
  v_lshlrev_b32 v186, 16, v154
  v_and_b32 v187, 0xffff0000, v154
  v_pk_add_f32 v[50:51], v[50:51], v[186:187]
  v_lshlrev_b32 v188, 16, v165
  v_and_b32 v189, 0xffff0000, v165
  v_pk_add_f32 v[48:49], v[48:49], v[188:189]
  v_lshlrev_b32 v190, 16, v166
  v_and_b32 v191, 0xffff0000, v166
  v_pk_add_f32 v[50:51], v[50:51], v[190:191]
  v_lshlrev_b32 v184, 16, v177
  v_and_b32 v185, 0xffff0000, v177
  v_pk_add_f32 v[48:49], v[48:49], v[184:185]
  v_lshlrev_b32 v186, 16, v178
  v_and_b32 v187, 0xffff0000, v178
  v_pk_add_f32 v[50:51], v[50:51], v[186:187]
  v_cvt_pk_bf16_f32 v48, v48, v49
  v_cvt_pk_bf16_f32 v49, v50, v51
  buffer_store_dwordx2 v[48:49], v15, s[24:27], s43 offen offset:128
  s_endpgm
k2_q1:
  s_add_u32 s50, s47, 92160
  v_cvt_pk_bf16_f32 v68, v68, v69
  v_cvt_pk_bf16_f32 v69, v70, v71
  v_cvt_pk_bf16_f32 v70, v72, v73
  v_cvt_pk_bf16_f32 v71, v74, v74
  v_or_b32 v71, s49, v71
  buffer_store_dwordx4 v[68:71], v16, s[12:15], s50 offen offset:0 sc1
  v_cvt_pk_bf16_f32 v72, v75, v76
  v_cvt_pk_bf16_f32 v73, v77, v78
  v_cvt_pk_bf16_f32 v74, v79, v80
  v_cvt_pk_bf16_f32 v75, v81, v81
  v_or_b32 v75, s49, v75
  buffer_store_dwordx4 v[72:75], v16, s[12:15], s50 offen offset:1024 sc1
  s_add_u32 s50, s52, 114688
  v_cvt_pk_bf16_f32 v88, v88, v89
  v_cvt_pk_bf16_f32 v89, v90, v91
  v_cvt_pk_bf16_f32 v90, v92, v93
  v_cvt_pk_bf16_f32 v91, v94, v94
  v_or_b32 v91, s49, v91
  buffer_store_dwordx4 v[88:91], v16, s[12:15], s50 offen offset:0 sc1
  v_cvt_pk_bf16_f32 v92, v95, v96
  v_cvt_pk_bf16_f32 v93, v97, v98
  v_cvt_pk_bf16_f32 v94, v99, v100
  v_cvt_pk_bf16_f32 v95, v101, v101
  v_or_b32 v95, s49, v95
  buffer_store_dwordx4 v[92:95], v16, s[12:15], s50 offen offset:1024 sc1
  s_add_u32 s50, s47, 0
  v_cvt_pk_bf16_f32 v32, v32, v33
  v_cvt_pk_bf16_f32 v33, v34, v35
  v_cvt_pk_bf16_f32 v34, v36, v37
  v_cvt_pk_bf16_f32 v35, v38, v38
  v_or_b32 v35, s49, v35
  buffer_store_dwordx4 v[32:35], v16, s[12:15], s50 offen offset:0 sc1
  v_cvt_pk_bf16_f32 v36, v39, v40
  v_cvt_pk_bf16_f32 v37, v41, v42
  v_cvt_pk_bf16_f32 v38, v43, v44
  v_cvt_pk_bf16_f32 v39, v45, v45
  v_or_b32 v39, s49, v39
  buffer_store_dwordx4 v[36:39], v16, s[12:15], s50 offen offset:1024 sc1
  s_add_u32 s50, s47, 92160
  v_cvt_pk_bf16_f32 v76, v82, v83
  v_cvt_pk_bf16_f32 v77, v84, v85
  v_cvt_pk_bf16_f32 v78, v86, v87
  v_mov_b32 v79, s49
  buffer_store_dwordx4 v[76:79], v16, s[12:15], s50 offen offset:2048 sc1
  s_add_u32 s50, s52, 114688
  v_cvt_pk_bf16_f32 v96, v102, v103
  v_mov_b32 v97, s49
  v_mov_b32 v99, s49
  buffer_store_dwordx2 v[96:97], v13, s[12:15], s50 offen offset:2048 sc1
  s_add_u32 s50, s47, 0
  v_cvt_pk_bf16_f32 v40, v46, v47
  v_cvt_pk_bf16_f32 v41, v48, v49
  v_cvt_pk_bf16_f32 v42, v50, v51
  v_mov_b32 v43, s49
  buffer_store_dwordx4 v[40:43], v16, s[12:15], s50 offen offset:2048 sc1
  s_add_u32 s53, s52, 36864
  s_add_u32 s54, s52, 47104
  s_add_u32 s55, s52, 57344
  v_lshlrev_b32 v18, 16, v18
  v_lshlrev_b32 v184, 16, v20
  v_and_b32 v185, 0xffff0000, v20
  v_pk_add_f32 v[52:53], v[52:53], v[18:19] op_sel_hi:[1,0]
  s_nop 0
  v_pk_add_f32 v[52:53], v[52:53], v[184:185]
  v_lshlrev_b32 v186, 16, v21
  v_and_b32 v187, 0xffff0000, v21
  v_pk_add_f32 v[54:55], v[54:55], v[18:19] op_sel_hi:[1,0]
  s_nop 0
  v_pk_add_f32 v[54:55], v[54:55], v[186:187]
  v_lshlrev_b32 v188, 16, v22
  v_and_b32 v189, 0xffff0000, v22
  v_pk_add_f32 v[56:57], v[56:57], v[18:19] op_sel_hi:[1,0]
  s_nop 0
  v_pk_add_f32 v[56:57], v[56:57], v[188:189]
  v_lshlrev_b32 v190, 16, v23
  v_and_b32 v191, 0xffff0000, v23
  v_pk_add_f32 v[58:59], v[58:59], v[18:19] op_sel_hi:[1,0]
  s_nop 0
  v_pk_add_f32 v[58:59], v[58:59], v[190:191]
  v_lshlrev_b32 v184, 16, v24
  v_and_b32 v185, 0xffff0000, v24
  v_pk_add_f32 v[60:61], v[60:61], v[18:19] op_sel_hi:[1,0]
  s_nop 0
  v_pk_add_f32 v[60:61], v[60:61], v[184:185]
  v_lshlrev_b32 v186, 16, v25
  v_and_b32 v187, 0xffff0000, v25
  v_pk_add_f32 v[62:63], v[62:63], v[18:19] op_sel_hi:[1,0]
  s_nop 0
  v_pk_add_f32 v[62:63], v[62:63], v[186:187]
  v_lshlrev_b32 v188, 16, v26
  v_and_b32 v189, 0xffff0000, v26
  v_pk_add_f32 v[64:65], v[64:65], v[18:19] op_sel_hi:[1,0]
  s_nop 0
  v_pk_add_f32 v[64:65], v[64:65], v[188:189]
  v_lshlrev_b32 v190, 16, v27
  v_and_b32 v191, 0xffff0000, v27
  v_pk_add_f32 v[66:67], v[66:67], v[18:19] op_sel_hi:[1,0]
  s_nop 0
  v_pk_add_f32 v[66:67], v[66:67], v[190:191]
  s_mov_b32 s51, 0x100000
  s_waitcnt vmcnt(0)
  buffer_load_dwordx4 v[144:147], v16, s[12:15], s53 offen offset:0 sc1
  buffer_load_dwordx4 v[148:151], v16, s[12:15], s53 offen offset:1024 sc1
  buffer_load_dwordx4 v[156:159], v16, s[12:15], s54 offen offset:0 sc1
  buffer_load_dwordx4 v[160:163], v16, s[12:15], s54 offen offset:1024 sc1
  buffer_load_dwordx4 v[168:171], v16, s[12:15], s55 offen offset:0 sc1
  buffer_load_dwordx4 v[172:175], v16, s[12:15], s55 offen offset:1024 sc1
  buffer_load_dwordx2 v[152:153], v13, s[12:15], s53 offen offset:2048 sc1
  buffer_load_dwordx2 v[164:165], v13, s[12:15], s54 offen offset:2048 sc1
  buffer_load_dwordx2 v[176:177], v13, s[12:15], s55 offen offset:2048 sc1
  s_waitcnt vmcnt(0)
  v_min3_u32 v9, v147, v151, v159
  v_min3_u32 v10, v163, v171, v175
  v_min3_u32 v11, v153, v165, v177
  v_min3_u32 v9, v9, v10, v11
  v_cmp_gt_u32 vcc, s49, v9
  s_cbranch_vccz k2_ok1
k2_poll1:
  buffer_load_dwordx2 v[152:153], v13, s[12:15], s53 offen offset:2048 sc1
  buffer_load_dwordx2 v[164:165], v13, s[12:15], s54 offen offset:2048 sc1
  buffer_load_dwordx2 v[176:177], v13, s[12:15], s55 offen offset:2048 sc1
  s_sub_u32 s51, s51, 1
  s_cmp_eq_u32 s51, 0
  s_cbranch_scc1 k2_exit
  s_waitcnt vmcnt(0)
  v_min3_u32 v9, v153, v165, v177
  v_cmp_gt_u32 vcc, s49, v9
  s_cbranch_vccnz k2_poll1
  buffer_load_dwordx4 v[144:147], v16, s[12:15], s53 offen offset:0 sc1
  buffer_load_dwordx4 v[148:151], v16, s[12:15], s53 offen offset:1024 sc1
  buffer_load_dwordx4 v[156:159], v16, s[12:15], s54 offen offset:0 sc1
  buffer_load_dwordx4 v[160:163], v16, s[12:15], s54 offen offset:1024 sc1
  buffer_load_dwordx4 v[168:171], v16, s[12:15], s55 offen offset:0 sc1
  buffer_load_dwordx4 v[172:175], v16, s[12:15], s55 offen offset:1024 sc1
  s_waitcnt vmcnt(0)
  v_min3_u32 v9, v147, v151, v159
  v_min3_u32 v10, v163, v171, v175
  v_min_u32 v9, v9, v10
  v_cmp_gt_u32 vcc, s49, v9
  s_cbranch_vccnz k2_poll1
k2_ok1:
  v_lshlrev_b32 v184, 16, v144
  v_and_b32 v185, 0xffff0000, v144
  v_pk_add_f32 v[52:53], v[52:53], v[184:185]
  v_lshlrev_b32 v186, 16, v145
  v_and_b32 v187, 0xffff0000, v145
  v_pk_add_f32 v[54:55], v[54:55], v[186:187]
  v_lshlrev_b32 v188, 16, v156
  v_and_b32 v189, 0xffff0000, v156
  v_pk_add_f32 v[52:53], v[52:53], v[188:189]
  v_lshlrev_b32 v190, 16, v157
  v_and_b32 v191, 0xffff0000, v157
  v_pk_add_f32 v[54:55], v[54:55], v[190:191]
  v_lshlrev_b32 v184, 16, v168
  v_and_b32 v185, 0xffff0000, v168
  v_pk_add_f32 v[52:53], v[52:53], v[184:185]
  v_lshlrev_b32 v186, 16, v169
  v_and_b32 v187, 0xffff0000, v169
  v_pk_add_f32 v[54:55], v[54:55], v[186:187]
  v_cvt_pk_bf16_f32 v52, v52, v53
  v_cvt_pk_bf16_f32 v53, v54, v55
  buffer_store_dwordx2 v[52:53], v15, s[24:27], s43 offen offset:0
  v_lshlrev_b32 v184, 16, v146
  v_and_b32 v185, 0xffff0000, v146
  v_pk_add_f32 v[56:57], v[56:57], v[184:185]
  v_lshlrev_b32 v186, 16, v147
  v_lshlrev_b32 v187, 16, v148
  v_pk_add_f32 v[58:59], v[58:59], v[186:187]
  v_lshlrev_b32 v188, 16, v158
  v_and_b32 v189, 0xffff0000, v158
  v_pk_add_f32 v[56:57], v[56:57], v[188:189]
  v_lshlrev_b32 v190, 16, v159
  v_lshlrev_b32 v191, 16, v160
  v_pk_add_f32 v[58:59], v[58:59], v[190:191]
  v_lshlrev_b32 v184, 16, v170
  v_and_b32 v185, 0xffff0000, v170
  v_pk_add_f32 v[56:57], v[56:57], v[184:185]
  v_lshlrev_b32 v186, 16, v171
  v_lshlrev_b32 v187, 16, v172
  v_pk_add_f32 v[58:59], v[58:59], v[186:187]
  v_cvt_pk_bf16_f32 v56, v56, v57
  v_cvt_pk_bf16_f32 v57, v58, v59
  buffer_store_dwordx2 v[56:57], v15, s[24:27], s43 offen offset:32
  v_and_b32 v184, 0xffff0000, v148
  v_lshlrev_b32 v185, 16, v149
  v_pk_add_f32 v[60:61], v[60:61], v[184:185]
  v_and_b32 v186, 0xffff0000, v149
  v_lshlrev_b32 v187, 16, v150
  v_pk_add_f32 v[62:63], v[62:63], v[186:187]
  v_and_b32 v188, 0xffff0000, v160
  v_lshlrev_b32 v189, 16, v161
  v_pk_add_f32 v[60:61], v[60:61], v[188:189]
  v_and_b32 v190, 0xffff0000, v161
  v_lshlrev_b32 v191, 16, v162
  v_pk_add_f32 v[62:63], v[62:63], v[190:191]
  v_and_b32 v184, 0xffff0000, v172
  v_lshlrev_b32 v185, 16, v173
  v_pk_add_f32 v[60:61], v[60:61], v[184:185]
  v_and_b32 v186, 0xffff0000, v173
  v_lshlrev_b32 v187, 16, v174
  v_pk_add_f32 v[62:63], v[62:63], v[186:187]
  v_cvt_pk_bf16_f32 v60, v60, v61
  v_cvt_pk_bf16_f32 v61, v62, v63
  buffer_store_dwordx2 v[60:61], v15, s[24:27], s43 offen offset:64
  v_and_b32 v184, 0xffff0000, v150
  v_lshlrev_b32 v185, 16, v151
  v_pk_add_f32 v[64:65], v[64:65], v[184:185]
  v_lshlrev_b32 v186, 16, v152
  v_and_b32 v187, 0xffff0000, v152
  v_pk_add_f32 v[66:67], v[66:67], v[186:187]
  v_and_b32 v188, 0xffff0000, v162
  v_lshlrev_b32 v189, 16, v163
  v_pk_add_f32 v[64:65], v[64:65], v[188:189]
  v_lshlrev_b32 v190, 16, v164
  v_and_b32 v191, 0xffff0000, v164
  v_pk_add_f32 v[66:67], v[66:67], v[190:191]
  v_and_b32 v184, 0xffff0000, v174
  v_lshlrev_b32 v185, 16, v175
  v_pk_add_f32 v[64:65], v[64:65], v[184:185]
  v_lshlrev_b32 v186, 16, v176
  v_and_b32 v187, 0xffff0000, v176
  v_pk_add_f32 v[66:67], v[66:67], v[186:187]
  v_cvt_pk_bf16_f32 v64, v64, v65
  v_cvt_pk_bf16_f32 v65, v66, v67
  buffer_store_dwordx2 v[64:65], v15, s[24:27], s43 offen offset:96
  s_endpgm
k2_q2:
  s_add_u32 s50, s52, 124928
  v_cvt_pk_bf16_f32 v88, v88, v89
  v_cvt_pk_bf16_f32 v89, v90, v91
  v_cvt_pk_bf16_f32 v90, v92, v93
  v_cvt_pk_bf16_f32 v91, v94, v94
  v_or_b32 v91, s49, v91
  buffer_store_dwordx4 v[88:91], v16, s[12:15], s50 offen offset:0 sc1
  v_cvt_pk_bf16_f32 v92, v95, v96
  v_cvt_pk_bf16_f32 v93, v97, v98
  v_cvt_pk_bf16_f32 v94, v99, v100
  v_cvt_pk_bf16_f32 v95, v101, v101
  v_or_b32 v95, s49, v95
  buffer_store_dwordx4 v[92:95], v16, s[12:15], s50 offen offset:1024 sc1
  s_add_u32 s50, s47, 12288
  v_cvt_pk_bf16_f32 v32, v32, v33
  v_cvt_pk_bf16_f32 v33, v34, v35
  v_cvt_pk_bf16_f32 v34, v36, v37
  v_cvt_pk_bf16_f32 v35, v38, v38
  v_or_b32 v35, s49, v35
  buffer_store_dwordx4 v[32:35], v16, s[12:15], s50 offen offset:0 sc1
  v_cvt_pk_bf16_f32 v36, v39, v40
  v_cvt_pk_bf16_f32 v37, v41, v42
  v_cvt_pk_bf16_f32 v38, v43, v44
  v_cvt_pk_bf16_f32 v39, v45, v45
  v_or_b32 v39, s49, v39
  buffer_store_dwordx4 v[36:39], v16, s[12:15], s50 offen offset:1024 sc1
  s_add_u32 s50, s52, 36864
  v_cvt_pk_bf16_f32 v52, v52, v53
  v_cvt_pk_bf16_f32 v53, v54, v55
  v_cvt_pk_bf16_f32 v54, v56, v57
  v_cvt_pk_bf16_f32 v55, v58, v58
  v_or_b32 v55, s49, v55
  buffer_store_dwordx4 v[52:55], v16, s[12:15], s50 offen offset:0 sc1
  v_cvt_pk_bf16_f32 v56, v59, v60
  v_cvt_pk_bf16_f32 v57, v61, v62
  v_cvt_pk_bf16_f32 v58, v63, v64
  v_cvt_pk_bf16_f32 v59, v65, v65
  v_or_b32 v59, s49, v59
  buffer_store_dwordx4 v[56:59], v16, s[12:15], s50 offen offset:1024 sc1
  s_add_u32 s50, s52, 124928
  v_cvt_pk_bf16_f32 v96, v102, v103
  v_mov_b32 v97, s49
  v_mov_b32 v99, s49
  buffer_store_dwordx2 v[96:97], v13, s[12:15], s50 offen offset:2048 sc1
  s_add_u32 s50, s47, 12288
  v_cvt_pk_bf16_f32 v40, v46, v47
  v_cvt_pk_bf16_f32 v41, v48, v49
  v_cvt_pk_bf16_f32 v42, v50, v51
  v_mov_b32 v43, s49
  buffer_store_dwordx4 v[40:43], v16, s[12:15], s50 offen offset:2048 sc1
  s_add_u32 s50, s52, 36864
  v_cvt_pk_bf16_f32 v60, v66, v67
  v_mov_b32 v61, s49
  v_mov_b32 v63, s49
  buffer_store_dwordx2 v[60:61], v13, s[12:15], s50 offen offset:2048 sc1
  s_add_u32 s53, s47, 67584
  s_add_u32 s54, s47, 79872
  s_add_u32 s55, s47, 92160
  v_lshlrev_b32 v18, 16, v18
  v_lshlrev_b32 v184, 16, v20
  v_and_b32 v185, 0xffff0000, v20
  v_pk_add_f32 v[68:69], v[68:69], v[18:19] op_sel_hi:[1,0]
  s_nop 0
  v_pk_add_f32 v[68:69], v[68:69], v[184:185]
  v_lshlrev_b32 v186, 16, v21
  v_and_b32 v187, 0xffff0000, v21
  v_pk_add_f32 v[70:71], v[70:71], v[18:19] op_sel_hi:[1,0]
  s_nop 0
  v_pk_add_f32 v[70:71], v[70:71], v[186:187]
  v_lshlrev_b32 v188, 16, v22
  v_and_b32 v189, 0xffff0000, v22
  v_pk_add_f32 v[72:73], v[72:73], v[18:19] op_sel_hi:[1,0]
  s_nop 0
  v_pk_add_f32 v[72:73], v[72:73], v[188:189]
  v_lshlrev_b32 v190, 16, v23
  v_and_b32 v191, 0xffff0000, v23
  v_pk_add_f32 v[74:75], v[74:75], v[18:19] op_sel_hi:[1,0]
  s_nop 0
  v_pk_add_f32 v[74:75], v[74:75], v[190:191]
  v_lshlrev_b32 v184, 16, v24
  v_and_b32 v185, 0xffff0000, v24
  v_pk_add_f32 v[76:77], v[76:77], v[18:19] op_sel_hi:[1,0]
  s_nop 0
  v_pk_add_f32 v[76:77], v[76:77], v[184:185]
  v_lshlrev_b32 v186, 16, v25
  v_and_b32 v187, 0xffff0000, v25
  v_pk_add_f32 v[78:79], v[78:79], v[18:19] op_sel_hi:[1,0]
  s_nop 0
  v_pk_add_f32 v[78:79], v[78:79], v[186:187]
  v_lshlrev_b32 v188, 16, v26
  v_and_b32 v189, 0xffff0000, v26
  v_pk_add_f32 v[80:81], v[80:81], v[18:19] op_sel_hi:[1,0]
  s_nop 0
  v_pk_add_f32 v[80:81], v[80:81], v[188:189]
  v_lshlrev_b32 v190, 16, v27
  v_and_b32 v191, 0xffff0000, v27
  v_pk_add_f32 v[82:83], v[82:83], v[18:19] op_sel_hi:[1,0]
  s_nop 0
  v_pk_add_f32 v[82:83], v[82:83], v[190:191]
  v_lshlrev_b32 v184, 16, v28
  v_and_b32 v185, 0xffff0000, v28
  v_pk_add_f32 v[84:85], v[84:85], v[18:19] op_sel_hi:[1,0]
  s_nop 0
  v_pk_add_f32 v[84:85], v[84:85], v[184:185]
  v_lshlrev_b32 v186, 16, v29
  v_and_b32 v187, 0xffff0000, v29
  v_pk_add_f32 v[86:87], v[86:87], v[18:19] op_sel_hi:[1,0]
  s_nop 0
  v_pk_add_f32 v[86:87], v[86:87], v[186:187]
  s_mov_b32 s51, 0x100000
  s_waitcnt vmcnt(0)
  buffer_load_dwordx4 v[144:147], v16, s[12:15], s53 offen offset:0 sc1
  buffer_load_dwordx4 v[148:151], v16, s[12:15], s53 offen offset:1024 sc1
  buffer_load_dwordx4 v[156:159], v16, s[12:15], s54 offen offset:0 sc1
  buffer_load_dwordx4 v[160:163], v16, s[12:15], s54 offen offset:1024 sc1
  buffer_load_dwordx4 v[168:171], v16, s[12:15], s55 offen offset:0 sc1
  buffer_load_dwordx4 v[172:175], v16, s[12:15], s55 offen offset:1024 sc1
  buffer_load_dwordx4 v[152:155], v16, s[12:15], s53 offen offset:2048 sc1
  buffer_load_dwordx4 v[164:167], v16, s[12:15], s54 offen offset:2048 sc1
  buffer_load_dwordx4 v[176:179], v16, s[12:15], s55 offen offset:2048 sc1
  s_waitcnt vmcnt(0)
  v_min3_u32 v9, v147, v151, v159
  v_min3_u32 v10, v163, v171, v175
  v_min3_u32 v11, v155, v167, v179
  v_min3_u32 v9, v9, v10, v11
  v_cmp_gt_u32 vcc, s49, v9
  s_cbranch_vccz k2_ok2
k2_poll2:
  buffer_load_dwordx4 v[152:155], v16, s[12:15], s53 offen offset:2048 sc1
  buffer_load_dwordx4 v[164:167], v16, s[12:15], s54 offen offset:2048 sc1
  buffer_load_dwordx4 v[176:179], v16, s[12:15], s55 offen offset:2048 sc1
  s_sub_u32 s51, s51, 1
  s_cmp_eq_u32 s51, 0
  s_cbranch_scc1 k2_exit
  s_waitcnt vmcnt(0)
  v_min3_u32 v9, v155, v167, v179
  v_cmp_gt_u32 vcc, s49, v9
  s_cbranch_vccnz k2_poll2
  buffer_load_dwordx4 v[144:147], v16, s[12:15], s53 offen offset:0 sc1
  buffer_load_dwordx4 v[148:151], v16, s[12:15], s53 offen offset:1024 sc1
  buffer_load_dwordx4 v[156:159], v16, s[12:15], s54 offen offset:0 sc1
  buffer_load_dwordx4 v[160:163], v16, s[12:15], s54 offen offset:1024 sc1
  buffer_load_dwordx4 v[168:171], v16, s[12:15], s55 offen offset:0 sc1
  buffer_load_dwordx4 v[172:175], v16, s[12:15], s55 offen offset:1024 sc1
  s_waitcnt vmcnt(0)
  v_min3_u32 v9, v147, v151, v159
  v_min3_u32 v10, v163, v171, v175
  v_min_u32 v9, v9, v10
  v_cmp_gt_u32 vcc, s49, v9
  s_cbranch_vccnz k2_poll2
k2_ok2:
  v_lshlrev_b32 v184, 16, v144
  v_and_b32 v185, 0xffff0000, v144
  v_pk_add_f32 v[68:69], v[68:69], v[184:185]
  v_lshlrev_b32 v186, 16, v145
  v_and_b32 v187, 0xffff0000, v145
  v_pk_add_f32 v[70:71], v[70:71], v[186:187]
  v_lshlrev_b32 v188, 16, v156
  v_and_b32 v189, 0xffff0000, v156
  v_pk_add_f32 v[68:69], v[68:69], v[188:189]
  v_lshlrev_b32 v190, 16, v157
  v_and_b32 v191, 0xffff0000, v157
  v_pk_add_f32 v[70:71], v[70:71], v[190:191]
  v_lshlrev_b32 v184, 16, v168
  v_and_b32 v185, 0xffff0000, v168
  v_pk_add_f32 v[68:69], v[68:69], v[184:185]
  v_lshlrev_b32 v186, 16, v169
  v_and_b32 v187, 0xffff0000, v169
  v_pk_add_f32 v[70:71], v[70:71], v[186:187]
  v_cvt_pk_bf16_f32 v68, v68, v69
  v_cvt_pk_bf16_f32 v69, v70, v71
  buffer_store_dwordx2 v[68:69], v15, s[24:27], s43 offen offset:0
  v_lshlrev_b32 v184, 16, v146
  v_and_b32 v185, 0xffff0000, v146
  v_pk_add_f32 v[72:73], v[72:73], v[184:185]
  v_lshlrev_b32 v186, 16, v147
  v_lshlrev_b32 v187, 16, v148
  v_pk_add_f32 v[74:75], v[74:75], v[186:187]
  v_lshlrev_b32 v188, 16, v158
  v_and_b32 v189, 0xffff0000, v158
  v_pk_add_f32 v[72:73], v[72:73], v[188:189]
  v_lshlrev_b32 v190, 16, v159
  v_lshlrev_b32 v191, 16, v160
  v_pk_add_f32 v[74:75], v[74:75], v[190:191]
  v_lshlrev_b32 v184, 16, v170
  v_and_b32 v185, 0xffff0000, v170
  v_pk_add_f32 v[72:73], v[72:73], v[184:185]
  v_lshlrev_b32 v186, 16, v171
  v_lshlrev_b32 v187, 16, v172
  v_pk_add_f32 v[74:75], v[74:75], v[186:187]
  v_cvt_pk_bf16_f32 v72, v72, v73
  v_cvt_pk_bf16_f32 v73, v74, v75
  buffer_store_dwordx2 v[72:73], v15, s[24:27], s43 offen offset:32
  v_and_b32 v184, 0xffff0000, v148
  v_lshlrev_b32 v185, 16, v149
  v_pk_add_f32 v[76:77], v[76:77], v[184:185]
  v_and_b32 v186, 0xffff0000, v149
  v_lshlrev_b32 v187, 16, v150
  v_pk_add_f32 v[78:79], v[78:79], v[186:187]
  v_and_b32 v188, 0xffff0000, v160
  v_lshlrev_b32 v189, 16, v161
  v_pk_add_f32 v[76:77], v[76:77], v[188:189]
  v_and_b32 v190, 0xffff0000, v161
  v_lshlrev_b32 v191, 16, v162
  v_pk_add_f32 v[78:79], v[78:79], v[190:191]
  v_and_b32 v184, 0xffff0000, v172
  v_lshlrev_b32 v185, 16, v173
  v_pk_add_f32 v[76:77], v[76:77], v[184:185]
  v_and_b32 v186, 0xffff0000, v173
  v_lshlrev_b32 v187, 16, v174
  v_pk_add_f32 v[78:79], v[78:79], v[186:187]
  v_cvt_pk_bf16_f32 v76, v76, v77
  v_cvt_pk_bf16_f32 v77, v78, v79
  buffer_store_dwordx2 v[76:77], v15, s[24:27], s43 offen offset:64
  v_and_b32 v184, 0xffff0000, v150
  v_lshlrev_b32 v185, 16, v151
  v_pk_add_f32 v[80:81], v[80:81], v[184:185]
  v_lshlrev_b32 v186, 16, v152
  v_and_b32 v187, 0xffff0000, v152
  v_pk_add_f32 v[82:83], v[82:83], v[186:187]
  v_and_b32 v188, 0xffff0000, v162
  v_lshlrev_b32 v189, 16, v163
  v_pk_add_f32 v[80:81], v[80:81], v[188:189]
  v_lshlrev_b32 v190, 16, v164
  v_and_b32 v191, 0xffff0000, v164
  v_pk_add_f32 v[82:83], v[82:83], v[190:191]
  v_and_b32 v184, 0xffff0000, v174
  v_lshlrev_b32 v185, 16, v175
  v_pk_add_f32 v[80:81], v[80:81], v[184:185]
  v_lshlrev_b32 v186, 16, v176
  v_and_b32 v187, 0xffff0000, v176
  v_pk_add_f32 v[82:83], v[82:83], v[186:187]
  v_cvt_pk_bf16_f32 v80, v80, v81
  v_cvt_pk_bf16_f32 v81, v82, v83
  buffer_store_dwordx2 v[80:81], v15, s[24:27], s43 offen offset:96
  v_lshlrev_b32 v184, 16, v153
  v_and_b32 v185, 0xffff0000, v153
  v_pk_add_f32 v[84:85], v[84:85], v[184:185]
  v_lshlrev_b32 v186, 16, v154
  v_and_b32 v187, 0xffff0000, v154
  v_pk_add_f32 v[86:87], v[86:87], v[186:187]
  v_lshlrev_b32 v188, 16, v165
  v_and_b32 v189, 0xffff0000, v165
  v_pk_add_f32 v[84:85], v[84:85], v[188:189]
  v_lshlrev_b32 v190, 16, v166
  v_and_b32 v191, 0xffff0000, v166
  v_pk_add_f32 v[86:87], v[86:87], v[190:191]
  v_lshlrev_b32 v184, 16, v177
  v_and_b32 v185, 0xffff0000, v177
  v_pk_add_f32 v[84:85], v[84:85], v[184:185]
  v_lshlrev_b32 v186, 16, v178
  v_and_b32 v187, 0xffff0000, v178
  v_pk_add_f32 v[86:87], v[86:87], v[186:187]
  v_cvt_pk_bf16_f32 v84, v84, v85
  v_cvt_pk_bf16_f32 v85, v86, v87
  buffer_store_dwordx2 v[84:85], v15, s[24:27], s43 offen offset:128
  s_endpgm
k2_q3:
  s_add_u32 s50, s47, 24576
  v_cvt_pk_bf16_f32 v32, v32, v33
  v_cvt_pk_bf16_f32 v33, v34, v35
  v_cvt_pk_bf16_f32 v34, v36, v37
  v_cvt_pk_bf16_f32 v35, v38, v38
  v_or_b32 v35, s49, v35
  buffer_store_dwordx4 v[32:35], v16, s[12:15], s50 offen offset:0 sc1
  v_cvt_pk_bf16_f32 v36, v39, v40
  v_cvt_pk_bf16_f32 v37, v41, v42
  v_cvt_pk_bf16_f32 v38, v43, v44
  v_cvt_pk_bf16_f32 v39, v45, v45
  v_or_b32 v39, s49, v39
  buffer_store_dwordx4 v[36:39], v16, s[12:15], s50 offen offset:1024 sc1
  s_add_u32 s50, s52, 47104
  v_cvt_pk_bf16_f32 v52, v52, v53
  v_cvt_pk_bf16_f32 v53, v54, v55
  v_cvt_pk_bf16_f32 v54, v56, v57
  v_cvt_pk_bf16_f32 v55, v58, v58
  v_or_b32 v55, s49, v55
  buffer_store_dwordx4 v[52:55], v16, s[12:15], s50 offen offset:0 sc1
  v_cvt_pk_bf16_f32 v56, v59, v60
  v_cvt_pk_bf16_f32 v57, v61, v62
  v_cvt_pk_bf16_f32 v58, v63, v64
  v_cvt_pk_bf16_f32 v59, v65, v65
  v_or_b32 v59, s49, v59
  buffer_store_dwordx4 v[56:59], v16, s[12:15], s50 offen offset:1024 sc1
  s_add_u32 s50, s47, 67584
  v_cvt_pk_bf16_f32 v68, v68, v69
  v_cvt_pk_bf16_f32 v69, v70, v71
  v_cvt_pk_bf16_f32 v70, v72, v73
  v_cvt_pk_bf16_f32 v71, v74, v74
  v_or_b32 v71, s49, v71
  buffer_store_dwordx4 v[68:71], v16, s[12:15], s50 offen offset:0 sc1
  v_cvt_pk_bf16_f32 v72, v75, v76
  v_cvt_pk_bf16_f32 v73, v77, v78
  v_cvt_pk_bf16_f32 v74, v79, v80
  v_cvt_pk_bf16_f32 v75, v81, v81
  v_or_b32 v75, s49, v75
  buffer_store_dwordx4 v[72:75], v16, s[12:15], s50 offen offset:1024 sc1
  s_add_u32 s50, s47, 24576
  v_cvt_pk_bf16_f32 v40, v46, v47
  v_cvt_pk_bf16_f32 v41, v48, v49
  v_cvt_pk_bf16_f32 v42, v50, v51
  v_mov_b32 v43, s49
  buffer_store_dwordx4 v[40:43], v16, s[12:15], s50 offen offset:2048 sc1
  s_add_u32 s50, s52, 47104
  v_cvt_pk_bf16_f32 v60, v66, v67
  v_mov_b32 v61, s49
  v_mov_b32 v63, s49
  buffer_store_dwordx2 v[60:61], v13, s[12:15], s50 offen offset:2048 sc1
  s_add_u32 s50, s47, 67584
  v_cvt_pk_bf16_f32 v76, v82, v83
  v_cvt_pk_bf16_f32 v77, v84, v85
  v_cvt_pk_bf16_f32 v78, v86, v87
  v_mov_b32 v79, s49
  buffer_store_dwordx4 v[76:79], v16, s[12:15], s50 offen offset:2048 sc1
  s_add_u32 s53, s52, 104448
  s_add_u32 s54, s52, 114688
  s_add_u32 s55, s52, 124928
  v_lshlrev_b32 v18, 16, v18
  v_lshlrev_b32 v184, 16, v20
  v_and_b32 v185, 0xffff0000, v20
  v_pk_add_f32 v[88:89], v[88:89], v[18:19] op_sel_hi:[1,0]
  s_nop 0
  v_pk_add_f32 v[88:89], v[88:89], v[184:185]
  v_lshlrev_b32 v186, 16, v21
  v_and_b32 v187, 0xffff0000, v21
  v_pk_add_f32 v[90:91], v[90:91], v[18:19] op_sel_hi:[1,0]
  s_nop 0
  v_pk_add_f32 v[90:91], v[90:91], v[186:187]
  v_lshlrev_b32 v188, 16, v22
  v_and_b32 v189, 0xffff0000, v22
  v_pk_add_f32 v[92:93], v[92:93], v[18:19] op_sel_hi:[1,0]
  s_nop 0
  v_pk_add_f32 v[92:93], v[92:93], v[188:189]
  v_lshlrev_b32 v190, 16, v23
  v_and_b32 v191, 0xffff0000, v23
  v_pk_add_f32 v[94:95], v[94:95], v[18:19] op_sel_hi:[1,0]
  s_nop 0
  v_pk_add_f32 v[94:95], v[94:95], v[190:191]
  v_lshlrev_b32 v184, 16, v24
  v_and_b32 v185, 0xffff0000, v24
  v_pk_add_f32 v[96:97], v[96:97], v[18:19] op_sel_hi:[1,0]
  s_nop 0
  v_pk_add_f32 v[96:97], v[96:97], v[184:185]
  v_lshlrev_b32 v186, 16, v25
  v_and_b32 v187, 0xffff0000, v25
  v_pk_add_f32 v[98:99], v[98:99], v[18:19] op_sel_hi:[1,0]
  s_nop 0
  v_pk_add_f32 v[98:99], v[98:99], v[186:187]
  v_lshlrev_b32 v188, 16, v26
  v_and_b32 v189, 0xffff0000, v26
  v_pk_add_f32 v[100:101], v[100:101], v[18:19] op_sel_hi:[1,0]
  s_nop 0
  v_pk_add_f32 v[100:101], v[100:101], v[188:189]
  v_lshlrev_b32 v190, 16, v27
  v_and_b32 v191, 0xffff0000, v27
  v_pk_add_f32 v[102:103], v[102:103], v[18:19] op_sel_hi:[1,0]
  s_nop 0
  v_pk_add_f32 v[102:103], v[102:103], v[190:191]
  s_mov_b32 s51, 0x100000
  s_waitcnt vmcnt(0)
  buffer_load_dwordx4 v[144:147], v16, s[12:15], s53 offen offset:0 sc1
  buffer_load_dwordx4 v[148:151], v16, s[12:15], s53 offen offset:1024 sc1
  buffer_load_dwordx4 v[156:159], v16, s[12:15], s54 offen offset:0 sc1
  buffer_load_dwordx4 v[160:163], v16, s[12:15], s54 offen offset:1024 sc1
  buffer_load_dwordx4 v[168:171], v16, s[12:15], s55 offen offset:0 sc1
  buffer_load_dwordx4 v[172:175], v16, s[12:15], s55 offen offset:1024 sc1
  buffer_load_dwordx2 v[152:153], v13, s[12:15], s53 offen offset:2048 sc1
  buffer_load_dwordx2 v[164:165], v13, s[12:15], s54 offen offset:2048 sc1
  buffer_load_dwordx2 v[176:177], v13, s[12:15], s55 offen offset:2048 sc1
  s_waitcnt vmcnt(0)
  v_min3_u32 v9, v147, v151, v159
  v_min3_u32 v10, v163, v171, v175
  v_min3_u32 v11, v153, v165, v177
  v_min3_u32 v9, v9, v10, v11
  v_cmp_gt_u32 vcc, s49, v9
  s_cbranch_vccz k2_ok3
k2_poll3:
  buffer_load_dwordx2 v[152:153], v13, s[12:15], s53 offen offset:2048 sc1
  buffer_load_dwordx2 v[164:165], v13, s[12:15], s54 offen offset:2048 sc1
  buffer_load_dwordx2 v[176:177], v13, s[12:15], s55 offen offset:2048 sc1
  s_sub_u32 s51, s51, 1
  s_cmp_eq_u32 s51, 0
  s_cbranch_scc1 k2_exit
  s_waitcnt vmcnt(0)
  v_min3_u32 v9, v153, v165, v177
  v_cmp_gt_u32 vcc, s49, v9
  s_cbranch_vccnz k2_poll3
  buffer_load_dwordx4 v[144:147], v16, s[12:15], s53 offen offset:0 sc1
  buffer_load_dwordx4 v[148:151], v16, s[12:15], s53 offen offset:1024 sc1
  buffer_load_dwordx4 v[156:159], v16, s[12:15], s54 offen offset:0 sc1
  buffer_load_dwordx4 v[160:163], v16, s[12:15], s54 offen offset:1024 sc1
  buffer_load_dwordx4 v[168:171], v16, s[12:15], s55 offen offset:0 sc1
  buffer_load_dwordx4 v[172:175], v16, s[12:15], s55 offen offset:1024 sc1
  s_waitcnt vmcnt(0)
  v_min3_u32 v9, v147, v151, v159
  v_min3_u32 v10, v163, v171, v175
  v_min_u32 v9, v9, v10
  v_cmp_gt_u32 vcc, s49, v9
  s_cbranch_vccnz k2_poll3
k2_ok3:
  v_lshlrev_b32 v184, 16, v144
  v_and_b32 v185, 0xffff0000, v144
  v_pk_add_f32 v[88:89], v[88:89], v[184:185]
  v_lshlrev_b32 v186, 16, v145
  v_and_b32 v187, 0xffff0000, v145
  v_pk_add_f32 v[90:91], v[90:91], v[186:187]
  v_lshlrev_b32 v188, 16, v156
  v_and_b32 v189, 0xffff0000, v156
  v_pk_add_f32 v[88:89], v[88:89], v[188:189]
  v_lshlrev_b32 v190, 16, v157
  v_and_b32 v191, 0xffff0000, v157
  v_pk_add_f32 v[90:91], v[90:91], v[190:191]
  v_lshlrev_b32 v184, 16, v168
  v_and_b32 v185, 0xffff0000, v168
  v_pk_add_f32 v[88:89], v[88:89], v[184:185]
  v_lshlrev_b32 v186, 16, v169
  v_and_b32 v187, 0xffff0000, v169
  v_pk_add_f32 v[90:91], v[90:91], v[186:187]
  v_cvt_pk_bf16_f32 v88, v88, v89
  v_cvt_pk_bf16_f32 v89, v90, v91
  buffer_store_dwordx2 v[88:89], v15, s[24:27], s43 offen offset:0
  v_lshlrev_b32 v184, 16, v146
  v_and_b32 v185, 0xffff0000, v146
  v_pk_add_f32 v[92:93], v[92:93], v[184:185]
  v_lshlrev_b32 v186, 16, v147
  v_lshlrev_b32 v187, 16, v148
  v_pk_add_f32 v[94:95], v[94:95], v[186:187]
  v_lshlrev_b32 v188, 16, v158
  v_and_b32 v189, 0xffff0000, v158
  v_pk_add_f32 v[92:93], v[92:93], v[188:189]
  v_lshlrev_b32 v190, 16, v159
  v_lshlrev_b32 v191, 16, v160
  v_pk_add_f32 v[94:95], v[94:95], v[190:191]
  v_lshlrev_b32 v184, 16, v170
  v_and_b32 v185, 0xffff0000, v170
  v_pk_add_f32 v[92:93], v[92:93], v[184:185]
  v_lshlrev_b32 v186, 16, v171
  v_lshlrev_b32 v187, 16, v172
  v_pk_add_f32 v[94:95], v[94:95], v[186:187]
  v_cvt_pk_bf16_f32 v92, v92, v93
  v_cvt_pk_bf16_f32 v93, v94, v95
  buffer_store_dwordx2 v[92:93], v15, s[24:27], s43 offen offset:32
  v_and_b32 v184, 0xffff0000, v148
  v_lshlrev_b32 v185, 16, v149
  v_pk_add_f32 v[96:97], v[96:97], v[184:185]
  v_and_b32 v186, 0xffff0000, v149
  v_lshlrev_b32 v187, 16, v150
  v_pk_add_f32 v[98:99], v[98:99], v[186:187]
  v_and_b32 v188, 0xffff0000, v160
  v_lshlrev_b32 v189, 16, v161
  v_pk_add_f32 v[96:97], v[96:97], v[188:189]
  v_and_b32 v190, 0xffff0000, v161
  v_lshlrev_b32 v191, 16, v162
  v_pk_add_f32 v[98:99], v[98:99], v[190:191]
  v_and_b32 v184, 0xffff0000, v172
  v_lshlrev_b32 v185, 16, v173
  v_pk_add_f32 v[96:97], v[96:97], v[184:185]
  v_and_b32 v186, 0xffff0000, v173
  v_lshlrev_b32 v187, 16, v174
  v_pk_add_f32 v[98:99], v[98:99], v[186:187]
  v_cvt_pk_bf16_f32 v96, v96, v97
  v_cvt_pk_bf16_f32 v97, v98, v99
  buffer_store_dwordx2 v[96:97], v15, s[24:27], s43 offen offset:64
  v_and_b32 v184, 0xffff0000, v150
  v_lshlrev_b32 v185, 16, v151
  v_pk_add_f32 v[100:101], v[100:101], v[184:185]
  v_lshlrev_b32 v186, 16, v152
  v_and_b32 v187, 0xffff0000, v152
  v_pk_add_f32 v[102:103], v[102:103], v[186:187]
  v_and_b32 v188, 0xffff0000, v162
  v_lshlrev_b32 v189, 16, v163
  v_pk_add_f32 v[100:101], v[100:101], v[188:189]
  v_lshlrev_b32 v190, 16, v164
  v_and_b32 v191, 0xffff0000, v164
  v_pk_add_f32 v[102:103], v[102:103], v[190:191]
  v_and_b32 v184, 0xffff0000, v174
  v_lshlrev_b32 v185, 16, v175
  v_pk_add_f32 v[100:101], v[100:101], v[184:185]
  v_lshlrev_b32 v186, 16, v176
  v_and_b32 v187, 0xffff0000, v176
  v_pk_add_f32 v[102:103], v[102:103], v[186:187]
  v_cvt_pk_bf16_f32 v100, v100, v101
  v_cvt_pk_bf16_f32 v101, v102, v103
  buffer_store_dwordx2 v[100:101], v15, s[24:27], s43 offen offset:96
  s_endpgm
k2_loader:
  s_setprio 3
  v_lshrrev_b32 v1, 4, v0
  s_cmp_ge_u32 s3, 6
  s_cbranch_scc1 k2_ldg
  v_bfe_u32 v2, v0, 1, 3
  v_xor_b32 v2, v2, v1
  v_and_b32 v3, 1, v0
  v_lshlrev_b32 v3, 4, v3
  v_lshl_add_u32 v3, v1, 12, v3
  v_lshl_add_u32 v5, v2, 5, v3
  v_xor_b32 v2, 4, v2
  v_lshl_add_u32 v6, v2, 5, v3
  v_add_u32 v8, 0, v5
  v_add_u32 v9, 15360, v5
  v_add_u32 v10, 30720, v6
  v_add_u32 v11, 46080, v6
  v_add_u32 v12, 65536, v5
  v_add_u32 v13, 80896, v5
  v_add_u32 v14, 96256, v6
  v_add_u32 v15, 111616, v6
  s_sub_u32 s41, s3, 4
  s_lshl_b32 s42, s41, 17
  s_lshl_b32 s43, s7, 8
  s_add_u32 s42, s42, s43
  s_lshl_b32 s43, s39, 18
  s_add_u32 s46, s42, s43
  s_add_u32 s42, s42, 8519680
  s_lshl_b32 s47, s41, 13
  s_lshl_b32 s43, s5, 4
  s_mul_i32 s50, s41, 24
  s_sub_u32 s43, s43, s50
  s_add_u32 s43, s43, 0
  s_lshl_b32 s43, s43, 12
  v_lshrrev_b32 v2, 1, v0
  v_lshlrev_b32 v2, 12, v2
  v_and_b32 v3, 1, v0
  v_lshl_add_u32 v2, v3, 7, v2
  v_add_u32 v2, s43, v2
  v_mov_b32 v7, 0x40000000
  v_cmp_gt_u32 vcc, 16, v0
  s_nop 1
  v_cndmask_b32 v7, v7, v2, vcc
  s_add_u32 s48, s47, 104448
  s_mov_b32 s44, s47
  s_mov_b32 s49, s39
  s_cmp_lg_u32 s49, 72
  s_cbranch_scc1 k2sw_29
  s_mov_b32 s8, s30
  s_and_b32 s9, s31, 0xffff
  s_mov_b32 s10, 37355520
  s_mov_b32 s11, 0x20000
  s_mov_b32 s46, s42
k2sw_29:
  s_add_u32 s49, s49, 1
  s_add_u32 m0, s44, 0
  s_nop 0
  buffer_load_dwordx4 v8, s[8:11], s46 offen offset:0 lds
  buffer_load_dwordx4 v9, s[8:11], s46 offen offset:1024 lds
  buffer_load_dwordx4 v10, s[8:11], s46 offen offset:2048 lds
  buffer_load_dwordx4 v11, s[8:11], s46 offen offset:3072 lds
  s_add_u32 m0, s44, 4096
  s_nop 0
  buffer_load_dwordx4 v12, s[8:11], s46 offen offset:0 lds
  buffer_load_dwordx4 v13, s[8:11], s46 offen offset:1024 lds
  buffer_load_dwordx4 v14, s[8:11], s46 offen offset:2048 lds
  buffer_load_dwordx4 v15, s[8:11], s46 offen offset:3072 lds
  s_add_u32 s46, s46, 262144
  s_add_u32 s44, s44, 34816
  s_cmp_ge_u32 s44, s48
  s_cselect_b32 s44, s47, s44
  s_cmp_lg_u32 s49, 72
  s_cbranch_scc1 k2sw_30
  s_mov_b32 s8, s30
  s_and_b32 s9, s31, 0xffff
  s_mov_b32 s10, 37355520
  s_mov_b32 s11, 0x20000
  s_mov_b32 s46, s42
k2sw_30:
  s_add_u32 s49, s49, 1
  s_add_u32 m0, s44, 0
  s_nop 0
  buffer_load_dwordx4 v8, s[8:11], s46 offen offset:0 lds
  buffer_load_dwordx4 v9, s[8:11], s46 offen offset:1024 lds
  buffer_load_dwordx4 v10, s[8:11], s46 offen offset:2048 lds
  buffer_load_dwordx4 v11, s[8:11], s46 offen offset:3072 lds
  s_add_u32 m0, s44, 4096
  s_nop 0
  buffer_load_dwordx4 v12, s[8:11], s46 offen offset:0 lds
  buffer_load_dwordx4 v13, s[8:11], s46 offen offset:1024 lds
  buffer_load_dwordx4 v14, s[8:11], s46 offen offset:2048 lds
  buffer_load_dwordx4 v15, s[8:11], s46 offen offset:3072 lds
  s_add_u32 s46, s46, 262144
  s_add_u32 s44, s44, 34816
  s_cmp_ge_u32 s44, s48
  s_cselect_b32 s44, s47, s44
  s_waitcnt vmcnt(8)
  s_barrier
  s_cmp_lg_u32 s49, 72
  s_cbranch_scc1 k2sw_31
  s_mov_b32 s8, s30
  s_and_b32 s9, s31, 0xffff
  s_mov_b32 s10, 37355520
  s_mov_b32 s11, 0x20000
  s_mov_b32 s46, s42
k2sw_31:
  s_add_u32 s49, s49, 1
  s_add_u32 m0, s44, 0
  s_nop 0
  buffer_load_dwordx4 v8, s[8:11], s46 offen offset:0 lds
  buffer_load_dwordx4 v9, s[8:11], s46 offen offset:1024 lds
  buffer_load_dwordx4 v10, s[8:11], s46 offen offset:2048 lds
  buffer_load_dwordx4 v11, s[8:11], s46 offen offset:3072 lds
  s_add_u32 m0, s44, 4096
  s_nop 0
  buffer_load_dwordx4 v12, s[8:11], s46 offen offset:0 lds
  buffer_load_dwordx4 v13, s[8:11], s46 offen offset:1024 lds
  buffer_load_dwordx4 v14, s[8:11], s46 offen offset:2048 lds
  buffer_load_dwordx4 v15, s[8:11], s46 offen offset:3072 lds
  s_add_u32 s46, s46, 262144
  s_add_u32 s44, s44, 34816
  s_cmp_ge_u32 s44, s48
  s_cselect_b32 s44, s47, s44
  s_sub_u32 s45, s40, 3
k2_lqw:
  s_waitcnt vmcnt(8)
  s_barrier
  s_cmp_lg_u32 s49, 72
  s_cbranch_scc1 k2sw_32
  s_mov_b32 s8, s30
  s_and_b32 s9, s31, 0xffff
  s_mov_b32 s10, 37355520
  s_mov_b32 s11, 0x20000
  s_mov_b32 s46, s42
k2sw_32:
  s_add_u32 s49, s49, 1
  s_add_u32 m0, s44, 0
  s_nop 0
  buffer_load_dwordx4 v8, s[8:11], s46 offen offset:0 lds
  buffer_load_dwordx4 v9, s[8:11], s46 offen offset:1024 lds
  buffer_load_dwordx4 v10, s[8:11], s46 offen offset:2048 lds
  buffer_load_dwordx4 v11, s[8:11], s46 offen offset:3072 lds
  s_add_u32 m0, s44, 4096
  s_nop 0
  buffer_load_dwordx4 v12, s[8:11], s46 offen offset:0 lds
  buffer_load_dwordx4 v13, s[8:11], s46 offen offset:1024 lds
  buffer_load_dwordx4 v14, s[8:11], s46 offen offset:2048 lds
  buffer_load_dwordx4 v15, s[8:11], s46 offen offset:3072 lds
  s_add_u32 s46, s46, 262144
  s_add_u32 s44, s44, 34816
  s_cmp_ge_u32 s44, s48
  s_cselect_b32 s44, s47, s44
  s_sub_u32 s45, s45, 1
  s_cmp_lg_u32 s45, 0
  s_cbranch_scc1 k2_lqw
  s_waitcnt vmcnt(8)
  s_barrier
  s_waitcnt vmcnt(0)
  s_barrier
  s_endpgm
k2_ldg:
  v_lshrrev_b32 v3, 3, v0
  v_mul_u32_u24 v3, 10368, v3
  v_and_b32 v4, 7, v0
  v_xor_b32 v4, v4, v1
  s_sub_u32 s41, s3, 6
  s_lshl_b32 s43, s41, 2
  v_xor_b32 v4, s43, v4
  v_lshl_add_u32 v5, v4, 4, v3
  v_xor_b32 v4, 4, v4
  v_lshl_add_u32 v6, v4, 4, v3
  v_add_u32 v8, 0, v5
  v_add_u32 v9, 81920, v6
  v_add_u32 v10, 163840, v5
  v_add_u32 v11, 245760, v6
  v_add_u32 v12, 331776, v5
  v_add_u32 v13, 413696, v6
  v_add_u32 v14, 495616, v5
  v_add_u32 v15, 577536, v6
  v_add_u32 v16, 663552, v5
  s_mul_i32 s46, s5, 1492992
  s_mul_i32 s43, s41, 746496
  s_add_u32 s46, s46, s43
  s_lshl_b32 s43, s39, 7
  s_add_u32 s46, s46, s43
  s_add_u32 s46, s46, 2490368
  s_mul_i32 s47, s41, 9216
  s_add_u32 s47, s47, 16384
  s_and_b32 s43, s7, 7
  s_mul_i32 s43, s43, 18
  s_mul_i32 s50, s41, 63
  s_sub_i32 s43, s43, s50
  s_mul_i32 s43, s43, 10368
  s_add_i32 s43, s43, 0
  v_mul_u32_u24 v2, 10368, v0
  s_add_i32 s51, s46, s43
  v_mov_b32 v7, 0x40000000
  v_cmp_gt_u32 vcc, 9, v0
  s_nop 1
  v_cndmask_b32 v7, v7, v2, vcc
  s_add_u32 s48, s47, 104448
  s_mov_b32 s44, s47
  s_mov_b32 s49, s39
  s_add_u32 m0, s44, 0
  s_nop 0
  buffer_load_dwordx4 v8, s[12:15], s46 offen offset:0 lds
  buffer_load_dwordx4 v9, s[12:15], s46 offen offset:1024 lds
  buffer_load_dwordx4 v10, s[12:15], s46 offen offset:2048 lds
  buffer_load_dwordx4 v11, s[12:15], s46 offen offset:3072 lds
  s_add_u32 m0, s44, 4096
  s_nop 0
  buffer_load_dwordx4 v12, s[12:15], s46 offen offset:0 lds
  buffer_load_dwordx4 v13, s[12:15], s46 offen offset:1024 lds
  buffer_load_dwordx4 v14, s[12:15], s46 offen offset:2048 lds
  buffer_load_dwordx4 v15, s[12:15], s46 offen offset:3072 lds
  s_add_u32 m0, s44, 8192
  s_nop 0
  buffer_load_dwordx4 v16, s[12:15], s46 offen offset:0 lds
  s_add_u32 s46, s46, 128
  s_add_u32 s44, s44, 34816
  s_cmp_ge_u32 s44, s48
  s_cselect_b32 s44, s47, s44
  s_add_u32 m0, s44, 0
  s_nop 0
  buffer_load_dwordx4 v8, s[12:15], s46 offen offset:0 lds
  buffer_load_dwordx4 v9, s[12:15], s46 offen offset:1024 lds
  buffer_load_dwordx4 v10, s[12:15], s46 offen offset:2048 lds
  buffer_load_dwordx4 v11, s[12:15], s46 offen offset:3072 lds
  s_add_u32 m0, s44, 4096
  s_nop 0
  buffer_load_dwordx4 v12, s[12:15], s46 offen offset:0 lds
  buffer_load_dwordx4 v13, s[12:15], s46 offen offset:1024 lds
  buffer_load_dwordx4 v14, s[12:15], s46 offen offset:2048 lds
  buffer_load_dwordx4 v15, s[12:15], s46 offen offset:3072 lds
  s_add_u32 m0, s44, 8192
  s_nop 0
  buffer_load_dwordx4 v16, s[12:15], s46 offen offset:0 lds
  s_add_u32 s46, s46, 128
  s_add_u32 s44, s44, 34816
  s_cmp_ge_u32 s44, s48
  s_cselect_b32 s44, s47, s44
  s_waitcnt vmcnt(9)
  s_barrier
  s_add_u32 m0, s44, 0
  s_nop 0
  buffer_load_dwordx4 v8, s[12:15], s46 offen offset:0 lds
  buffer_load_dwordx4 v9, s[12:15], s46 offen offset:1024 lds
  buffer_load_dwordx4 v10, s[12:15], s46 offen offset:2048 lds
  buffer_load_dwordx4 v11, s[12:15], s46 offen offset:3072 lds
  s_add_u32 m0, s44, 4096
  s_nop 0
  buffer_load_dwordx4 v12, s[12:15], s46 offen offset:0 lds
  buffer_load_dwordx4 v13, s[12:15], s46 offen offset:1024 lds
  buffer_load_dwordx4 v14, s[12:15], s46 offen offset:2048 lds
  buffer_load_dwordx4 v15, s[12:15], s46 offen offset:3072 lds
  s_add_u32 m0, s44, 8192
  s_nop 0
  buffer_load_dwordx4 v16, s[12:15], s46 offen offset:0 lds
  s_add_u32 s46, s46, 128
  s_add_u32 s44, s44, 34816
  s_cmp_ge_u32 s44, s48
  s_cselect_b32 s44, s47, s44
  s_sub_u32 s45, s40, 3
k2_lqg:
  s_waitcnt vmcnt(9)
  s_barrier
  s_add_u32 m0, s44, 0
  s_nop 0
  buffer_load_dwordx4 v8, s[12:15], s46 offen offset:0 lds
  buffer_load_dwordx4 v9, s[12:15], s46 offen offset:1024 lds
  buffer_load_dwordx4 v10, s[12:15], s46 offen offset:2048 lds
  buffer_load_dwordx4 v11, s[12:15], s46 offen offset:3072 lds
  s_add_u32 m0, s44, 4096
  s_nop 0
  buffer_load_dwordx4 v12, s[12:15], s46 offen offset:0 lds
  buffer_load_dwordx4 v13, s[12:15], s46 offen offset:1024 lds
  buffer_load_dwordx4 v14, s[12:15], s46 offen offset:2048 lds
  buffer_load_dwordx4 v15, s[12:15], s46 offen offset:3072 lds
  s_add_u32 m0, s44, 8192
  s_nop 0
  buffer_load_dwordx4 v16, s[12:15], s46 offen offset:0 lds
  s_add_u32 s46, s46, 128
  s_add_u32 s44, s44, 34816
  s_cmp_ge_u32 s44, s48
  s_cselect_b32 s44, s47, s44
  s_sub_u32 s45, s45, 1
  s_cmp_lg_u32 s45, 0
  s_cbranch_scc1 k2_lqg
  s_waitcnt vmcnt(9)
  s_barrier
  s_waitcnt vmcnt(0)
  s_barrier
  s_endpgm
k2_exit:
  s_endpgm
.section .rodata,"a"
.p2align 6
.amdhsa_kernel k0_ln_qkv_kernel
  .amdhsa_next_free_vgpr 256
  .amdhsa_next_free_sgpr 102
  .amdhsa_accum_offset 256
  .amdhsa_group_segment_fixed_size 0
  .amdhsa_kernarg_size 88
  .amdhsa_user_sgpr_count 2
  .amdhsa_user_sgpr_kernarg_segment_ptr 1
  .amdhsa_system_sgpr_workgroup_id_x 1
.end_amdhsa_kernel
.p2align 6
.amdhsa_kernel k1_gemm1_attn_kernel
  .amdhsa_next_free_vgpr 256
  .amdhsa_next_free_sgpr 102
  .amdhsa_accum_offset 256
  .amdhsa_group_segment_fixed_size 0
  .amdhsa_kernarg_size 88
  .amdhsa_user_sgpr_count 2
  .amdhsa_user_sgpr_kernarg_segment_ptr 1
  .amdhsa_system_sgpr_workgroup_id_x 1
.end_amdhsa_kernel
.p2align 6
.amdhsa_kernel k2_gemm2_kernel
  .amdhsa_next_free_vgpr 256
  .amdhsa_next_free_sgpr 102
  .amdhsa_accum_offset 256
  .amdhsa_group_segment_fixed_size 0
  .amdhsa_kernarg_size 88
  .amdhsa_user_sgpr_count 2
  .amdhsa_user_sgpr_kernarg_segment_ptr 1
  .amdhsa_system_sgpr_workgroup_id_x 1
.end_amdhsa_kernel
```
